```python
import torch

def _softmax(x, axis=-1):
    return torch.softmax(x, dim=axis)
def _gelu(x):
    return torch.nn.functional.gelu(x, approximate="tanh")
def _silu(x):
    return torch.nn.functional.silu(x)
def _sigmoid(x):
    return torch.sigmoid(x)
def _layernorm(x, axis=-1, eps=1e-5):
    m = x.mean(dim=axis, keepdim=True)
    v = x.var(dim=axis, keepdim=True, unbiased=False)
    return (x - m) / torch.sqrt(v + eps)
def _scatter_add(tgt, idx, src, axis=0):
    return tgt.clone().index_add_(axis, idx, src)
def _segment_sum(src, seg, n):
    out = torch.zeros((n,) + src.shape[1:], dtype=src.dtype)
    return out.index_add_(0, seg, src)
def _pad(x, pw):
    flat = tuple(v for pair in reversed(pw) for v in pair)
    return torch.nn.functional.pad(x, flat)

kernel_name = 'standalone__mha_softmax__near_ridge'

def setup_inputs():

    _w = (lambda a: (lambda t: t.to(torch.bfloat16) if t.is_floating_point() else t)(torch.as_tensor(a)))
    B, H, Sq, Sk, D = 16, 16, 512, 512, 256
    return {
        "q": _w((lambda *s: torch.randn(*s, dtype=torch.bfloat16) * 0.8)(B, H, Sq, D)),
        "k": _w((lambda *s: torch.randn(*s, dtype=torch.bfloat16) * 0.8)(B, H, Sk, D)),
        "v": _w((lambda *s: torch.randn(*s, dtype=torch.bfloat16) * 0.05)(B, H, Sk, D)),
    }

def reference(q, k, v):
    scale = q.shape[-1] ** -0.5
    scores = torch.einsum("bhqd,bhkd->bhqk", q, k) * scale
    p = _softmax(scores, axis=-1)
    return torch.einsum("bhqk,bhkd->bhqd", p, v)
```

```asm
; @launch grid=(256,1,1) block=(256,1,1) lds=157952
.amdgcn_target "amdgcn-amd-amdhsa--gfx950"
.text
.globl standalone__mha_softmax__near_ridge_kernel
.p2align 8
.type standalone__mha_softmax__near_ridge_kernel,@function
standalone__mha_softmax__near_ridge_kernel:
    s_cmp_ge_u32 s2, 256
    s_cbranch_scc1 L_exit
    s_load_dwordx4 s[40:43], s[0:1], 0
    s_load_dwordx4 s[44:47], s[0:1], 16
    v_lshrrev_b32 v21, 6, v0
    v_and_b32 v0, 63, v0
    v_readfirstlane_b32 s20, v21
    v_lshrrev_b32 v24, 5, v0
    v_and_b32 v25, 31, v0
    v_lshlrev_b32 v5, 13, v24
    v_lshl_add_u32 v5, v25, 4, v5
    v_lshl_add_u32 v5, v21, 9, v5
    v_add_u32 v6, 1008, v5
    v_add_u32 v7, 2016, v5
    v_add_u32 v8, 3024, v5
    s_and_b32 s33, s2, 7
    s_lshr_b32 s34, s2, 4
    s_lshl_b32 s34, s34, 3
    s_add_u32 s33, s33, s34
    s_lshl_b32 s24, s33, 18
    s_mov_b32 s25, s24
    s_bfe_u32 s34, s2, 0x10003
    s_lshl_b32 s34, s34, 17
    s_add_u32 s23, s24, s34
    s_mul_i32 s30, s20, 4160
    s_mov_b32 s38, 16640
    s_mov_b32 s39, 149760
    s_mov_b32 s28, 66560
    s_mov_b32 s29, 0
    s_mov_b32 s22, 0
    s_mov_b32 s87, 0xffff
    s_lshl_b32 s33, s20, 14
    s_add_u32 s76, s23, s33
    s_add_u32 s77, s76, 0x2000
    s_add_u32 s78, s76, 0x10000
    s_add_u32 s79, s76, 0x12000
    s_mul_i32 s80, s20, 16640
    s_waitcnt lgkmcnt(0)
    s_mov_b32 s4, s40
    s_and_b32 s5, s41, 0xffff
    s_mov_b32 s6, 67108864
    s_mov_b32 s7, 0x20000
    s_mov_b32 s8, s42
    s_and_b32 s9, s43, 0xffff
    s_mov_b32 s10, 67108864
    s_mov_b32 s11, 0x20000
    s_mov_b32 s12, s44
    s_and_b32 s13, s45, 0xffff
    s_mov_b32 s14, 67108864
    s_mov_b32 s15, 0x20000
    s_mov_b32 s16, s46
    s_and_b32 s17, s47, 0xffff
    s_mov_b32 s18, 67108864
    s_mov_b32 s19, 0x20000
    s_add_u32 m0, s29, s30
    s_add_u32 s29, s29, s38
    s_sub_u32 s31, s29, s39
    s_min_u32 s29, s29, s31
    buffer_load_dwordx4 v5, s[4:7], s23 offen offset:0 nt lds
    buffer_load_dwordx4 v6, s[4:7], s23 offen offset:1040 nt lds
    buffer_load_dwordx4 v7, s[4:7], s23 offen offset:2080 nt lds
    buffer_load_dwordx4 v8, s[4:7], s23 offen offset:3120 nt lds
    s_add_u32 s23, s23, 0x4000
    s_bitcmp1_b32 s2, 4
    s_cbranch_scc0 L_deep0
    s_waitcnt vmcnt(0)
L_deep0:
    s_add_u32 m0, s29, s30
    s_add_u32 s29, s29, s38
    s_sub_u32 s31, s29, s39
    s_min_u32 s29, s29, s31
    buffer_load_dwordx4 v5, s[4:7], s23 offen offset:0 nt lds
    buffer_load_dwordx4 v6, s[4:7], s23 offen offset:1040 nt lds
    buffer_load_dwordx4 v7, s[4:7], s23 offen offset:2080 nt lds
    buffer_load_dwordx4 v8, s[4:7], s23 offen offset:3120 nt lds
    s_add_u32 s23, s23, 0x4000
    s_bitcmp1_b32 s2, 4
    s_cbranch_scc0 L_deep1
    s_waitcnt vmcnt(0)
L_deep1:
    s_add_u32 m0, s29, s30
    s_add_u32 s29, s29, s38
    s_sub_u32 s31, s29, s39
    s_min_u32 s29, s29, s31
    buffer_load_dwordx4 v5, s[4:7], s23 offen offset:0 nt lds
    buffer_load_dwordx4 v6, s[4:7], s23 offen offset:1040 nt lds
    buffer_load_dwordx4 v7, s[4:7], s23 offen offset:2080 nt lds
    buffer_load_dwordx4 v8, s[4:7], s23 offen offset:3120 nt lds
    s_add_u32 s23, s23, 0x4000
    s_bitcmp1_b32 s2, 4
    s_cbranch_scc0 L_deep2
    s_waitcnt vmcnt(0)
L_deep2:
    s_add_u32 m0, s29, s30
    s_add_u32 s29, s29, s38
    s_sub_u32 s31, s29, s39
    s_min_u32 s29, s29, s31
    buffer_load_dwordx4 v5, s[4:7], s23 offen offset:0 nt lds
    buffer_load_dwordx4 v6, s[4:7], s23 offen offset:1040 nt lds
    buffer_load_dwordx4 v7, s[4:7], s23 offen offset:2080 nt lds
    buffer_load_dwordx4 v8, s[4:7], s23 offen offset:3120 nt lds
    s_add_u32 s23, s23, 0x4000
    s_bitcmp1_b32 s2, 4
    s_cbranch_scc0 L_deep3
    s_waitcnt vmcnt(0)
L_deep3:
    s_add_u32 m0, s29, s30
    s_add_u32 s29, s29, s38
    s_sub_u32 s31, s29, s39
    s_min_u32 s29, s29, s31
    buffer_load_dwordx4 v5, s[8:11], s24 offen offset:0 nt lds
    buffer_load_dwordx4 v6, s[8:11], s24 offen offset:1040 nt lds
    buffer_load_dwordx4 v7, s[8:11], s24 offen offset:2080 nt lds
    buffer_load_dwordx4 v8, s[8:11], s24 offen offset:3120 nt lds
    s_add_u32 s24, s24, 0x4000
    s_bitcmp1_b32 s2, 4
    s_cbranch_scc0 L_deep4
    s_waitcnt vmcnt(0)
L_deep4:
    s_add_u32 m0, s29, s30
    s_add_u32 s29, s29, s38
    s_sub_u32 s31, s29, s39
    s_min_u32 s29, s29, s31
    buffer_load_dwordx4 v5, s[4:7], s23 offen offset:0 nt lds
    buffer_load_dwordx4 v6, s[4:7], s23 offen offset:1040 nt lds
    buffer_load_dwordx4 v7, s[4:7], s23 offen offset:2080 nt lds
    buffer_load_dwordx4 v8, s[4:7], s23 offen offset:3120 nt lds
    s_add_u32 s23, s23, 0x4000
    s_bitcmp1_b32 s2, 4
    s_cbranch_scc0 L_deep5
    s_waitcnt vmcnt(0)
L_deep5:
    v_and_b32 v24, 15, v0
    v_lshrrev_b32 v25, 4, v0
    v_lshrrev_b32 v26, 2, v24
    v_and_b32 v27, 1, v26
    v_lshrrev_b32 v26, 1, v26
    v_lshl_add_u32 v26, v27, 1, v26
    v_mov_b32 v22, v26
    v_and_b32 v27, 3, v24
    v_lshl_add_u32 v26, v27, 2, v26
    v_mul_u32_u24 v1, 1040, v26
    v_lshl_add_u32 v1, v25, 6, v1
    v_and_b32 v27, 1, v25
    v_lshrrev_b32 v26, 1, v25
    v_lshl_add_u32 v26, v27, 1, v26
    v_bfe_u32 v27, v0, 2, 2
    v_lshl_add_u32 v26, v27, 2, v26
    v_mul_u32_u24 v2, 1040, v26
    v_and_b32 v27, 3, v0
    v_lshl_add_u32 v2, v27, 3, v2
    v_and_b32 v27, 3, v24
    v_lshl_add_u32 v26, v22, 2, v27
    v_lshrrev_b32 v22, 3, v26
    v_lshl_add_u32 v27, v22, 2, v27
    v_and_b32 v22, 1, v25
    v_lshrrev_b32 v23, 1, v25
    v_lshl_add_u32 v22, v22, 1, v23
    v_xor_b32 v27, v27, v22
    v_lshlrev_b32 v27, 4, v27
    v_lshl_add_u32 v27, v26, 7, v27
    v_lshl_add_u32 v27, v21, 11, v27
    v_add_u32 v120, 149760, v27
    v_xor_b32 v121, 64, v120
    v_lshrrev_b32 v26, 3, v0
    v_and_b32 v27, 7, v0
    v_and_b32 v22, 3, v26
    v_xor_b32 v11, v22, v27
    v_lshlrev_b32 v11, 4, v11
    v_lshl_add_u32 v11, v26, 7, v11
    v_lshl_add_u32 v11, v21, 11, v11
    v_add_u32 v11, 149760, v11
    v_xor_b32 v122, 64, v11
    v_add_u32 v122, 0x400, v122
    v_lshlrev_b32 v9, 9, v26
    v_lshl_add_u32 v9, v27, 4, v9
    v_add_u32 v10, 0x1000, v9
    s_mov_b32 s21, 0x3db8aa3b
    s_mov_b32 s35, 0x41000000
    s_getpc_b64 s[64:65]
L_pc:
    s_and_b32 s65, s65, 0xffff
    s_mov_b32 s66, L_code_end-L_pc
    s_mov_b32 s67, 0x20000
    s_lshr_b32 s68, s2, 3
    s_and_b32 s68, s68, 7
    s_lshl_b32 s68, s68, 2
    s_add_u32 s68, s68, s20
    s_mul_i32 s68, s68, 3072
    v_lshlrev_b32 v30, 4, v0
    buffer_load_dwordx4 v[56:59], v30, s[64:67], s68 offen offset:0
    buffer_load_dwordx4 v[60:63], v30, s[64:67], s68 offen offset:1024
    buffer_load_dwordx4 v[64:67], v30, s[64:67], s68 offen offset:2048
    s_waitcnt vmcnt(11)
    s_barrier
    s_add_u32 m0, s29, s30
    s_add_u32 s29, s29, s38
    s_sub_u32 s31, s29, s39
    s_min_u32 s29, s29, s31
    buffer_load_dwordx4 v5, s[4:7], s23 offen offset:0 nt lds
    v_add_u32 v21, s80, v1
    ds_read_b128 a[0:3], v21 offset:0
    ds_read_b128 a[4:7], v21 offset:16
    ds_read_b128 a[8:11], v21 offset:32
    ds_read_b128 a[12:15], v21 offset:48
    ds_read_b128 a[16:19], v21 offset:256
    ds_read_b128 a[20:23], v21 offset:272
    ds_read_b128 a[24:27], v21 offset:288
    ds_read_b128 a[28:31], v21 offset:304
    ds_read_b128 a[32:35], v21 offset:512
    buffer_load_dwordx4 v6, s[4:7], s23 offen offset:1040 nt lds
    ds_read_b128 a[36:39], v21 offset:528
    ds_read_b128 a[40:43], v21 offset:544
    ds_read_b128 a[44:47], v21 offset:560
    ds_read_b128 a[48:51], v21 offset:768
    ds_read_b128 a[52:55], v21 offset:784
    ds_read_b128 a[56:59], v21 offset:800
    ds_read_b128 a[60:63], v21 offset:816
    s_waitcnt vmcnt(9)
    s_waitcnt lgkmcnt(0)
    s_barrier
    v_add_u32 v3, s28, v1
    buffer_load_dwordx4 v7, s[4:7], s23 offen offset:2080 nt lds
    ds_read_b128 v[104:107], v3 offset:0
    ds_read_b128 v[108:111], v3 offset:16
    ds_read_b128 v[112:115], v3 offset:32
    ds_read_b128 v[116:119], v3 offset:48
    s_waitcnt lgkmcnt(3)
    v_mfma_f32_16x16x32_bf16 v[24:27], v[104:107], a[0:3], 0
    v_mfma_f32_16x16x32_bf16 v[32:35], v[104:107], a[32:35], 0
    s_waitcnt lgkmcnt(2)
    buffer_load_dwordx4 v8, s[4:7], s23 offen offset:3120 nt lds
    s_add_u32 s23, s23, 0x4000
    ds_read_b128 v[104:107], v3 offset:256
    v_mfma_f32_16x16x32_bf16 v[24:27], v[108:111], a[4:7], v[24:27]
    v_mfma_f32_16x16x32_bf16 v[32:35], v[108:111], a[36:39], v[32:35]
    s_waitcnt lgkmcnt(2)
    ds_read_b128 v[108:111], v3 offset:272
    s_add_u32 m0, s29, s30
    s_add_u32 s29, s29, s38
    s_sub_u32 s31, s29, s39
    s_min_u32 s29, s29, s31
    buffer_load_dwordx4 v5, s[4:7], s23 offen offset:0 nt lds
    v_mfma_f32_16x16x32_bf16 v[24:27], v[112:115], a[8:11], v[24:27]
    v_mfma_f32_16x16x32_bf16 v[32:35], v[112:115], a[40:43], v[32:35]
    s_waitcnt lgkmcnt(2)
    ds_read_b128 v[112:115], v3 offset:288
    v_mfma_f32_16x16x32_bf16 v[24:27], v[116:119], a[12:15], v[24:27]
    buffer_load_dwordx4 v6, s[4:7], s23 offen offset:1040 nt lds
    v_mfma_f32_16x16x32_bf16 v[32:35], v[116:119], a[44:47], v[32:35]
    s_waitcnt lgkmcnt(2)
    ds_read_b128 v[116:119], v3 offset:304
    v_mfma_f32_16x16x32_bf16 v[24:27], v[104:107], a[16:19], v[24:27]
    buffer_load_dwordx4 v7, s[4:7], s23 offen offset:2080 nt lds
    v_mfma_f32_16x16x32_bf16 v[32:35], v[104:107], a[48:51], v[32:35]
    s_waitcnt lgkmcnt(2)
    ds_read_b128 v[104:107], v3 offset:512
    v_mfma_f32_16x16x32_bf16 v[24:27], v[108:111], a[20:23], v[24:27]
    v_mfma_f32_16x16x32_bf16 v[32:35], v[108:111], a[52:55], v[32:35]
    s_waitcnt lgkmcnt(2)
    buffer_load_dwordx4 v8, s[4:7], s23 offen offset:3120 nt lds
    s_add_u32 s23, s23, 0x4000
    ds_read_b128 v[108:111], v3 offset:528
    v_mfma_f32_16x16x32_bf16 v[24:27], v[112:115], a[24:27], v[24:27]
    v_mfma_f32_16x16x32_bf16 v[32:35], v[112:115], a[56:59], v[32:35]
    s_waitcnt lgkmcnt(2)
    ds_read_b128 v[112:115], v3 offset:544
    s_add_u32 m0, s29, s30
    s_add_u32 s29, s29, s38
    s_sub_u32 s31, s29, s39
    s_min_u32 s29, s29, s31
    buffer_load_dwordx4 v5, s[4:7], s23 offen offset:0 nt lds
    v_mfma_f32_16x16x32_bf16 v[24:27], v[116:119], a[28:31], v[24:27]
    v_mfma_f32_16x16x32_bf16 v[32:35], v[116:119], a[60:63], v[32:35]
    s_waitcnt lgkmcnt(2)
    ds_read_b128 v[116:119], v3 offset:560
    v_mfma_f32_16x16x32_bf16 v[28:31], v[104:107], a[0:3], 0
    buffer_load_dwordx4 v6, s[4:7], s23 offen offset:1040 nt lds
    v_mfma_f32_16x16x32_bf16 v[36:39], v[104:107], a[32:35], 0
    s_waitcnt lgkmcnt(2)
    ds_read_b128 v[104:107], v3 offset:768
    v_mfma_f32_16x16x32_bf16 v[28:31], v[108:111], a[4:7], v[28:31]
    buffer_load_dwordx4 v7, s[4:7], s23 offen offset:2080 nt lds
    v_mfma_f32_16x16x32_bf16 v[36:39], v[108:111], a[36:39], v[36:39]
    s_waitcnt lgkmcnt(2)
    ds_read_b128 v[108:111], v3 offset:784
    v_mfma_f32_16x16x32_bf16 v[28:31], v[112:115], a[8:11], v[28:31]
    v_mfma_f32_16x16x32_bf16 v[36:39], v[112:115], a[40:43], v[36:39]
    s_waitcnt lgkmcnt(2)
    buffer_load_dwordx4 v8, s[4:7], s23 offen offset:3120 nt lds
    s_add_u32 s23, s23, 0x4000
    ds_read_b128 v[112:115], v3 offset:800
    v_mfma_f32_16x16x32_bf16 v[28:31], v[116:119], a[12:15], v[28:31]
    v_mfma_f32_16x16x32_bf16 v[36:39], v[116:119], a[44:47], v[36:39]
    s_waitcnt lgkmcnt(2)
    ds_read_b128 v[116:119], v3 offset:816
    s_add_u32 m0, s29, s30
    s_add_u32 s29, s29, s38
    s_sub_u32 s31, s29, s39
    s_min_u32 s29, s29, s31
    buffer_load_dwordx4 v5, s[8:11], s24 offen offset:0 nt lds
    v_mfma_f32_16x16x32_bf16 v[28:31], v[104:107], a[16:19], v[28:31]
    v_mfma_f32_16x16x32_bf16 v[36:39], v[104:107], a[48:51], v[36:39]
    s_waitcnt lgkmcnt(2)
    v_mfma_f32_16x16x32_bf16 v[28:31], v[108:111], a[20:23], v[28:31]
    v_mfma_f32_16x16x32_bf16 v[36:39], v[108:111], a[52:55], v[36:39]
    s_waitcnt lgkmcnt(1)
    buffer_load_dwordx4 v6, s[8:11], s24 offen offset:1040 nt lds
    v_mfma_f32_16x16x32_bf16 v[28:31], v[112:115], a[24:27], v[28:31]
    v_mfma_f32_16x16x32_bf16 v[36:39], v[112:115], a[56:59], v[36:39]
    s_waitcnt lgkmcnt(0)
    v_mfma_f32_16x16x32_bf16 v[28:31], v[116:119], a[28:31], v[28:31]
    v_mfma_f32_16x16x32_bf16 v[36:39], v[116:119], a[60:63], v[36:39]
    s_waitcnt vmcnt(2)
    buffer_load_dwordx4 v7, s[8:11], s24 offen offset:2080 nt lds
    s_barrier
    s_add_u32 s33, s28, s80
    s_add_u32 s33, s33, s38
    s_sub_u32 s34, s33, s39
    s_min_u32 s33, s33, s34
    v_add_u32 v21, s33, v1
    s_add_u32 s28, s28, 83200
    s_sub_u32 s48, s28, s39
    s_min_u32 s28, s28, s48
    ds_read_b128 a[64:67], v21 offset:0
    ds_read_b128 a[96:99], v21 offset:512
    ds_read_b128 a[68:71], v21 offset:16
    ds_read_b128 a[100:103], v21 offset:528
    ds_read_b128 a[72:75], v21 offset:32
    ds_read_b128 a[104:107], v21 offset:544
    ds_read_b128 a[76:79], v21 offset:48
    buffer_load_dwordx4 v8, s[8:11], s24 offen offset:3120 nt lds
    s_add_u32 s24, s24, 0x4000
    ds_read_b128 a[108:111], v21 offset:560
    ds_read_b128 v[104:107], v3 offset:0
    ds_read_b128 v[108:111], v3 offset:16
    ds_read_b128 v[112:115], v3 offset:32
    ds_read_b128 v[116:119], v3 offset:48
    s_waitcnt lgkmcnt(3)
    v_mfma_f32_16x16x32_bf16 v[40:43], v[104:107], a[64:67], 0
    ds_read_b128 a[80:83], v21 offset:256
    v_mfma_f32_16x16x32_bf16 v[48:51], v[104:107], a[96:99], 0
    s_waitcnt lgkmcnt(3)
    ds_read_b128 v[104:107], v3 offset:256
    ds_read_b128 a[112:115], v21 offset:768
    v_mfma_f32_16x16x32_bf16 v[40:43], v[108:111], a[68:71], v[40:43]
    s_add_u32 m0, s29, s30
    s_add_u32 s29, s29, s38
    s_sub_u32 s31, s29, s39
    s_min_u32 s29, s29, s31
    buffer_load_dwordx4 v5, s[12:15], s25 offen offset:0 nt lds
    ds_read_b128 a[84:87], v21 offset:272
    v_mfma_f32_16x16x32_bf16 v[48:51], v[108:111], a[100:103], v[48:51]
    s_waitcnt lgkmcnt(5)
    ds_read_b128 v[108:111], v3 offset:272
    ds_read_b128 a[116:119], v21 offset:784
    v_mfma_f32_16x16x32_bf16 v[40:43], v[112:115], a[72:75], v[40:43]
    ds_read_b128 a[88:91], v21 offset:288
    v_mfma_f32_16x16x32_bf16 v[48:51], v[112:115], a[104:107], v[48:51]
    s_waitcnt lgkmcnt(7)
    ds_read_b128 v[112:115], v3 offset:288
    ds_read_b128 a[120:123], v21 offset:800
    v_mfma_f32_16x16x32_bf16 v[40:43], v[116:119], a[76:79], v[40:43]
    buffer_load_dwordx4 v6, s[12:15], s25 offen offset:1040 nt lds
    ds_read_b128 a[92:95], v21 offset:304
    v_mfma_f32_16x16x32_bf16 v[48:51], v[116:119], a[108:111], v[48:51]
    s_waitcnt lgkmcnt(7)
    ds_read_b128 v[116:119], v3 offset:304
    ds_read_b128 a[124:127], v21 offset:816
    v_mfma_f32_16x16x32_bf16 v[40:43], v[104:107], a[80:83], v[40:43]
    v_mfma_f32_16x16x32_bf16 v[48:51], v[104:107], a[112:115], v[48:51]
    s_waitcnt lgkmcnt(6)
    ds_read_b128 v[104:107], v3 offset:512
    buffer_load_dwordx4 v7, s[12:15], s25 offen offset:2080 nt lds
    v_mfma_f32_16x16x32_bf16 v[40:43], v[108:111], a[84:87], v[40:43]
    v_mfma_f32_16x16x32_bf16 v[48:51], v[108:111], a[116:119], v[48:51]
    s_waitcnt lgkmcnt(4)
    ds_read_b128 v[108:111], v3 offset:528
    v_mfma_f32_16x16x32_bf16 v[40:43], v[112:115], a[88:91], v[40:43]
    v_mfma_f32_16x16x32_bf16 v[48:51], v[112:115], a[120:123], v[48:51]
    s_waitcnt lgkmcnt(2)
    ds_read_b128 v[112:115], v3 offset:544
    buffer_load_dwordx4 v8, s[12:15], s25 offen offset:3120 nt lds
    s_add_u32 s25, s25, 0x4000
    v_mfma_f32_16x16x32_bf16 v[40:43], v[116:119], a[92:95], v[40:43]
    v_mfma_f32_16x16x32_bf16 v[48:51], v[116:119], a[124:127], v[48:51]
    s_waitcnt lgkmcnt(2)
    ds_read_b128 v[116:119], v3 offset:560
    v_mfma_f32_16x16x32_bf16 v[44:47], v[104:107], a[64:67], 0
    v_mfma_f32_16x16x32_bf16 v[52:55], v[104:107], a[96:99], 0
    s_waitcnt lgkmcnt(2)
    s_add_u32 m0, s29, s30
    s_add_u32 s29, s29, s38
    s_sub_u32 s31, s29, s39
    s_min_u32 s29, s29, s31
    buffer_load_dwordx4 v5, s[8:11], s24 offen offset:0 nt lds
    ds_read_b128 v[104:107], v3 offset:768
    v_mfma_f32_16x16x32_bf16 v[44:47], v[108:111], a[68:71], v[44:47]
    v_mfma_f32_16x16x32_bf16 v[52:55], v[108:111], a[100:103], v[52:55]
    s_waitcnt lgkmcnt(2)
    ds_read_b128 v[108:111], v3 offset:784
    v_mfma_f32_16x16x32_bf16 v[44:47], v[112:115], a[72:75], v[44:47]
    v_mfma_f32_16x16x32_bf16 v[52:55], v[112:115], a[104:107], v[52:55]
    s_waitcnt lgkmcnt(2)
    ds_read_b128 v[112:115], v3 offset:800
    buffer_load_dwordx4 v6, s[8:11], s24 offen offset:1040 nt lds
    v_mfma_f32_16x16x32_bf16 v[44:47], v[116:119], a[76:79], v[44:47]
    v_mfma_f32_16x16x32_bf16 v[52:55], v[116:119], a[108:111], v[52:55]
    s_waitcnt lgkmcnt(2)
    ds_read_b128 v[116:119], v3 offset:816
    v_mfma_f32_16x16x32_bf16 v[44:47], v[104:107], a[80:83], v[44:47]
    v_mfma_f32_16x16x32_bf16 v[52:55], v[104:107], a[112:115], v[52:55]
    s_waitcnt lgkmcnt(2)
    v_mfma_f32_16x16x32_bf16 v[44:47], v[108:111], a[84:87], v[44:47]
    buffer_load_dwordx4 v7, s[8:11], s24 offen offset:2080 nt lds
    v_mfma_f32_16x16x32_bf16 v[52:55], v[108:111], a[116:119], v[52:55]
    s_waitcnt lgkmcnt(1)
    v_mfma_f32_16x16x32_bf16 v[44:47], v[112:115], a[88:91], v[44:47]
    v_mfma_f32_16x16x32_bf16 v[52:55], v[112:115], a[120:123], v[52:55]
    s_waitcnt lgkmcnt(0)
    v_mfma_f32_16x16x32_bf16 v[44:47], v[116:119], a[92:95], v[44:47]
    buffer_load_dwordx4 v8, s[8:11], s24 offen offset:3120 nt lds
    s_add_u32 s24, s24, 0x4000
    v_mfma_f32_16x16x32_bf16 v[52:55], v[116:119], a[124:127], v[52:55]
    s_waitcnt vmcnt(4)
    s_barrier
    v_add_u32 v3, s28, v1
    s_add_u32 s28, s28, s38
    s_sub_u32 s48, s28, s39
    s_min_u32 s28, s28, s48
    ds_read_b128 v[104:107], v3 offset:0
    ds_read_b128 v[108:111], v3 offset:16
    ds_read_b128 v[112:115], v3 offset:32
    ds_read_b128 v[116:119], v3 offset:48
    v_max3_f32 v56, v24, v25, v26
    v_max3_f32 v56, v56, v27, v28
    v_max3_f32 v56, v56, v29, v30
    v_max_f32 v56, v56, v31
    v_mov_b32 v57, v56
    v_max3_f32 v58, v32, v33, v34
    s_add_u32 m0, s29, s30
    s_add_u32 s29, s29, s38
    s_sub_u32 s31, s29, s39
    s_min_u32 s29, s29, s31
    buffer_load_dwordx4 v5, s[12:15], s25 offen offset:0 nt lds
    v_max3_f32 v58, v58, v35, v36
    v_max3_f32 v58, v58, v37, v38
    v_max_f32 v58, v58, v39
    v_mov_b32 v59, v58
    v_max3_f32 v60, v40, v41, v42
    v_max3_f32 v60, v60, v43, v44
    v_max3_f32 v60, v60, v45, v46
    v_max_f32 v60, v60, v47
    v_mov_b32 v61, v60
    v_max3_f32 v62, v48, v49, v50
    v_max3_f32 v62, v62, v51, v52
    v_max3_f32 v62, v62, v53, v54
    v_max_f32 v62, v62, v55
    v_mov_b32 v63, v62
    s_nop 1
    v_permlane16_swap_b32 v56, v57
    v_permlane16_swap_b32 v58, v59
    buffer_load_dwordx4 v6, s[12:15], s25 offen offset:1040 nt lds
    v_permlane16_swap_b32 v60, v61
    v_permlane16_swap_b32 v62, v63
    v_max_f32 v56, v56, v57
    v_max_f32 v58, v58, v59
    v_max_f32 v60, v60, v61
    v_max_f32 v62, v62, v63
    v_mov_b32 v57, v56
    v_mov_b32 v59, v58
    v_mov_b32 v61, v60
    v_mov_b32 v63, v62
    s_nop 1
    v_permlane32_swap_b32 v56, v57
    v_permlane32_swap_b32 v58, v59
    v_permlane32_swap_b32 v60, v61
    v_permlane32_swap_b32 v62, v63
    v_max_f32 v56, v56, v57
    buffer_load_dwordx4 v7, s[12:15], s25 offen offset:2080 nt lds
    v_max_f32 v58, v58, v59
    v_max_f32 v60, v60, v61
    v_max_f32 v62, v62, v63
    v_mul_f32 v12, s21, v56
    v_sub_f32 v12, 0, v12
    v_mov_b32 v16, 0
    v_mul_f32 v13, s21, v58
    v_sub_f32 v13, 0, v13
    v_mov_b32 v17, 0
    v_mul_f32 v14, s21, v60
    v_sub_f32 v14, 0, v14
    v_mov_b32 v18, 0
    v_mul_f32 v15, s21, v62
    v_sub_f32 v15, 0, v15
    v_mov_b32 v19, 0
    v_fma_f32 v24, v24, s21, v12
    v_fma_f32 v25, v25, s21, v12
    v_fma_f32 v26, v26, s21, v12
    buffer_load_dwordx4 v8, s[12:15], s25 offen offset:3120 nt lds
    s_add_u32 s25, s25, 0x4000
    v_fma_f32 v27, v27, s21, v12
    v_fma_f32 v28, v28, s21, v12
    v_fma_f32 v29, v29, s21, v12
    v_fma_f32 v30, v30, s21, v12
    v_fma_f32 v31, v31, s21, v12
    v_fma_f32 v32, v32, s21, v13
    v_fma_f32 v33, v33, s21, v13
    v_fma_f32 v34, v34, s21, v13
    v_fma_f32 v35, v35, s21, v13
    v_fma_f32 v36, v36, s21, v13
    v_fma_f32 v37, v37, s21, v13
    v_fma_f32 v38, v38, s21, v13
    v_fma_f32 v39, v39, s21, v13
    v_fma_f32 v40, v40, s21, v14
    v_fma_f32 v41, v41, s21, v14
    v_fma_f32 v42, v42, s21, v14
    v_fma_f32 v43, v43, s21, v14
    s_add_u32 m0, s29, s30
    s_add_u32 s29, s29, s38
    s_sub_u32 s31, s29, s39
    s_min_u32 s29, s29, s31
    buffer_load_dwordx4 v5, s[8:11], s24 offen offset:0 nt lds
    v_fma_f32 v44, v44, s21, v14
    v_fma_f32 v45, v45, s21, v14
    v_fma_f32 v46, v46, s21, v14
    v_fma_f32 v47, v47, s21, v14
    v_fma_f32 v48, v48, s21, v15
    v_fma_f32 v49, v49, s21, v15
    v_fma_f32 v50, v50, s21, v15
    v_fma_f32 v51, v51, s21, v15
    v_fma_f32 v52, v52, s21, v15
    v_fma_f32 v53, v53, s21, v15
    v_fma_f32 v54, v54, s21, v15
    v_fma_f32 v55, v55, s21, v15
    s_waitcnt lgkmcnt(2)
    v_mfma_f32_16x16x32_bf16 v[56:59], v[104:107], a[0:3], 0
    v_exp_f32 v24, v24
    v_mfma_f32_16x16x32_bf16 v[56:59], v[108:111], a[4:7], v[56:59]
    v_add_u32 v4, s28, v2
    v_add_f32 v16, v16, v24
    v_mfma_f32_16x16x32_bf16 v[64:67], v[104:107], a[32:35], 0
    s_add_u32 s28, s28, s38
    v_exp_f32 v25, v25
    v_mfma_f32_16x16x32_bf16 v[64:67], v[108:111], a[36:39], v[64:67]
    s_sub_u32 s48, s28, s39
    v_exp_f32 v26, v26
    v_mfma_f32_16x16x32_bf16 v[72:75], v[104:107], a[64:67], 0
    s_min_u32 s28, s28, s48
    v_exp_f32 v27, v27
    v_mfma_f32_16x16x32_bf16 v[72:75], v[108:111], a[68:71], v[72:75]
    buffer_load_dwordx4 v6, s[8:11], s24 offen offset:1040 nt lds
    v_exp_f32 v28, v28
    v_mfma_f32_16x16x32_bf16 v[80:83], v[104:107], a[96:99], 0
    ds_read_b128 v[104:107], v3 offset:256
    v_cvt_pk_bf16_f32 v88, v24, v25
    v_mfma_f32_16x16x32_bf16 v[80:83], v[108:111], a[100:103], v[80:83]
    s_waitcnt lgkmcnt(1)
    ds_read_b128 v[108:111], v3 offset:272
    v_cvt_pk_bf16_f32 v89, v26, v27
    v_mfma_f32_16x16x32_bf16 v[56:59], v[112:115], a[8:11], v[56:59]
    v_exp_f32 v29, v29
    v_mfma_f32_16x16x32_bf16 v[56:59], v[116:119], a[12:15], v[56:59]
    v_exp_f32 v30, v30
    v_mfma_f32_16x16x32_bf16 v[64:67], v[112:115], a[40:43], v[64:67]
    v_exp_f32 v31, v31
    v_mfma_f32_16x16x32_bf16 v[64:67], v[116:119], a[44:47], v[64:67]
    v_exp_f32 v32, v32
    v_mfma_f32_16x16x32_bf16 v[72:75], v[112:115], a[72:75], v[72:75]
    v_exp_f32 v33, v33
    v_mfma_f32_16x16x32_bf16 v[72:75], v[116:119], a[76:79], v[72:75]
    buffer_load_dwordx4 v7, s[8:11], s24 offen offset:2080 nt lds
    v_exp_f32 v34, v34
    v_mfma_f32_16x16x32_bf16 v[80:83], v[112:115], a[104:107], v[80:83]
    ds_read_b128 v[112:115], v3 offset:288
    v_cvt_pk_bf16_f32 v90, v28, v29
    v_mfma_f32_16x16x32_bf16 v[80:83], v[116:119], a[108:111], v[80:83]
    s_waitcnt lgkmcnt(1)
    ds_read_b128 v[116:119], v3 offset:304
    v_cvt_pk_bf16_f32 v91, v30, v31
    v_mfma_f32_16x16x32_bf16 v[56:59], v[104:107], a[16:19], v[56:59]
    v_exp_f32 v35, v35
    v_mfma_f32_16x16x32_bf16 v[56:59], v[108:111], a[20:23], v[56:59]
    v_exp_f32 v36, v36
    v_mfma_f32_16x16x32_bf16 v[64:67], v[104:107], a[48:51], v[64:67]
    v_exp_f32 v37, v37
    v_mfma_f32_16x16x32_bf16 v[64:67], v[108:111], a[52:55], v[64:67]
    v_exp_f32 v38, v38
    v_mfma_f32_16x16x32_bf16 v[72:75], v[104:107], a[80:83], v[72:75]
    v_exp_f32 v39, v39
    v_mfma_f32_16x16x32_bf16 v[72:75], v[108:111], a[84:87], v[72:75]
    buffer_load_dwordx4 v8, s[8:11], s24 offen offset:3120 nt lds
    s_add_u32 s24, s24, 0x4000
    v_exp_f32 v40, v40
    v_mfma_f32_16x16x32_bf16 v[80:83], v[104:107], a[112:115], v[80:83]
    ds_read_b128 v[104:107], v3 offset:512
    v_cvt_pk_bf16_f32 v92, v32, v33
    v_mfma_f32_16x16x32_bf16 v[80:83], v[108:111], a[116:119], v[80:83]
    s_waitcnt lgkmcnt(1)
    ds_read_b128 v[108:111], v3 offset:528
    v_cvt_pk_bf16_f32 v93, v34, v35
    v_mfma_f32_16x16x32_bf16 v[56:59], v[112:115], a[24:27], v[56:59]
    v_exp_f32 v41, v41
    v_mfma_f32_16x16x32_bf16 v[56:59], v[116:119], a[28:31], v[56:59]
    v_exp_f32 v42, v42
    v_mfma_f32_16x16x32_bf16 v[64:67], v[112:115], a[56:59], v[64:67]
    v_exp_f32 v43, v43
    v_mfma_f32_16x16x32_bf16 v[64:67], v[116:119], a[60:63], v[64:67]
    v_exp_f32 v44, v44
    v_mfma_f32_16x16x32_bf16 v[72:75], v[112:115], a[88:91], v[72:75]
    v_exp_f32 v45, v45
    v_mfma_f32_16x16x32_bf16 v[72:75], v[116:119], a[92:95], v[72:75]
    s_add_u32 m0, s29, s30
    s_add_u32 s29, s29, s38
    s_sub_u32 s31, s29, s39
    s_min_u32 s29, s29, s31
    buffer_load_dwordx4 v5, s[12:15], s25 offen offset:0 nt lds
    v_exp_f32 v46, v46
    v_mfma_f32_16x16x32_bf16 v[80:83], v[112:115], a[120:123], v[80:83]
    ds_read_b128 v[112:115], v3 offset:544
    v_cvt_pk_bf16_f32 v94, v36, v37
    v_mfma_f32_16x16x32_bf16 v[80:83], v[116:119], a[124:127], v[80:83]
    s_waitcnt lgkmcnt(1)
    ds_read_b128 v[116:119], v3 offset:560
    v_cvt_pk_bf16_f32 v95, v38, v39
    v_mfma_f32_16x16x32_bf16 v[60:63], v[104:107], a[0:3], 0
    v_exp_f32 v47, v47
    v_mfma_f32_16x16x32_bf16 v[60:63], v[108:111], a[4:7], v[60:63]
    v_exp_f32 v48, v48
    v_mfma_f32_16x16x32_bf16 v[68:71], v[104:107], a[32:35], 0
    v_exp_f32 v49, v49
    v_mfma_f32_16x16x32_bf16 v[68:71], v[108:111], a[36:39], v[68:71]
    v_exp_f32 v50, v50
    v_mfma_f32_16x16x32_bf16 v[76:79], v[104:107], a[64:67], 0
    v_exp_f32 v51, v51
    v_mfma_f32_16x16x32_bf16 v[76:79], v[108:111], a[68:71], v[76:79]
    v_exp_f32 v52, v52
    buffer_load_dwordx4 v6, s[12:15], s25 offen offset:1040 nt lds
    v_mfma_f32_16x16x32_bf16 v[84:87], v[104:107], a[96:99], 0
    ds_read_b128 v[104:107], v3 offset:768
    v_cvt_pk_bf16_f32 v96, v40, v41
    v_mfma_f32_16x16x32_bf16 v[84:87], v[108:111], a[100:103], v[84:87]
    s_waitcnt lgkmcnt(1)
    ds_read_b128 v[108:111], v3 offset:784
    v_cvt_pk_bf16_f32 v97, v42, v43
    v_mfma_f32_16x16x32_bf16 v[60:63], v[112:115], a[8:11], v[60:63]
    v_exp_f32 v53, v53
    v_mfma_f32_16x16x32_bf16 v[60:63], v[116:119], a[12:15], v[60:63]
    v_exp_f32 v54, v54
    v_mfma_f32_16x16x32_bf16 v[68:71], v[112:115], a[40:43], v[68:71]
    v_exp_f32 v55, v55
    v_mfma_f32_16x16x32_bf16 v[68:71], v[116:119], a[44:47], v[68:71]
    v_cvt_pk_bf16_f32 v98, v44, v45
    v_cvt_pk_bf16_f32 v99, v46, v47
    v_mfma_f32_16x16x32_bf16 v[76:79], v[112:115], a[72:75], v[76:79]
    v_cvt_pk_bf16_f32 v100, v48, v49
    v_cvt_pk_bf16_f32 v101, v50, v51
    v_mfma_f32_16x16x32_bf16 v[76:79], v[116:119], a[76:79], v[76:79]
    v_cvt_pk_bf16_f32 v102, v52, v53
    buffer_load_dwordx4 v7, s[12:15], s25 offen offset:2080 nt lds
    v_cvt_pk_bf16_f32 v103, v54, v55
    v_mfma_f32_16x16x32_bf16 v[84:87], v[112:115], a[104:107], v[84:87]
    ds_read_b128 v[112:115], v3 offset:800
    v_add_f32 v16, v16, v25
    v_mfma_f32_16x16x32_bf16 v[84:87], v[116:119], a[108:111], v[84:87]
    s_waitcnt lgkmcnt(1)
    ds_read_b128 v[116:119], v3 offset:816
    v_add_f32 v16, v16, v26
    v_mfma_f32_16x16x32_bf16 v[60:63], v[104:107], a[16:19], v[60:63]
    v_add_f32 v16, v16, v27
    v_add_f32 v16, v16, v28
    v_mfma_f32_16x16x32_bf16 v[60:63], v[108:111], a[20:23], v[60:63]
    v_add_u32 v3, s28, v1
    v_add_f32 v16, v16, v29
    v_mfma_f32_16x16x32_bf16 v[68:71], v[104:107], a[48:51], v[68:71]
    s_add_u32 s28, s28, s38
    v_add_f32 v16, v16, v30
    v_add_f32 v16, v16, v31
    v_mfma_f32_16x16x32_bf16 v[68:71], v[108:111], a[52:55], v[68:71]
    s_sub_u32 s48, s28, s39
    v_add_f32 v17, v17, v32
    v_add_f32 v17, v17, v33
    v_mfma_f32_16x16x32_bf16 v[76:79], v[104:107], a[80:83], v[76:79]
    s_min_u32 s28, s28, s48
    v_add_f32 v17, v17, v34
    v_add_f32 v17, v17, v35
    v_mfma_f32_16x16x32_bf16 v[76:79], v[108:111], a[84:87], v[76:79]
    v_add_f32 v17, v17, v36
    v_add_f32 v17, v17, v37
    buffer_load_dwordx4 v8, s[12:15], s25 offen offset:3120 nt lds
    s_add_u32 s25, s25, 0x4000
    v_mfma_f32_16x16x32_bf16 v[84:87], v[104:107], a[112:115], v[84:87]
    ds_read_b64_tr_b16 v[104:105], v4 offset:0
    v_add_f32 v17, v17, v38
    v_mfma_f32_16x16x32_bf16 v[84:87], v[108:111], a[116:119], v[84:87]
    s_waitcnt lgkmcnt(1)
    ds_read_b64_tr_b16 v[106:107], v4 offset:512
    ds_read_b64_tr_b16 v[108:109], v4 offset:32
    v_mfma_f32_16x16x32_bf16 v[60:63], v[112:115], a[24:27], v[60:63]
    ds_read_b64_tr_b16 v[110:111], v4 offset:544
    v_add_f32 v17, v17, v39
    v_mfma_f32_16x16x32_bf16 v[60:63], v[116:119], a[28:31], v[60:63]
    v_add_f32 v18, v18, v40
    v_add_f32 v18, v18, v41
    v_mfma_f32_16x16x32_bf16 v[68:71], v[112:115], a[56:59], v[68:71]
    v_add_f32 v18, v18, v42
    v_add_f32 v18, v18, v43
    v_mfma_f32_16x16x32_bf16 v[68:71], v[116:119], a[60:63], v[68:71]
    v_add_f32 v18, v18, v44
    v_add_f32 v18, v18, v45
    v_mfma_f32_16x16x32_bf16 v[76:79], v[112:115], a[88:91], v[76:79]
    v_add_f32 v18, v18, v46
    v_add_f32 v18, v18, v47
    v_mfma_f32_16x16x32_bf16 v[76:79], v[116:119], a[92:95], v[76:79]
    v_add_f32 v19, v19, v48
    v_add_f32 v19, v19, v49
    v_mfma_f32_16x16x32_bf16 v[84:87], v[112:115], a[120:123], v[84:87]
    ds_read_b64_tr_b16 v[112:113], v4 offset:64
    v_add_f32 v19, v19, v50
    v_mfma_f32_16x16x32_bf16 v[84:87], v[116:119], a[124:127], v[84:87]
    s_waitcnt lgkmcnt(3)
    ds_read_b64_tr_b16 v[114:115], v4 offset:576
    ds_read_b64_tr_b16 v[116:117], v4 offset:96
    v_mfma_f32_16x16x32_bf16 v[128:131], v[104:107], v[88:91], 0
    ds_read_b64_tr_b16 v[118:119], v4 offset:608
    v_fma_f32 v56, v56, s21, v12
    v_mfma_f32_16x16x32_bf16 v[132:135], v[104:107], v[92:95], 0
    v_add_f32 v19, v19, v51
    v_fma_f32 v57, v57, s21, v12
    v_mfma_f32_16x16x32_bf16 v[136:139], v[104:107], v[96:99], 0
    v_fma_f32 v58, v58, s21, v12
    v_mfma_f32_16x16x32_bf16 v[140:143], v[104:107], v[100:103], 0
    s_waitcnt lgkmcnt(4)
    ds_read_b64_tr_b16 v[104:105], v4 offset:128
    v_max3_f32 v20, v56, v57, v58
    v_mfma_f32_16x16x32_bf16 v[144:147], v[108:111], v[88:91], 0
    s_waitcnt vmcnt(8)
    ds_read_b64_tr_b16 v[106:107], v4 offset:640
    v_mfma_f32_16x16x32_bf16 v[148:151], v[108:111], v[92:95], 0
    v_fma_f32 v59, v59, s21, v12
    v_fma_f32 v64, v64, s21, v13
    v_mfma_f32_16x16x32_bf16 v[152:155], v[108:111], v[96:99], 0
    s_barrier
    v_max3_f32 v20, v20, v59, v64
    v_mfma_f32_16x16x32_bf16 v[156:159], v[108:111], v[100:103], 0
    s_waitcnt lgkmcnt(4)
    ds_read_b64_tr_b16 v[108:109], v4 offset:160
    v_fma_f32 v65, v65, s21, v13
    v_mfma_f32_16x16x32_bf16 v[160:163], v[112:115], v[88:91], 0
    s_add_u32 m0, s29, s30
    ds_read_b64_tr_b16 v[110:111], v4 offset:672
    v_fma_f32 v66, v66, s21, v13
    v_mfma_f32_16x16x32_bf16 v[164:167], v[112:115], v[92:95], 0
    s_add_u32 s29, s29, s38
    buffer_load_dwordx4 v5, s[8:11], s24 offen offset:0 nt lds
    v_mfma_f32_16x16x32_bf16 v[168:171], v[112:115], v[96:99], 0
    s_sub_u32 s31, s29, s39
    v_max3_f32 v20, v20, v65, v66
    v_mfma_f32_16x16x32_bf16 v[172:175], v[112:115], v[100:103], 0
    s_waitcnt lgkmcnt(4)
    ds_read_b64_tr_b16 v[112:113], v4 offset:192
    v_fma_f32 v67, v67, s21, v13
    v_mfma_f32_16x16x32_bf16 v[176:179], v[116:119], v[88:91], 0
    s_min_u32 s29, s29, s31
    ds_read_b64_tr_b16 v[114:115], v4 offset:704
    v_add_f32 v19, v19, v52
    v_mfma_f32_16x16x32_bf16 v[180:183], v[116:119], v[92:95], 0
    v_fma_f32 v72, v72, s21, v14
    v_mfma_f32_16x16x32_bf16 v[184:187], v[116:119], v[96:99], 0
    buffer_load_dwordx4 v6, s[8:11], s24 offen offset:1040 nt lds
    v_mfma_f32_16x16x32_bf16 v[188:191], v[116:119], v[100:103], 0
    s_waitcnt lgkmcnt(4)
    ds_read_b64_tr_b16 v[116:117], v4 offset:224
    v_max3_f32 v20, v20, v67, v72
    v_mfma_f32_16x16x32_bf16 v[192:195], v[104:107], v[88:91], 0
    ds_read_b64_tr_b16 v[118:119], v4 offset:736
    v_mfma_f32_16x16x32_bf16 v[196:199], v[104:107], v[92:95], 0
    v_fma_f32 v73, v73, s21, v14
    v_fma_f32 v74, v74, s21, v14
    v_mfma_f32_16x16x32_bf16 v[200:203], v[104:107], v[96:99], 0
    v_max3_f32 v20, v20, v73, v74
    v_mfma_f32_16x16x32_bf16 v[204:207], v[104:107], v[100:103], 0
    s_waitcnt lgkmcnt(4)
    ds_read_b64_tr_b16 v[104:105], v4 offset:256
    v_fma_f32 v75, v75, s21, v14
    v_mfma_f32_16x16x32_bf16 v[208:211], v[108:111], v[88:91], 0
    ds_read_b64_tr_b16 v[106:107], v4 offset:768
    v_fma_f32 v80, v80, s21, v15
    v_mfma_f32_16x16x32_bf16 v[212:215], v[108:111], v[92:95], 0
    buffer_load_dwordx4 v7, s[8:11], s24 offen offset:2080 nt lds
    v_mfma_f32_16x16x32_bf16 v[216:219], v[108:111], v[96:99], 0
    v_max3_f32 v20, v20, v75, v80
    v_mfma_f32_16x16x32_bf16 v[220:223], v[108:111], v[100:103], 0
    s_waitcnt lgkmcnt(4)
    ds_read_b64_tr_b16 v[108:109], v4 offset:288
    v_fma_f32 v81, v81, s21, v15
    v_mfma_f32_16x16x32_bf16 v[224:227], v[112:115], v[88:91], 0
    ds_read_b64_tr_b16 v[110:111], v4 offset:800
    v_mfma_f32_16x16x32_bf16 v[228:231], v[112:115], v[92:95], 0
    v_fma_f32 v82, v82, s21, v15
    v_add_f32 v19, v19, v53
    v_mfma_f32_16x16x32_bf16 v[232:235], v[112:115], v[96:99], 0
    buffer_load_dwordx4 v8, s[8:11], s24 offen offset:3120 nt lds
    v_mfma_f32_16x16x32_bf16 v[236:239], v[112:115], v[100:103], 0
    s_waitcnt lgkmcnt(4)
    ds_read_b64_tr_b16 v[112:113], v4 offset:320
    v_max3_f32 v20, v20, v81, v82
    v_mfma_f32_16x16x32_bf16 v[240:243], v[116:119], v[88:91], 0
    s_add_u32 s24, s24, 0x4000
    ds_read_b64_tr_b16 v[114:115], v4 offset:832
    v_mfma_f32_16x16x32_bf16 v[244:247], v[116:119], v[92:95], 0
    s_add_u32 m0, s29, s30
    v_fma_f32 v83, v83, s21, v15
    v_fma_f32 v60, v60, s21, v12
    v_mfma_f32_16x16x32_bf16 v[248:251], v[116:119], v[96:99], 0
    s_add_u32 s29, s29, s38
    buffer_load_dwordx4 v5, s[12:15], s25 offen offset:0 nt lds
    v_mfma_f32_16x16x32_bf16 v[252:255], v[116:119], v[100:103], 0
    s_waitcnt lgkmcnt(4)
    ds_read_b64_tr_b16 v[116:117], v4 offset:352
    v_mfma_f32_16x16x32_bf16 a[128:131], v[104:107], v[88:91], 0
    s_sub_u32 s31, s29, s39
    ds_read_b64_tr_b16 v[118:119], v4 offset:864
    v_max3_f32 v20, v20, v83, v60
    v_mfma_f32_16x16x32_bf16 a[132:135], v[104:107], v[92:95], 0
    s_min_u32 s29, s29, s31
    v_fma_f32 v61, v61, s21, v12
    v_mfma_f32_16x16x32_bf16 a[136:139], v[104:107], v[96:99], 0
    v_fma_f32 v62, v62, s21, v12
    v_max3_f32 v20, v20, v61, v62
    v_mfma_f32_16x16x32_bf16 a[140:143], v[104:107], v[100:103], 0
    s_waitcnt lgkmcnt(4)
    ds_read_b64_tr_b16 v[104:105], v4 offset:384
    v_fma_f32 v63, v63, s21, v12
    v_mfma_f32_16x16x32_bf16 a[144:147], v[108:111], v[88:91], 0
    ds_read_b64_tr_b16 v[106:107], v4 offset:896
    v_mfma_f32_16x16x32_bf16 a[148:151], v[108:111], v[92:95], 0
    buffer_load_dwordx4 v6, s[12:15], s25 offen offset:1040 nt lds
    v_mfma_f32_16x16x32_bf16 a[152:155], v[108:111], v[96:99], 0
    v_fma_f32 v68, v68, s21, v13
    v_add_f32 v19, v19, v54
    v_mfma_f32_16x16x32_bf16 a[156:159], v[108:111], v[100:103], 0
    s_waitcnt lgkmcnt(4)
    ds_read_b64_tr_b16 v[108:109], v4 offset:416
    v_mfma_f32_16x16x32_bf16 a[160:163], v[112:115], v[88:91], 0
    ds_read_b64_tr_b16 v[110:111], v4 offset:928
    v_max3_f32 v20, v20, v63, v68
    v_mfma_f32_16x16x32_bf16 a[164:167], v[112:115], v[92:95], 0
    v_fma_f32 v69, v69, s21, v13
    v_fma_f32 v70, v70, s21, v13
    v_mfma_f32_16x16x32_bf16 a[168:171], v[112:115], v[96:99], 0
    buffer_load_dwordx4 v7, s[12:15], s25 offen offset:2080 nt lds
    v_mfma_f32_16x16x32_bf16 a[172:175], v[112:115], v[100:103], 0
    s_waitcnt lgkmcnt(4)
    ds_read_b64_tr_b16 v[112:113], v4 offset:448
    v_mfma_f32_16x16x32_bf16 a[176:179], v[116:119], v[88:91], 0
    ds_read_b64_tr_b16 v[114:115], v4 offset:960
    v_max3_f32 v20, v20, v69, v70
    v_mfma_f32_16x16x32_bf16 a[180:183], v[116:119], v[92:95], 0
    v_fma_f32 v71, v71, s21, v13
    v_mfma_f32_16x16x32_bf16 a[184:187], v[116:119], v[96:99], 0
    v_fma_f32 v76, v76, s21, v14
    v_max3_f32 v20, v20, v71, v76
    v_mfma_f32_16x16x32_bf16 a[188:191], v[116:119], v[100:103], 0
    s_waitcnt lgkmcnt(4)
    ds_read_b64_tr_b16 v[116:117], v4 offset:480
    v_mfma_f32_16x16x32_bf16 a[192:195], v[104:107], v[88:91], 0
    ds_read_b64_tr_b16 v[118:119], v4 offset:992
    v_fma_f32 v77, v77, s21, v14
    v_mfma_f32_16x16x32_bf16 a[196:199], v[104:107], v[92:95], 0
    buffer_load_dwordx4 v8, s[12:15], s25 offen offset:3120 nt lds
    v_mfma_f32_16x16x32_bf16 a[200:203], v[104:107], v[96:99], 0
    s_add_u32 s25, s25, 0x4000
    v_fma_f32 v78, v78, s21, v14
    v_max3_f32 v20, v20, v77, v78
    v_mfma_f32_16x16x32_bf16 a[204:207], v[104:107], v[100:103], 0
    s_waitcnt lgkmcnt(4)
    ds_read_b128 v[104:107], v3 offset:0
    v_mfma_f32_16x16x32_bf16 a[208:211], v[108:111], v[88:91], 0
    v_add_f32 v19, v19, v55
    v_fma_f32 v79, v79, s21, v14
    v_mfma_f32_16x16x32_bf16 a[212:215], v[108:111], v[92:95], 0
    v_fma_f32 v84, v84, s21, v15
    v_mfma_f32_16x16x32_bf16 a[216:219], v[108:111], v[96:99], 0
    v_max3_f32 v20, v20, v79, v84
    v_fma_f32 v85, v85, s21, v15
    v_mfma_f32_16x16x32_bf16 a[220:223], v[108:111], v[100:103], 0
    s_waitcnt lgkmcnt(3)
    ds_read_b128 v[108:111], v3 offset:16
    v_mfma_f32_16x16x32_bf16 a[224:227], v[112:115], v[88:91], 0
    v_fma_f32 v86, v86, s21, v15
    v_max3_f32 v20, v20, v85, v86
    v_mfma_f32_16x16x32_bf16 a[228:231], v[112:115], v[92:95], 0
    v_fma_f32 v87, v87, s21, v15
    v_mfma_f32_16x16x32_bf16 a[232:235], v[112:115], v[96:99], 0
    v_max3_f32 v20, v20, v87, v87
    v_mfma_f32_16x16x32_bf16 a[236:239], v[112:115], v[100:103], 0
    s_waitcnt lgkmcnt(2)
    ds_read_b128 v[112:115], v3 offset:32
    v_mfma_f32_16x16x32_bf16 a[240:243], v[116:119], v[88:91], 0
    v_mfma_f32_16x16x32_bf16 a[244:247], v[116:119], v[92:95], 0
    v_cmp_lt_f32 vcc, s35, v20
    v_mfma_f32_16x16x32_bf16 a[248:251], v[116:119], v[96:99], 0
    v_mfma_f32_16x16x32_bf16 a[252:255], v[116:119], v[100:103], 0
    s_waitcnt lgkmcnt(1)
    ds_read_b128 v[116:119], v3 offset:48
    s_cbranch_vccnz L_rare_s0a
L_cont_s0a:
    s_branch L_s1c
L_s11:
    s_add_u32 s23, s23, 33423360
    v_mfma_f32_16x16x32_bf16 v[24:27], v[104:107], a[0:3], 0
    v_exp_f32 v56, v56
    v_mfma_f32_16x16x32_bf16 v[24:27], v[108:111], a[4:7], v[24:27]
    v_add_u32 v4, s28, v2
    v_add_f32 v16, v16, v56
    v_mfma_f32_16x16x32_bf16 v[32:35], v[104:107], a[32:35], 0
    s_add_u32 s28, s28, s38
    v_exp_f32 v57, v57
    v_mfma_f32_16x16x32_bf16 v[32:35], v[108:111], a[36:39], v[32:35]
    s_sub_u32 s48, s28, s39
    v_exp_f32 v58, v58
    v_mfma_f32_16x16x32_bf16 v[40:43], v[104:107], a[64:67], 0
    s_min_u32 s28, s28, s48
    v_exp_f32 v59, v59
    v_mfma_f32_16x16x32_bf16 v[40:43], v[108:111], a[68:71], v[40:43]
    v_exp_f32 v60, v60
    v_mfma_f32_16x16x32_bf16 v[48:51], v[104:107], a[96:99], 0
    ds_read_b128 v[104:107], v3 offset:256
    v_cvt_pk_bf16_f32 v88, v56, v57
    v_mfma_f32_16x16x32_bf16 v[48:51], v[108:111], a[100:103], v[48:51]
    s_waitcnt lgkmcnt(1)
    ds_read_b128 v[108:111], v3 offset:272
    v_cvt_pk_bf16_f32 v89, v58, v59
    v_mfma_f32_16x16x32_bf16 v[24:27], v[112:115], a[8:11], v[24:27]
    v_exp_f32 v61, v61
    v_mfma_f32_16x16x32_bf16 v[24:27], v[116:119], a[12:15], v[24:27]
    v_exp_f32 v62, v62
    v_mfma_f32_16x16x32_bf16 v[32:35], v[112:115], a[40:43], v[32:35]
    v_exp_f32 v63, v63
    v_mfma_f32_16x16x32_bf16 v[32:35], v[116:119], a[44:47], v[32:35]
    v_exp_f32 v64, v64
    v_mfma_f32_16x16x32_bf16 v[40:43], v[112:115], a[72:75], v[40:43]
    v_exp_f32 v65, v65
    v_mfma_f32_16x16x32_bf16 v[40:43], v[116:119], a[76:79], v[40:43]
    v_exp_f32 v66, v66
    v_mfma_f32_16x16x32_bf16 v[48:51], v[112:115], a[104:107], v[48:51]
    ds_read_b128 v[112:115], v3 offset:288
    v_cvt_pk_bf16_f32 v90, v60, v61
    v_mfma_f32_16x16x32_bf16 v[48:51], v[116:119], a[108:111], v[48:51]
    s_waitcnt lgkmcnt(1)
    ds_read_b128 v[116:119], v3 offset:304
    v_cvt_pk_bf16_f32 v91, v62, v63
    v_mfma_f32_16x16x32_bf16 v[24:27], v[104:107], a[16:19], v[24:27]
    v_exp_f32 v67, v67
    v_mfma_f32_16x16x32_bf16 v[24:27], v[108:111], a[20:23], v[24:27]
    v_exp_f32 v68, v68
    v_mfma_f32_16x16x32_bf16 v[32:35], v[104:107], a[48:51], v[32:35]
    v_exp_f32 v69, v69
    v_mfma_f32_16x16x32_bf16 v[32:35], v[108:111], a[52:55], v[32:35]
    v_exp_f32 v70, v70
    v_mfma_f32_16x16x32_bf16 v[40:43], v[104:107], a[80:83], v[40:43]
    v_exp_f32 v71, v71
    v_mfma_f32_16x16x32_bf16 v[40:43], v[108:111], a[84:87], v[40:43]
    v_exp_f32 v72, v72
    v_mfma_f32_16x16x32_bf16 v[48:51], v[104:107], a[112:115], v[48:51]
    ds_read_b128 v[104:107], v3 offset:512
    v_cvt_pk_bf16_f32 v92, v64, v65
    v_mfma_f32_16x16x32_bf16 v[48:51], v[108:111], a[116:119], v[48:51]
    s_waitcnt lgkmcnt(1)
    ds_read_b128 v[108:111], v3 offset:528
    v_cvt_pk_bf16_f32 v93, v66, v67
    v_mfma_f32_16x16x32_bf16 v[24:27], v[112:115], a[24:27], v[24:27]
    v_exp_f32 v73, v73
    v_mfma_f32_16x16x32_bf16 v[24:27], v[116:119], a[28:31], v[24:27]
    v_exp_f32 v74, v74
    v_mfma_f32_16x16x32_bf16 v[32:35], v[112:115], a[56:59], v[32:35]
    v_exp_f32 v75, v75
    v_mfma_f32_16x16x32_bf16 v[32:35], v[116:119], a[60:63], v[32:35]
    v_exp_f32 v76, v76
    v_mfma_f32_16x16x32_bf16 v[40:43], v[112:115], a[88:91], v[40:43]
    v_exp_f32 v77, v77
    v_mfma_f32_16x16x32_bf16 v[40:43], v[116:119], a[92:95], v[40:43]
    v_exp_f32 v78, v78
    v_mfma_f32_16x16x32_bf16 v[48:51], v[112:115], a[120:123], v[48:51]
    ds_read_b128 v[112:115], v3 offset:544
    v_cvt_pk_bf16_f32 v94, v68, v69
    v_mfma_f32_16x16x32_bf16 v[48:51], v[116:119], a[124:127], v[48:51]
    s_waitcnt lgkmcnt(1)
    ds_read_b128 v[116:119], v3 offset:560
    v_cvt_pk_bf16_f32 v95, v70, v71
    v_mfma_f32_16x16x32_bf16 v[28:31], v[104:107], a[0:3], 0
    v_exp_f32 v79, v79
    v_mfma_f32_16x16x32_bf16 v[28:31], v[108:111], a[4:7], v[28:31]
    v_exp_f32 v80, v80
    v_mfma_f32_16x16x32_bf16 v[36:39], v[104:107], a[32:35], 0
    v_exp_f32 v81, v81
    v_mfma_f32_16x16x32_bf16 v[36:39], v[108:111], a[36:39], v[36:39]
    v_exp_f32 v82, v82
    v_mfma_f32_16x16x32_bf16 v[44:47], v[104:107], a[64:67], 0
    v_exp_f32 v83, v83
    v_mfma_f32_16x16x32_bf16 v[44:47], v[108:111], a[68:71], v[44:47]
    v_exp_f32 v84, v84
    v_mfma_f32_16x16x32_bf16 v[52:55], v[104:107], a[96:99], 0
    ds_read_b128 v[104:107], v3 offset:768
    v_cvt_pk_bf16_f32 v96, v72, v73
    v_mfma_f32_16x16x32_bf16 v[52:55], v[108:111], a[100:103], v[52:55]
    s_waitcnt lgkmcnt(1)
    ds_read_b128 v[108:111], v3 offset:784
    v_cvt_pk_bf16_f32 v97, v74, v75
    v_mfma_f32_16x16x32_bf16 v[28:31], v[112:115], a[8:11], v[28:31]
    v_exp_f32 v85, v85
    v_mfma_f32_16x16x32_bf16 v[28:31], v[116:119], a[12:15], v[28:31]
    v_exp_f32 v86, v86
    v_mfma_f32_16x16x32_bf16 v[36:39], v[112:115], a[40:43], v[36:39]
    v_exp_f32 v87, v87
    v_mfma_f32_16x16x32_bf16 v[36:39], v[116:119], a[44:47], v[36:39]
    v_cvt_pk_bf16_f32 v98, v76, v77
    v_cvt_pk_bf16_f32 v99, v78, v79
    v_mfma_f32_16x16x32_bf16 v[44:47], v[112:115], a[72:75], v[44:47]
    v_cvt_pk_bf16_f32 v100, v80, v81
    v_cvt_pk_bf16_f32 v101, v82, v83
    v_mfma_f32_16x16x32_bf16 v[44:47], v[116:119], a[76:79], v[44:47]
    v_cvt_pk_bf16_f32 v102, v84, v85
    v_cvt_pk_bf16_f32 v103, v86, v87
    v_mfma_f32_16x16x32_bf16 v[52:55], v[112:115], a[104:107], v[52:55]
    ds_read_b128 v[112:115], v3 offset:800
    v_add_f32 v16, v16, v57
    v_mfma_f32_16x16x32_bf16 v[52:55], v[116:119], a[108:111], v[52:55]
    s_waitcnt lgkmcnt(1)
    ds_read_b128 v[116:119], v3 offset:816
    v_add_f32 v16, v16, v58
    v_mfma_f32_16x16x32_bf16 v[28:31], v[104:107], a[16:19], v[28:31]
    v_add_f32 v16, v16, v59
    v_add_f32 v16, v16, v60
    v_mfma_f32_16x16x32_bf16 v[28:31], v[108:111], a[20:23], v[28:31]
    v_add_u32 v3, s28, v1
    v_add_f32 v16, v16, v61
    v_mfma_f32_16x16x32_bf16 v[36:39], v[104:107], a[48:51], v[36:39]
    s_add_u32 s28, s28, s38
    v_add_f32 v16, v16, v62
    v_add_f32 v16, v16, v63
    v_mfma_f32_16x16x32_bf16 v[36:39], v[108:111], a[52:55], v[36:39]
    s_sub_u32 s48, s28, s39
    v_add_f32 v17, v17, v64
    v_add_f32 v17, v17, v65
    v_mfma_f32_16x16x32_bf16 v[44:47], v[104:107], a[80:83], v[44:47]
    s_min_u32 s28, s28, s48
    v_add_f32 v17, v17, v66
    v_add_f32 v17, v17, v67
    v_mfma_f32_16x16x32_bf16 v[44:47], v[108:111], a[84:87], v[44:47]
    v_add_f32 v17, v17, v68
    v_add_f32 v17, v17, v69
    v_mfma_f32_16x16x32_bf16 v[52:55], v[104:107], a[112:115], v[52:55]
    ds_read_b64_tr_b16 v[104:105], v4 offset:0
    v_add_f32 v17, v17, v70
    v_mfma_f32_16x16x32_bf16 v[52:55], v[108:111], a[116:119], v[52:55]
    s_waitcnt lgkmcnt(1)
    ds_read_b64_tr_b16 v[106:107], v4 offset:512
    ds_read_b64_tr_b16 v[108:109], v4 offset:32
    v_mfma_f32_16x16x32_bf16 v[28:31], v[112:115], a[24:27], v[28:31]
    ds_read_b64_tr_b16 v[110:111], v4 offset:544
    v_add_f32 v17, v17, v71
    v_mfma_f32_16x16x32_bf16 v[28:31], v[116:119], a[28:31], v[28:31]
    v_add_f32 v18, v18, v72
    v_add_f32 v18, v18, v73
    v_mfma_f32_16x16x32_bf16 v[36:39], v[112:115], a[56:59], v[36:39]
    v_add_f32 v18, v18, v74
    v_add_f32 v18, v18, v75
    v_mfma_f32_16x16x32_bf16 v[36:39], v[116:119], a[60:63], v[36:39]
    v_add_f32 v18, v18, v76
    v_add_f32 v18, v18, v77
    v_mfma_f32_16x16x32_bf16 v[44:47], v[112:115], a[88:91], v[44:47]
    v_add_f32 v18, v18, v78
    v_add_f32 v18, v18, v79
    v_mfma_f32_16x16x32_bf16 v[44:47], v[116:119], a[92:95], v[44:47]
    v_add_f32 v19, v19, v80
    v_add_f32 v19, v19, v81
    v_mfma_f32_16x16x32_bf16 v[52:55], v[112:115], a[120:123], v[52:55]
    ds_read_b64_tr_b16 v[112:113], v4 offset:64
    v_add_f32 v19, v19, v82
    v_mfma_f32_16x16x32_bf16 v[52:55], v[116:119], a[124:127], v[52:55]
    s_waitcnt lgkmcnt(3)
    ds_read_b64_tr_b16 v[114:115], v4 offset:576
    ds_read_b64_tr_b16 v[116:117], v4 offset:96
    v_mfma_f32_16x16x32_bf16 v[128:131], v[104:107], v[88:91], v[128:131]
    ds_read_b64_tr_b16 v[118:119], v4 offset:608
    v_fma_f32 v24, v24, s21, v12
    v_mfma_f32_16x16x32_bf16 v[132:135], v[104:107], v[92:95], v[132:135]
    v_add_f32 v19, v19, v83
    v_fma_f32 v25, v25, s21, v12
    v_mfma_f32_16x16x32_bf16 v[136:139], v[104:107], v[96:99], v[136:139]
    v_fma_f32 v26, v26, s21, v12
    v_mfma_f32_16x16x32_bf16 v[140:143], v[104:107], v[100:103], v[140:143]
    s_waitcnt lgkmcnt(4)
    ds_read_b64_tr_b16 v[104:105], v4 offset:128
    v_max3_f32 v20, v24, v25, v26
    v_mfma_f32_16x16x32_bf16 v[144:147], v[108:111], v[88:91], v[144:147]
    s_waitcnt vmcnt(16)
    ds_read_b64_tr_b16 v[106:107], v4 offset:640
    v_mfma_f32_16x16x32_bf16 v[148:151], v[108:111], v[92:95], v[148:151]
    v_fma_f32 v27, v27, s21, v12
    v_fma_f32 v32, v32, s21, v13
    v_mfma_f32_16x16x32_bf16 v[152:155], v[108:111], v[96:99], v[152:155]
    s_barrier
    v_max3_f32 v20, v20, v27, v32
    v_mfma_f32_16x16x32_bf16 v[156:159], v[108:111], v[100:103], v[156:159]
    s_waitcnt lgkmcnt(4)
    ds_read_b64_tr_b16 v[108:109], v4 offset:160
    v_fma_f32 v33, v33, s21, v13
    v_mfma_f32_16x16x32_bf16 v[160:163], v[112:115], v[88:91], v[160:163]
    s_add_u32 m0, s29, s30
    ds_read_b64_tr_b16 v[110:111], v4 offset:672
    v_fma_f32 v34, v34, s21, v13
    v_mfma_f32_16x16x32_bf16 v[164:167], v[112:115], v[92:95], v[164:167]
    s_add_u32 s29, s29, s38
    buffer_load_dwordx4 v5, s[4:7], s23 offen offset:0 nt lds
    v_mfma_f32_16x16x32_bf16 v[168:171], v[112:115], v[96:99], v[168:171]
    s_sub_u32 s31, s29, s39
    v_max3_f32 v20, v20, v33, v34
    v_mfma_f32_16x16x32_bf16 v[172:175], v[112:115], v[100:103], v[172:175]
    s_waitcnt lgkmcnt(4)
    ds_read_b64_tr_b16 v[112:113], v4 offset:192
    v_fma_f32 v35, v35, s21, v13
    v_mfma_f32_16x16x32_bf16 v[176:179], v[116:119], v[88:91], v[176:179]
    s_min_u32 s29, s29, s31
    ds_read_b64_tr_b16 v[114:115], v4 offset:704
    v_add_f32 v19, v19, v84
    v_mfma_f32_16x16x32_bf16 v[180:183], v[116:119], v[92:95], v[180:183]
    v_fma_f32 v40, v40, s21, v14
    v_mfma_f32_16x16x32_bf16 v[184:187], v[116:119], v[96:99], v[184:187]
    buffer_load_dwordx4 v6, s[4:7], s23 offen offset:1040 nt lds
    v_mfma_f32_16x16x32_bf16 v[188:191], v[116:119], v[100:103], v[188:191]
    s_waitcnt lgkmcnt(4)
    ds_read_b64_tr_b16 v[116:117], v4 offset:224
    v_max3_f32 v20, v20, v35, v40
    v_mfma_f32_16x16x32_bf16 v[192:195], v[104:107], v[88:91], v[192:195]
    ds_read_b64_tr_b16 v[118:119], v4 offset:736
    v_mfma_f32_16x16x32_bf16 v[196:199], v[104:107], v[92:95], v[196:199]
    v_fma_f32 v41, v41, s21, v14
    v_fma_f32 v42, v42, s21, v14
    v_mfma_f32_16x16x32_bf16 v[200:203], v[104:107], v[96:99], v[200:203]
    v_max3_f32 v20, v20, v41, v42
    v_mfma_f32_16x16x32_bf16 v[204:207], v[104:107], v[100:103], v[204:207]
    s_waitcnt lgkmcnt(4)
    ds_read_b64_tr_b16 v[104:105], v4 offset:256
    v_fma_f32 v43, v43, s21, v14
    v_mfma_f32_16x16x32_bf16 v[208:211], v[108:111], v[88:91], v[208:211]
    ds_read_b64_tr_b16 v[106:107], v4 offset:768
    v_fma_f32 v48, v48, s21, v15
    v_mfma_f32_16x16x32_bf16 v[212:215], v[108:111], v[92:95], v[212:215]
    buffer_load_dwordx4 v7, s[4:7], s23 offen offset:2080 nt lds
    v_mfma_f32_16x16x32_bf16 v[216:219], v[108:111], v[96:99], v[216:219]
    v_max3_f32 v20, v20, v43, v48
    v_mfma_f32_16x16x32_bf16 v[220:223], v[108:111], v[100:103], v[220:223]
    s_waitcnt lgkmcnt(4)
    ds_read_b64_tr_b16 v[108:109], v4 offset:288
    v_fma_f32 v49, v49, s21, v15
    v_mfma_f32_16x16x32_bf16 v[224:227], v[112:115], v[88:91], v[224:227]
    ds_read_b64_tr_b16 v[110:111], v4 offset:800
    v_mfma_f32_16x16x32_bf16 v[228:231], v[112:115], v[92:95], v[228:231]
    v_fma_f32 v50, v50, s21, v15
    v_add_f32 v19, v19, v85
    v_mfma_f32_16x16x32_bf16 v[232:235], v[112:115], v[96:99], v[232:235]
    buffer_load_dwordx4 v8, s[4:7], s23 offen offset:3120 nt lds
    v_mfma_f32_16x16x32_bf16 v[236:239], v[112:115], v[100:103], v[236:239]
    s_waitcnt lgkmcnt(4)
    ds_read_b64_tr_b16 v[112:113], v4 offset:320
    v_max3_f32 v20, v20, v49, v50
    v_mfma_f32_16x16x32_bf16 v[240:243], v[116:119], v[88:91], v[240:243]
    s_add_u32 s23, s23, 0x4000
    ds_read_b64_tr_b16 v[114:115], v4 offset:832
    v_mfma_f32_16x16x32_bf16 v[244:247], v[116:119], v[92:95], v[244:247]
    s_add_u32 m0, s29, s30
    v_fma_f32 v51, v51, s21, v15
    v_fma_f32 v28, v28, s21, v12
    v_mfma_f32_16x16x32_bf16 v[248:251], v[116:119], v[96:99], v[248:251]
    s_add_u32 s29, s29, s38
    buffer_load_dwordx4 v5, s[4:7], s23 offen offset:0 nt lds
    v_mfma_f32_16x16x32_bf16 v[252:255], v[116:119], v[100:103], v[252:255]
    s_waitcnt lgkmcnt(4)
    ds_read_b64_tr_b16 v[116:117], v4 offset:352
    v_mfma_f32_16x16x32_bf16 a[128:131], v[104:107], v[88:91], a[128:131]
    s_sub_u32 s31, s29, s39
    ds_read_b64_tr_b16 v[118:119], v4 offset:864
    v_max3_f32 v20, v20, v51, v28
    v_mfma_f32_16x16x32_bf16 a[132:135], v[104:107], v[92:95], a[132:135]
    s_min_u32 s29, s29, s31
    v_fma_f32 v29, v29, s21, v12
    v_mfma_f32_16x16x32_bf16 a[136:139], v[104:107], v[96:99], a[136:139]
    v_fma_f32 v30, v30, s21, v12
    v_max3_f32 v20, v20, v29, v30
    v_mfma_f32_16x16x32_bf16 a[140:143], v[104:107], v[100:103], a[140:143]
    s_waitcnt lgkmcnt(4)
    ds_read_b64_tr_b16 v[104:105], v4 offset:384
    v_fma_f32 v31, v31, s21, v12
    v_mfma_f32_16x16x32_bf16 a[144:147], v[108:111], v[88:91], a[144:147]
    ds_read_b64_tr_b16 v[106:107], v4 offset:896
    v_mfma_f32_16x16x32_bf16 a[148:151], v[108:111], v[92:95], a[148:151]
    buffer_load_dwordx4 v6, s[4:7], s23 offen offset:1040 nt lds
    v_mfma_f32_16x16x32_bf16 a[152:155], v[108:111], v[96:99], a[152:155]
    v_fma_f32 v36, v36, s21, v13
    v_add_f32 v19, v19, v86
    v_mfma_f32_16x16x32_bf16 a[156:159], v[108:111], v[100:103], a[156:159]
    s_waitcnt lgkmcnt(4)
    ds_read_b64_tr_b16 v[108:109], v4 offset:416
    v_mfma_f32_16x16x32_bf16 a[160:163], v[112:115], v[88:91], a[160:163]
    ds_read_b64_tr_b16 v[110:111], v4 offset:928
    v_max3_f32 v20, v20, v31, v36
    v_mfma_f32_16x16x32_bf16 a[164:167], v[112:115], v[92:95], a[164:167]
    v_fma_f32 v37, v37, s21, v13
    v_fma_f32 v38, v38, s21, v13
    v_mfma_f32_16x16x32_bf16 a[168:171], v[112:115], v[96:99], a[168:171]
    buffer_load_dwordx4 v7, s[4:7], s23 offen offset:2080 nt lds
    v_mfma_f32_16x16x32_bf16 a[172:175], v[112:115], v[100:103], a[172:175]
    s_waitcnt lgkmcnt(4)
    ds_read_b64_tr_b16 v[112:113], v4 offset:448
    v_mfma_f32_16x16x32_bf16 a[176:179], v[116:119], v[88:91], a[176:179]
    ds_read_b64_tr_b16 v[114:115], v4 offset:960
    v_max3_f32 v20, v20, v37, v38
    v_mfma_f32_16x16x32_bf16 a[180:183], v[116:119], v[92:95], a[180:183]
    v_fma_f32 v39, v39, s21, v13
    v_mfma_f32_16x16x32_bf16 a[184:187], v[116:119], v[96:99], a[184:187]
    v_fma_f32 v44, v44, s21, v14
    v_max3_f32 v20, v20, v39, v44
    v_mfma_f32_16x16x32_bf16 a[188:191], v[116:119], v[100:103], a[188:191]
    s_waitcnt lgkmcnt(4)
    ds_read_b64_tr_b16 v[116:117], v4 offset:480
    v_mfma_f32_16x16x32_bf16 a[192:195], v[104:107], v[88:91], a[192:195]
    ds_read_b64_tr_b16 v[118:119], v4 offset:992
    v_fma_f32 v45, v45, s21, v14
    v_mfma_f32_16x16x32_bf16 a[196:199], v[104:107], v[92:95], a[196:199]
    buffer_load_dwordx4 v8, s[4:7], s23 offen offset:3120 nt lds
    v_mfma_f32_16x16x32_bf16 a[200:203], v[104:107], v[96:99], a[200:203]
    s_add_u32 s23, s23, 0x4000
    v_fma_f32 v46, v46, s21, v14
    v_max3_f32 v20, v20, v45, v46
    v_mfma_f32_16x16x32_bf16 a[204:207], v[104:107], v[100:103], a[204:207]
    s_waitcnt lgkmcnt(4)
    ds_read_b128 v[104:107], v3 offset:0
    v_mfma_f32_16x16x32_bf16 a[208:211], v[108:111], v[88:91], a[208:211]
    v_add_f32 v19, v19, v87
    v_fma_f32 v47, v47, s21, v14
    v_mfma_f32_16x16x32_bf16 a[212:215], v[108:111], v[92:95], a[212:215]
    v_fma_f32 v52, v52, s21, v15
    v_mfma_f32_16x16x32_bf16 a[216:219], v[108:111], v[96:99], a[216:219]
    v_max3_f32 v20, v20, v47, v52
    v_fma_f32 v53, v53, s21, v15
    v_mfma_f32_16x16x32_bf16 a[220:223], v[108:111], v[100:103], a[220:223]
    s_waitcnt lgkmcnt(3)
    ds_read_b128 v[108:111], v3 offset:16
    v_mfma_f32_16x16x32_bf16 a[224:227], v[112:115], v[88:91], a[224:227]
    v_fma_f32 v54, v54, s21, v15
    v_max3_f32 v20, v20, v53, v54
    v_mfma_f32_16x16x32_bf16 a[228:231], v[112:115], v[92:95], a[228:231]
    v_fma_f32 v55, v55, s21, v15
    v_mfma_f32_16x16x32_bf16 a[232:235], v[112:115], v[96:99], a[232:235]
    v_max3_f32 v20, v20, v55, v55
    v_mfma_f32_16x16x32_bf16 a[236:239], v[112:115], v[100:103], a[236:239]
    s_waitcnt lgkmcnt(2)
    ds_read_b128 v[112:115], v3 offset:32
    v_mfma_f32_16x16x32_bf16 a[240:243], v[116:119], v[88:91], a[240:243]
    v_mfma_f32_16x16x32_bf16 a[244:247], v[116:119], v[92:95], a[244:247]
    v_cmp_lt_f32 vcc, s35, v20
    v_mfma_f32_16x16x32_bf16 a[248:251], v[116:119], v[96:99], a[248:251]
    v_mfma_f32_16x16x32_bf16 a[252:255], v[116:119], v[100:103], a[252:255]
    s_waitcnt lgkmcnt(1)
    ds_read_b128 v[116:119], v3 offset:48
    s_cbranch_vccnz L_rare_s11
L_cont_s11:
    s_add_u32 s24, s24, 33292288
    v_mfma_f32_16x16x32_bf16 v[56:59], v[104:107], a[0:3], 0
    v_exp_f32 v24, v24
    v_mfma_f32_16x16x32_bf16 v[56:59], v[108:111], a[4:7], v[56:59]
    v_add_u32 v4, s28, v2
    v_add_f32 v16, v16, v24
    v_mfma_f32_16x16x32_bf16 v[64:67], v[104:107], a[32:35], 0
    s_add_u32 s28, s28, s38
    v_exp_f32 v25, v25
    v_mfma_f32_16x16x32_bf16 v[64:67], v[108:111], a[36:39], v[64:67]
    s_sub_u32 s48, s28, s39
    v_exp_f32 v26, v26
    v_mfma_f32_16x16x32_bf16 v[72:75], v[104:107], a[64:67], 0
    s_min_u32 s28, s28, s48
    v_exp_f32 v27, v27
    v_mfma_f32_16x16x32_bf16 v[72:75], v[108:111], a[68:71], v[72:75]
    v_exp_f32 v28, v28
    v_mfma_f32_16x16x32_bf16 v[80:83], v[104:107], a[96:99], 0
    ds_read_b128 v[104:107], v3 offset:256
    v_cvt_pk_bf16_f32 v88, v24, v25
    v_mfma_f32_16x16x32_bf16 v[80:83], v[108:111], a[100:103], v[80:83]
    s_waitcnt lgkmcnt(1)
    ds_read_b128 v[108:111], v3 offset:272
    v_cvt_pk_bf16_f32 v89, v26, v27
    v_mfma_f32_16x16x32_bf16 v[56:59], v[112:115], a[8:11], v[56:59]
    v_exp_f32 v29, v29
    v_mfma_f32_16x16x32_bf16 v[56:59], v[116:119], a[12:15], v[56:59]
    v_exp_f32 v30, v30
    v_mfma_f32_16x16x32_bf16 v[64:67], v[112:115], a[40:43], v[64:67]
    v_exp_f32 v31, v31
    v_mfma_f32_16x16x32_bf16 v[64:67], v[116:119], a[44:47], v[64:67]
    v_exp_f32 v32, v32
    v_mfma_f32_16x16x32_bf16 v[72:75], v[112:115], a[72:75], v[72:75]
    v_exp_f32 v33, v33
    v_mfma_f32_16x16x32_bf16 v[72:75], v[116:119], a[76:79], v[72:75]
    v_exp_f32 v34, v34
    v_mfma_f32_16x16x32_bf16 v[80:83], v[112:115], a[104:107], v[80:83]
    ds_read_b128 v[112:115], v3 offset:288
    v_cvt_pk_bf16_f32 v90, v28, v29
    v_mfma_f32_16x16x32_bf16 v[80:83], v[116:119], a[108:111], v[80:83]
    s_waitcnt lgkmcnt(1)
    ds_read_b128 v[116:119], v3 offset:304
    v_cvt_pk_bf16_f32 v91, v30, v31
    v_mfma_f32_16x16x32_bf16 v[56:59], v[104:107], a[16:19], v[56:59]
    v_exp_f32 v35, v35
    v_mfma_f32_16x16x32_bf16 v[56:59], v[108:111], a[20:23], v[56:59]
    v_exp_f32 v36, v36
    v_mfma_f32_16x16x32_bf16 v[64:67], v[104:107], a[48:51], v[64:67]
    v_exp_f32 v37, v37
    v_mfma_f32_16x16x32_bf16 v[64:67], v[108:111], a[52:55], v[64:67]
    v_exp_f32 v38, v38
    v_mfma_f32_16x16x32_bf16 v[72:75], v[104:107], a[80:83], v[72:75]
    v_exp_f32 v39, v39
    v_mfma_f32_16x16x32_bf16 v[72:75], v[108:111], a[84:87], v[72:75]
    v_exp_f32 v40, v40
    v_mfma_f32_16x16x32_bf16 v[80:83], v[104:107], a[112:115], v[80:83]
    ds_read_b128 v[104:107], v3 offset:512
    v_cvt_pk_bf16_f32 v92, v32, v33
    v_mfma_f32_16x16x32_bf16 v[80:83], v[108:111], a[116:119], v[80:83]
    s_waitcnt lgkmcnt(1)
    ds_read_b128 v[108:111], v3 offset:528
    v_cvt_pk_bf16_f32 v93, v34, v35
    v_mfma_f32_16x16x32_bf16 v[56:59], v[112:115], a[24:27], v[56:59]
    v_exp_f32 v41, v41
    v_mfma_f32_16x16x32_bf16 v[56:59], v[116:119], a[28:31], v[56:59]
    v_exp_f32 v42, v42
    v_mfma_f32_16x16x32_bf16 v[64:67], v[112:115], a[56:59], v[64:67]
    v_exp_f32 v43, v43
    v_mfma_f32_16x16x32_bf16 v[64:67], v[116:119], a[60:63], v[64:67]
    v_exp_f32 v44, v44
    v_mfma_f32_16x16x32_bf16 v[72:75], v[112:115], a[88:91], v[72:75]
    v_exp_f32 v45, v45
    v_mfma_f32_16x16x32_bf16 v[72:75], v[116:119], a[92:95], v[72:75]
    v_exp_f32 v46, v46
    v_mfma_f32_16x16x32_bf16 v[80:83], v[112:115], a[120:123], v[80:83]
    ds_read_b128 v[112:115], v3 offset:544
    v_cvt_pk_bf16_f32 v94, v36, v37
    v_mfma_f32_16x16x32_bf16 v[80:83], v[116:119], a[124:127], v[80:83]
    s_waitcnt lgkmcnt(1)
    ds_read_b128 v[116:119], v3 offset:560
    v_cvt_pk_bf16_f32 v95, v38, v39
    v_mfma_f32_16x16x32_bf16 v[60:63], v[104:107], a[0:3], 0
    v_exp_f32 v47, v47
    v_mfma_f32_16x16x32_bf16 v[60:63], v[108:111], a[4:7], v[60:63]
    v_exp_f32 v48, v48
    v_mfma_f32_16x16x32_bf16 v[68:71], v[104:107], a[32:35], 0
    v_exp_f32 v49, v49
    v_mfma_f32_16x16x32_bf16 v[68:71], v[108:111], a[36:39], v[68:71]
    v_exp_f32 v50, v50
    v_mfma_f32_16x16x32_bf16 v[76:79], v[104:107], a[64:67], 0
    v_exp_f32 v51, v51
    v_mfma_f32_16x16x32_bf16 v[76:79], v[108:111], a[68:71], v[76:79]
    v_exp_f32 v52, v52
    v_mfma_f32_16x16x32_bf16 v[84:87], v[104:107], a[96:99], 0
    ds_read_b128 v[104:107], v3 offset:768
    v_cvt_pk_bf16_f32 v96, v40, v41
    v_mfma_f32_16x16x32_bf16 v[84:87], v[108:111], a[100:103], v[84:87]
    s_waitcnt lgkmcnt(1)
    ds_read_b128 v[108:111], v3 offset:784
    v_cvt_pk_bf16_f32 v97, v42, v43
    v_mfma_f32_16x16x32_bf16 v[60:63], v[112:115], a[8:11], v[60:63]
    v_exp_f32 v53, v53
    v_mfma_f32_16x16x32_bf16 v[60:63], v[116:119], a[12:15], v[60:63]
    v_exp_f32 v54, v54
    v_mfma_f32_16x16x32_bf16 v[68:71], v[112:115], a[40:43], v[68:71]
    v_exp_f32 v55, v55
    v_mfma_f32_16x16x32_bf16 v[68:71], v[116:119], a[44:47], v[68:71]
    v_cvt_pk_bf16_f32 v98, v44, v45
    v_cvt_pk_bf16_f32 v99, v46, v47
    v_mfma_f32_16x16x32_bf16 v[76:79], v[112:115], a[72:75], v[76:79]
    v_cvt_pk_bf16_f32 v100, v48, v49
    v_cvt_pk_bf16_f32 v101, v50, v51
    v_mfma_f32_16x16x32_bf16 v[76:79], v[116:119], a[76:79], v[76:79]
    v_cvt_pk_bf16_f32 v102, v52, v53
    v_cvt_pk_bf16_f32 v103, v54, v55
    v_mfma_f32_16x16x32_bf16 v[84:87], v[112:115], a[104:107], v[84:87]
    ds_read_b128 v[112:115], v3 offset:800
    v_add_f32 v16, v16, v25
    v_mfma_f32_16x16x32_bf16 v[84:87], v[116:119], a[108:111], v[84:87]
    s_waitcnt lgkmcnt(1)
    ds_read_b128 v[116:119], v3 offset:816
    v_add_f32 v16, v16, v26
    v_mfma_f32_16x16x32_bf16 v[60:63], v[104:107], a[16:19], v[60:63]
    v_add_f32 v16, v16, v27
    v_add_f32 v16, v16, v28
    v_mfma_f32_16x16x32_bf16 v[60:63], v[108:111], a[20:23], v[60:63]
    v_add_u32 v3, s28, v1
    v_add_f32 v16, v16, v29
    v_mfma_f32_16x16x32_bf16 v[68:71], v[104:107], a[48:51], v[68:71]
    s_add_u32 s28, s28, s38
    v_add_f32 v16, v16, v30
    v_add_f32 v16, v16, v31
    v_mfma_f32_16x16x32_bf16 v[68:71], v[108:111], a[52:55], v[68:71]
    s_sub_u32 s48, s28, s39
    v_add_f32 v17, v17, v32
    v_add_f32 v17, v17, v33
    v_mfma_f32_16x16x32_bf16 v[76:79], v[104:107], a[80:83], v[76:79]
    s_min_u32 s28, s28, s48
    v_add_f32 v17, v17, v34
    v_add_f32 v17, v17, v35
    v_mfma_f32_16x16x32_bf16 v[76:79], v[108:111], a[84:87], v[76:79]
    v_add_f32 v17, v17, v36
    v_add_f32 v17, v17, v37
    v_mfma_f32_16x16x32_bf16 v[84:87], v[104:107], a[112:115], v[84:87]
    ds_read_b64_tr_b16 v[104:105], v4 offset:0
    v_add_f32 v17, v17, v38
    v_mfma_f32_16x16x32_bf16 v[84:87], v[108:111], a[116:119], v[84:87]
    s_waitcnt lgkmcnt(1)
    ds_read_b64_tr_b16 v[106:107], v4 offset:512
    ds_read_b64_tr_b16 v[108:109], v4 offset:32
    v_mfma_f32_16x16x32_bf16 v[60:63], v[112:115], a[24:27], v[60:63]
    ds_read_b64_tr_b16 v[110:111], v4 offset:544
    v_add_f32 v17, v17, v39
    v_mfma_f32_16x16x32_bf16 v[60:63], v[116:119], a[28:31], v[60:63]
    v_add_f32 v18, v18, v40
    v_add_f32 v18, v18, v41
    v_mfma_f32_16x16x32_bf16 v[68:71], v[112:115], a[56:59], v[68:71]
    v_add_f32 v18, v18, v42
    v_add_f32 v18, v18, v43
    v_mfma_f32_16x16x32_bf16 v[68:71], v[116:119], a[60:63], v[68:71]
    v_add_f32 v18, v18, v44
    v_add_f32 v18, v18, v45
    v_mfma_f32_16x16x32_bf16 v[76:79], v[112:115], a[88:91], v[76:79]
    v_add_f32 v18, v18, v46
    v_add_f32 v18, v18, v47
    v_mfma_f32_16x16x32_bf16 v[76:79], v[116:119], a[92:95], v[76:79]
    v_add_f32 v19, v19, v48
    v_add_f32 v19, v19, v49
    v_mfma_f32_16x16x32_bf16 v[84:87], v[112:115], a[120:123], v[84:87]
    ds_read_b64_tr_b16 v[112:113], v4 offset:64
    v_add_f32 v19, v19, v50
    v_mfma_f32_16x16x32_bf16 v[84:87], v[116:119], a[124:127], v[84:87]
    s_waitcnt lgkmcnt(3)
    ds_read_b64_tr_b16 v[114:115], v4 offset:576
    ds_read_b64_tr_b16 v[116:117], v4 offset:96
    v_mfma_f32_16x16x32_bf16 v[128:131], v[104:107], v[88:91], v[128:131]
    ds_read_b64_tr_b16 v[118:119], v4 offset:608
    v_fma_f32 v56, v56, s21, v12
    v_mfma_f32_16x16x32_bf16 v[132:135], v[104:107], v[92:95], v[132:135]
    v_add_f32 v19, v19, v51
    v_fma_f32 v57, v57, s21, v12
    v_mfma_f32_16x16x32_bf16 v[136:139], v[104:107], v[96:99], v[136:139]
    v_fma_f32 v58, v58, s21, v12
    v_mfma_f32_16x16x32_bf16 v[140:143], v[104:107], v[100:103], v[140:143]
    s_waitcnt lgkmcnt(4)
    ds_read_b64_tr_b16 v[104:105], v4 offset:128
    v_max3_f32 v20, v56, v57, v58
    v_mfma_f32_16x16x32_bf16 v[144:147], v[108:111], v[88:91], v[144:147]
    s_waitcnt vmcnt(16)
    ds_read_b64_tr_b16 v[106:107], v4 offset:640
    v_mfma_f32_16x16x32_bf16 v[148:151], v[108:111], v[92:95], v[148:151]
    v_fma_f32 v59, v59, s21, v12
    v_fma_f32 v64, v64, s21, v13
    v_mfma_f32_16x16x32_bf16 v[152:155], v[108:111], v[96:99], v[152:155]
    s_barrier
    v_max3_f32 v20, v20, v59, v64
    v_mfma_f32_16x16x32_bf16 v[156:159], v[108:111], v[100:103], v[156:159]
    s_waitcnt lgkmcnt(4)
    ds_read_b64_tr_b16 v[108:109], v4 offset:160
    v_fma_f32 v65, v65, s21, v13
    v_mfma_f32_16x16x32_bf16 v[160:163], v[112:115], v[88:91], v[160:163]
    s_add_u32 m0, s29, s30
    ds_read_b64_tr_b16 v[110:111], v4 offset:672
    v_fma_f32 v66, v66, s21, v13
    v_mfma_f32_16x16x32_bf16 v[164:167], v[112:115], v[92:95], v[164:167]
    s_add_u32 s29, s29, s38
    buffer_load_dwordx4 v5, s[4:7], s23 offen offset:0 nt lds
    v_mfma_f32_16x16x32_bf16 v[168:171], v[112:115], v[96:99], v[168:171]
    s_sub_u32 s31, s29, s39
    v_max3_f32 v20, v20, v65, v66
    v_mfma_f32_16x16x32_bf16 v[172:175], v[112:115], v[100:103], v[172:175]
    s_waitcnt lgkmcnt(4)
    ds_read_b64_tr_b16 v[112:113], v4 offset:192
    v_fma_f32 v67, v67, s21, v13
    v_mfma_f32_16x16x32_bf16 v[176:179], v[116:119], v[88:91], v[176:179]
    s_min_u32 s29, s29, s31
    ds_read_b64_tr_b16 v[114:115], v4 offset:704
    v_add_f32 v19, v19, v52
    v_mfma_f32_16x16x32_bf16 v[180:183], v[116:119], v[92:95], v[180:183]
    v_fma_f32 v72, v72, s21, v14
    v_mfma_f32_16x16x32_bf16 v[184:187], v[116:119], v[96:99], v[184:187]
    buffer_load_dwordx4 v6, s[4:7], s23 offen offset:1040 nt lds
    v_mfma_f32_16x16x32_bf16 v[188:191], v[116:119], v[100:103], v[188:191]
    s_waitcnt lgkmcnt(4)
    ds_read_b64_tr_b16 v[116:117], v4 offset:224
    v_max3_f32 v20, v20, v67, v72
    v_mfma_f32_16x16x32_bf16 v[192:195], v[104:107], v[88:91], v[192:195]
    ds_read_b64_tr_b16 v[118:119], v4 offset:736
    v_mfma_f32_16x16x32_bf16 v[196:199], v[104:107], v[92:95], v[196:199]
    v_fma_f32 v73, v73, s21, v14
    v_fma_f32 v74, v74, s21, v14
    v_mfma_f32_16x16x32_bf16 v[200:203], v[104:107], v[96:99], v[200:203]
    v_max3_f32 v20, v20, v73, v74
    v_mfma_f32_16x16x32_bf16 v[204:207], v[104:107], v[100:103], v[204:207]
    s_waitcnt lgkmcnt(4)
    ds_read_b64_tr_b16 v[104:105], v4 offset:256
    v_fma_f32 v75, v75, s21, v14
    v_mfma_f32_16x16x32_bf16 v[208:211], v[108:111], v[88:91], v[208:211]
    ds_read_b64_tr_b16 v[106:107], v4 offset:768
    v_fma_f32 v80, v80, s21, v15
    v_mfma_f32_16x16x32_bf16 v[212:215], v[108:111], v[92:95], v[212:215]
    buffer_load_dwordx4 v7, s[4:7], s23 offen offset:2080 nt lds
    v_mfma_f32_16x16x32_bf16 v[216:219], v[108:111], v[96:99], v[216:219]
    v_max3_f32 v20, v20, v75, v80
    v_mfma_f32_16x16x32_bf16 v[220:223], v[108:111], v[100:103], v[220:223]
    s_waitcnt lgkmcnt(4)
    ds_read_b64_tr_b16 v[108:109], v4 offset:288
    v_fma_f32 v81, v81, s21, v15
    v_mfma_f32_16x16x32_bf16 v[224:227], v[112:115], v[88:91], v[224:227]
    ds_read_b64_tr_b16 v[110:111], v4 offset:800
    v_mfma_f32_16x16x32_bf16 v[228:231], v[112:115], v[92:95], v[228:231]
    v_fma_f32 v82, v82, s21, v15
    v_add_f32 v19, v19, v53
    v_mfma_f32_16x16x32_bf16 v[232:235], v[112:115], v[96:99], v[232:235]
    buffer_load_dwordx4 v8, s[4:7], s23 offen offset:3120 nt lds
    v_mfma_f32_16x16x32_bf16 v[236:239], v[112:115], v[100:103], v[236:239]
    s_waitcnt lgkmcnt(4)
    ds_read_b64_tr_b16 v[112:113], v4 offset:320
    v_max3_f32 v20, v20, v81, v82
    v_mfma_f32_16x16x32_bf16 v[240:243], v[116:119], v[88:91], v[240:243]
    s_add_u32 s23, s23, 0x4000
    ds_read_b64_tr_b16 v[114:115], v4 offset:832
    v_mfma_f32_16x16x32_bf16 v[244:247], v[116:119], v[92:95], v[244:247]
    s_add_u32 m0, s29, s30
    v_fma_f32 v83, v83, s21, v15
    v_fma_f32 v60, v60, s21, v12
    v_mfma_f32_16x16x32_bf16 v[248:251], v[116:119], v[96:99], v[248:251]
    s_add_u32 s29, s29, s38
    buffer_load_dwordx4 v5, s[4:7], s23 offen offset:0 nt lds
    v_mfma_f32_16x16x32_bf16 v[252:255], v[116:119], v[100:103], v[252:255]
    s_waitcnt lgkmcnt(4)
    ds_read_b64_tr_b16 v[116:117], v4 offset:352
    v_mfma_f32_16x16x32_bf16 a[128:131], v[104:107], v[88:91], a[128:131]
    s_sub_u32 s31, s29, s39
    ds_read_b64_tr_b16 v[118:119], v4 offset:864
    v_max3_f32 v20, v20, v83, v60
    v_mfma_f32_16x16x32_bf16 a[132:135], v[104:107], v[92:95], a[132:135]
    s_min_u32 s29, s29, s31
    v_fma_f32 v61, v61, s21, v12
    v_mfma_f32_16x16x32_bf16 a[136:139], v[104:107], v[96:99], a[136:139]
    v_fma_f32 v62, v62, s21, v12
    v_max3_f32 v20, v20, v61, v62
    v_mfma_f32_16x16x32_bf16 a[140:143], v[104:107], v[100:103], a[140:143]
    s_waitcnt lgkmcnt(4)
    ds_read_b64_tr_b16 v[104:105], v4 offset:384
    v_fma_f32 v63, v63, s21, v12
    v_mfma_f32_16x16x32_bf16 a[144:147], v[108:111], v[88:91], a[144:147]
    ds_read_b64_tr_b16 v[106:107], v4 offset:896
    v_mfma_f32_16x16x32_bf16 a[148:151], v[108:111], v[92:95], a[148:151]
    buffer_load_dwordx4 v6, s[4:7], s23 offen offset:1040 nt lds
    v_mfma_f32_16x16x32_bf16 a[152:155], v[108:111], v[96:99], a[152:155]
    v_fma_f32 v68, v68, s21, v13
    v_add_f32 v19, v19, v54
    v_mfma_f32_16x16x32_bf16 a[156:159], v[108:111], v[100:103], a[156:159]
    s_waitcnt lgkmcnt(4)
    ds_read_b64_tr_b16 v[108:109], v4 offset:416
    v_mfma_f32_16x16x32_bf16 a[160:163], v[112:115], v[88:91], a[160:163]
    ds_read_b64_tr_b16 v[110:111], v4 offset:928
    v_max3_f32 v20, v20, v63, v68
    v_mfma_f32_16x16x32_bf16 a[164:167], v[112:115], v[92:95], a[164:167]
    v_fma_f32 v69, v69, s21, v13
    v_fma_f32 v70, v70, s21, v13
    v_mfma_f32_16x16x32_bf16 a[168:171], v[112:115], v[96:99], a[168:171]
    buffer_load_dwordx4 v7, s[4:7], s23 offen offset:2080 nt lds
    v_mfma_f32_16x16x32_bf16 a[172:175], v[112:115], v[100:103], a[172:175]
    s_waitcnt lgkmcnt(4)
    ds_read_b64_tr_b16 v[112:113], v4 offset:448
    v_mfma_f32_16x16x32_bf16 a[176:179], v[116:119], v[88:91], a[176:179]
    ds_read_b64_tr_b16 v[114:115], v4 offset:960
    v_max3_f32 v20, v20, v69, v70
    v_mfma_f32_16x16x32_bf16 a[180:183], v[116:119], v[92:95], a[180:183]
    v_fma_f32 v71, v71, s21, v13
    v_mfma_f32_16x16x32_bf16 a[184:187], v[116:119], v[96:99], a[184:187]
    v_fma_f32 v76, v76, s21, v14
    v_max3_f32 v20, v20, v71, v76
    v_mfma_f32_16x16x32_bf16 a[188:191], v[116:119], v[100:103], a[188:191]
    s_waitcnt lgkmcnt(4)
    ds_read_b64_tr_b16 v[116:117], v4 offset:480
    v_mfma_f32_16x16x32_bf16 a[192:195], v[104:107], v[88:91], a[192:195]
    ds_read_b64_tr_b16 v[118:119], v4 offset:992
    v_fma_f32 v77, v77, s21, v14
    v_mfma_f32_16x16x32_bf16 a[196:199], v[104:107], v[92:95], a[196:199]
    buffer_load_dwordx4 v8, s[4:7], s23 offen offset:3120 nt lds
    v_mfma_f32_16x16x32_bf16 a[200:203], v[104:107], v[96:99], a[200:203]
    s_add_u32 s23, s23, 0x4000
    v_fma_f32 v78, v78, s21, v14
    v_max3_f32 v20, v20, v77, v78
    v_mfma_f32_16x16x32_bf16 a[204:207], v[104:107], v[100:103], a[204:207]
    s_waitcnt lgkmcnt(4)
    ds_read_b128 v[104:107], v3 offset:0
    v_mfma_f32_16x16x32_bf16 a[208:211], v[108:111], v[88:91], a[208:211]
    v_add_f32 v19, v19, v55
    v_fma_f32 v79, v79, s21, v14
    v_mfma_f32_16x16x32_bf16 a[212:215], v[108:111], v[92:95], a[212:215]
    v_fma_f32 v84, v84, s21, v15
    v_mfma_f32_16x16x32_bf16 a[216:219], v[108:111], v[96:99], a[216:219]
    v_max3_f32 v20, v20, v79, v84
    v_fma_f32 v85, v85, s21, v15
    v_mfma_f32_16x16x32_bf16 a[220:223], v[108:111], v[100:103], a[220:223]
    s_waitcnt lgkmcnt(3)
    ds_read_b128 v[108:111], v3 offset:16
    v_mfma_f32_16x16x32_bf16 a[224:227], v[112:115], v[88:91], a[224:227]
    v_fma_f32 v86, v86, s21, v15
    v_max3_f32 v20, v20, v85, v86
    v_mfma_f32_16x16x32_bf16 a[228:231], v[112:115], v[92:95], a[228:231]
    v_fma_f32 v87, v87, s21, v15
    v_mfma_f32_16x16x32_bf16 a[232:235], v[112:115], v[96:99], a[232:235]
    v_max3_f32 v20, v20, v87, v87
    v_mfma_f32_16x16x32_bf16 a[236:239], v[112:115], v[100:103], a[236:239]
    s_waitcnt lgkmcnt(2)
    ds_read_b128 v[112:115], v3 offset:32
    v_mfma_f32_16x16x32_bf16 a[240:243], v[116:119], v[88:91], a[240:243]
    v_mfma_f32_16x16x32_bf16 a[244:247], v[116:119], v[92:95], a[244:247]
    v_cmp_lt_f32 vcc, s35, v20
    v_mfma_f32_16x16x32_bf16 a[248:251], v[116:119], v[96:99], a[248:251]
    v_mfma_f32_16x16x32_bf16 a[252:255], v[116:119], v[100:103], a[252:255]
    s_waitcnt lgkmcnt(1)
    ds_read_b128 v[116:119], v3 offset:48
    s_cbranch_vccnz L_rare_s12
L_cont_s12:
    v_mfma_f32_16x16x32_bf16 v[24:27], v[104:107], a[0:3], 0
    v_exp_f32 v56, v56
    v_mfma_f32_16x16x32_bf16 v[24:27], v[108:111], a[4:7], v[24:27]
    v_add_u32 v4, s28, v2
    v_add_f32 v16, v16, v56
    v_mfma_f32_16x16x32_bf16 v[32:35], v[104:107], a[32:35], 0
    s_add_u32 s28, s28, s38
    v_exp_f32 v57, v57
    v_mfma_f32_16x16x32_bf16 v[32:35], v[108:111], a[36:39], v[32:35]
    s_sub_u32 s48, s28, s39
    v_exp_f32 v58, v58
    v_mfma_f32_16x16x32_bf16 v[40:43], v[104:107], a[64:67], 0
    s_min_u32 s28, s28, s48
    v_exp_f32 v59, v59
    v_mfma_f32_16x16x32_bf16 v[40:43], v[108:111], a[68:71], v[40:43]
    v_exp_f32 v60, v60
    v_mfma_f32_16x16x32_bf16 v[48:51], v[104:107], a[96:99], 0
    ds_read_b128 v[104:107], v3 offset:256
    v_cvt_pk_bf16_f32 v88, v56, v57
    v_mfma_f32_16x16x32_bf16 v[48:51], v[108:111], a[100:103], v[48:51]
    s_waitcnt lgkmcnt(1)
    ds_read_b128 v[108:111], v3 offset:272
    v_cvt_pk_bf16_f32 v89, v58, v59
    v_mfma_f32_16x16x32_bf16 v[24:27], v[112:115], a[8:11], v[24:27]
    v_exp_f32 v61, v61
    v_mfma_f32_16x16x32_bf16 v[24:27], v[116:119], a[12:15], v[24:27]
    v_exp_f32 v62, v62
    v_mfma_f32_16x16x32_bf16 v[32:35], v[112:115], a[40:43], v[32:35]
    v_exp_f32 v63, v63
    v_mfma_f32_16x16x32_bf16 v[32:35], v[116:119], a[44:47], v[32:35]
    v_exp_f32 v64, v64
    v_mfma_f32_16x16x32_bf16 v[40:43], v[112:115], a[72:75], v[40:43]
    v_exp_f32 v65, v65
    v_mfma_f32_16x16x32_bf16 v[40:43], v[116:119], a[76:79], v[40:43]
    v_exp_f32 v66, v66
    v_mfma_f32_16x16x32_bf16 v[48:51], v[112:115], a[104:107], v[48:51]
    ds_read_b128 v[112:115], v3 offset:288
    v_cvt_pk_bf16_f32 v90, v60, v61
    v_mfma_f32_16x16x32_bf16 v[48:51], v[116:119], a[108:111], v[48:51]
    s_waitcnt lgkmcnt(1)
    ds_read_b128 v[116:119], v3 offset:304
    v_cvt_pk_bf16_f32 v91, v62, v63
    v_mfma_f32_16x16x32_bf16 v[24:27], v[104:107], a[16:19], v[24:27]
    v_exp_f32 v67, v67
    v_mfma_f32_16x16x32_bf16 v[24:27], v[108:111], a[20:23], v[24:27]
    v_exp_f32 v68, v68
    v_mfma_f32_16x16x32_bf16 v[32:35], v[104:107], a[48:51], v[32:35]
    v_exp_f32 v69, v69
    v_mfma_f32_16x16x32_bf16 v[32:35], v[108:111], a[52:55], v[32:35]
    v_exp_f32 v70, v70
    v_mfma_f32_16x16x32_bf16 v[40:43], v[104:107], a[80:83], v[40:43]
    v_exp_f32 v71, v71
    v_mfma_f32_16x16x32_bf16 v[40:43], v[108:111], a[84:87], v[40:43]
    v_exp_f32 v72, v72
    v_mfma_f32_16x16x32_bf16 v[48:51], v[104:107], a[112:115], v[48:51]
    ds_read_b128 v[104:107], v3 offset:512
    v_cvt_pk_bf16_f32 v92, v64, v65
    v_mfma_f32_16x16x32_bf16 v[48:51], v[108:111], a[116:119], v[48:51]
    s_waitcnt lgkmcnt(1)
    ds_read_b128 v[108:111], v3 offset:528
    v_cvt_pk_bf16_f32 v93, v66, v67
    v_mfma_f32_16x16x32_bf16 v[24:27], v[112:115], a[24:27], v[24:27]
    v_exp_f32 v73, v73
    v_mfma_f32_16x16x32_bf16 v[24:27], v[116:119], a[28:31], v[24:27]
    v_exp_f32 v74, v74
    v_mfma_f32_16x16x32_bf16 v[32:35], v[112:115], a[56:59], v[32:35]
    v_exp_f32 v75, v75
    v_mfma_f32_16x16x32_bf16 v[32:35], v[116:119], a[60:63], v[32:35]
    v_exp_f32 v76, v76
    v_mfma_f32_16x16x32_bf16 v[40:43], v[112:115], a[88:91], v[40:43]
    v_exp_f32 v77, v77
    v_mfma_f32_16x16x32_bf16 v[40:43], v[116:119], a[92:95], v[40:43]
    v_exp_f32 v78, v78
    v_mfma_f32_16x16x32_bf16 v[48:51], v[112:115], a[120:123], v[48:51]
    ds_read_b128 v[112:115], v3 offset:544
    v_cvt_pk_bf16_f32 v94, v68, v69
    v_mfma_f32_16x16x32_bf16 v[48:51], v[116:119], a[124:127], v[48:51]
    s_waitcnt lgkmcnt(1)
    ds_read_b128 v[116:119], v3 offset:560
    v_cvt_pk_bf16_f32 v95, v70, v71
    v_mfma_f32_16x16x32_bf16 v[28:31], v[104:107], a[0:3], 0
    v_exp_f32 v79, v79
    v_mfma_f32_16x16x32_bf16 v[28:31], v[108:111], a[4:7], v[28:31]
    v_exp_f32 v80, v80
    v_mfma_f32_16x16x32_bf16 v[36:39], v[104:107], a[32:35], 0
    v_exp_f32 v81, v81
    v_mfma_f32_16x16x32_bf16 v[36:39], v[108:111], a[36:39], v[36:39]
    v_exp_f32 v82, v82
    v_mfma_f32_16x16x32_bf16 v[44:47], v[104:107], a[64:67], 0
    v_exp_f32 v83, v83
    v_mfma_f32_16x16x32_bf16 v[44:47], v[108:111], a[68:71], v[44:47]
    v_exp_f32 v84, v84
    v_mfma_f32_16x16x32_bf16 v[52:55], v[104:107], a[96:99], 0
    ds_read_b128 v[104:107], v3 offset:768
    v_cvt_pk_bf16_f32 v96, v72, v73
    v_mfma_f32_16x16x32_bf16 v[52:55], v[108:111], a[100:103], v[52:55]
    s_waitcnt lgkmcnt(1)
    ds_read_b128 v[108:111], v3 offset:784
    v_cvt_pk_bf16_f32 v97, v74, v75
    v_mfma_f32_16x16x32_bf16 v[28:31], v[112:115], a[8:11], v[28:31]
    v_exp_f32 v85, v85
    v_mfma_f32_16x16x32_bf16 v[28:31], v[116:119], a[12:15], v[28:31]
    v_exp_f32 v86, v86
    v_mfma_f32_16x16x32_bf16 v[36:39], v[112:115], a[40:43], v[36:39]
    v_exp_f32 v87, v87
    v_mfma_f32_16x16x32_bf16 v[36:39], v[116:119], a[44:47], v[36:39]
    v_cvt_pk_bf16_f32 v98, v76, v77
    v_cvt_pk_bf16_f32 v99, v78, v79
    v_mfma_f32_16x16x32_bf16 v[44:47], v[112:115], a[72:75], v[44:47]
    v_cvt_pk_bf16_f32 v100, v80, v81
    v_cvt_pk_bf16_f32 v101, v82, v83
    v_mfma_f32_16x16x32_bf16 v[44:47], v[116:119], a[76:79], v[44:47]
    v_cvt_pk_bf16_f32 v102, v84, v85
    v_cvt_pk_bf16_f32 v103, v86, v87
    v_mfma_f32_16x16x32_bf16 v[52:55], v[112:115], a[104:107], v[52:55]
    ds_read_b128 v[112:115], v3 offset:800
    v_add_f32 v16, v16, v57
    v_mfma_f32_16x16x32_bf16 v[52:55], v[116:119], a[108:111], v[52:55]
    s_waitcnt lgkmcnt(1)
    ds_read_b128 v[116:119], v3 offset:816
    v_add_f32 v16, v16, v58
    v_mfma_f32_16x16x32_bf16 v[28:31], v[104:107], a[16:19], v[28:31]
    v_add_f32 v16, v16, v59
    v_add_f32 v16, v16, v60
    v_mfma_f32_16x16x32_bf16 v[28:31], v[108:111], a[20:23], v[28:31]
    v_add_u32 v3, s28, v1
    v_add_f32 v16, v16, v61
    v_mfma_f32_16x16x32_bf16 v[36:39], v[104:107], a[48:51], v[36:39]
    s_add_u32 s28, s28, s38
    v_add_f32 v16, v16, v62
    v_add_f32 v16, v16, v63
    v_mfma_f32_16x16x32_bf16 v[36:39], v[108:111], a[52:55], v[36:39]
    s_sub_u32 s48, s28, s39
    v_add_f32 v17, v17, v64
    v_add_f32 v17, v17, v65
    v_mfma_f32_16x16x32_bf16 v[44:47], v[104:107], a[80:83], v[44:47]
    s_min_u32 s28, s28, s48
    v_add_f32 v17, v17, v66
    v_add_f32 v17, v17, v67
    v_mfma_f32_16x16x32_bf16 v[44:47], v[108:111], a[84:87], v[44:47]
    v_add_f32 v17, v17, v68
    v_add_f32 v17, v17, v69
    v_mfma_f32_16x16x32_bf16 v[52:55], v[104:107], a[112:115], v[52:55]
    ds_read_b64_tr_b16 v[104:105], v4 offset:0
    v_add_f32 v17, v17, v70
    v_mfma_f32_16x16x32_bf16 v[52:55], v[108:111], a[116:119], v[52:55]
    s_waitcnt lgkmcnt(1)
    ds_read_b64_tr_b16 v[106:107], v4 offset:512
    ds_read_b64_tr_b16 v[108:109], v4 offset:32
    v_mfma_f32_16x16x32_bf16 v[28:31], v[112:115], a[24:27], v[28:31]
    ds_read_b64_tr_b16 v[110:111], v4 offset:544
    v_add_f32 v17, v17, v71
    v_mfma_f32_16x16x32_bf16 v[28:31], v[116:119], a[28:31], v[28:31]
    v_add_f32 v18, v18, v72
    v_add_f32 v18, v18, v73
    v_mfma_f32_16x16x32_bf16 v[36:39], v[112:115], a[56:59], v[36:39]
    v_add_f32 v18, v18, v74
    v_add_f32 v18, v18, v75
    v_mfma_f32_16x16x32_bf16 v[36:39], v[116:119], a[60:63], v[36:39]
    v_add_f32 v18, v18, v76
    v_add_f32 v18, v18, v77
    v_mfma_f32_16x16x32_bf16 v[44:47], v[112:115], a[88:91], v[44:47]
    v_add_f32 v18, v18, v78
    v_add_f32 v18, v18, v79
    v_mfma_f32_16x16x32_bf16 v[44:47], v[116:119], a[92:95], v[44:47]
    v_add_f32 v19, v19, v80
    v_add_f32 v19, v19, v81
    v_mfma_f32_16x16x32_bf16 v[52:55], v[112:115], a[120:123], v[52:55]
    ds_read_b64_tr_b16 v[112:113], v4 offset:64
    v_add_f32 v19, v19, v82
    v_mfma_f32_16x16x32_bf16 v[52:55], v[116:119], a[124:127], v[52:55]
    s_waitcnt lgkmcnt(3)
    ds_read_b64_tr_b16 v[114:115], v4 offset:576
    ds_read_b64_tr_b16 v[116:117], v4 offset:96
    v_mfma_f32_16x16x32_bf16 v[128:131], v[104:107], v[88:91], v[128:131]
    ds_read_b64_tr_b16 v[118:119], v4 offset:608
    v_fma_f32 v24, v24, s21, v12
    v_mfma_f32_16x16x32_bf16 v[132:135], v[104:107], v[92:95], v[132:135]
    v_add_f32 v19, v19, v83
    v_fma_f32 v25, v25, s21, v12
    v_mfma_f32_16x16x32_bf16 v[136:139], v[104:107], v[96:99], v[136:139]
    v_fma_f32 v26, v26, s21, v12
    v_mfma_f32_16x16x32_bf16 v[140:143], v[104:107], v[100:103], v[140:143]
    s_waitcnt lgkmcnt(4)
    ds_read_b64_tr_b16 v[104:105], v4 offset:128
    v_max3_f32 v20, v24, v25, v26
    v_mfma_f32_16x16x32_bf16 v[144:147], v[108:111], v[88:91], v[144:147]
    s_waitcnt vmcnt(16)
    ds_read_b64_tr_b16 v[106:107], v4 offset:640
    v_mfma_f32_16x16x32_bf16 v[148:151], v[108:111], v[92:95], v[148:151]
    v_fma_f32 v27, v27, s21, v12
    v_fma_f32 v32, v32, s21, v13
    v_mfma_f32_16x16x32_bf16 v[152:155], v[108:111], v[96:99], v[152:155]
    s_barrier
    v_max3_f32 v20, v20, v27, v32
    v_mfma_f32_16x16x32_bf16 v[156:159], v[108:111], v[100:103], v[156:159]
    s_waitcnt lgkmcnt(4)
    ds_read_b64_tr_b16 v[108:109], v4 offset:160
    v_fma_f32 v33, v33, s21, v13
    v_mfma_f32_16x16x32_bf16 v[160:163], v[112:115], v[88:91], v[160:163]
    s_add_u32 m0, s29, s30
    ds_read_b64_tr_b16 v[110:111], v4 offset:672
    v_fma_f32 v34, v34, s21, v13
    v_mfma_f32_16x16x32_bf16 v[164:167], v[112:115], v[92:95], v[164:167]
    s_add_u32 s29, s29, s38
    buffer_load_dwordx4 v5, s[12:15], s25 offen offset:0 nt lds
    v_mfma_f32_16x16x32_bf16 v[168:171], v[112:115], v[96:99], v[168:171]
    s_sub_u32 s31, s29, s39
    v_max3_f32 v20, v20, v33, v34
    v_mfma_f32_16x16x32_bf16 v[172:175], v[112:115], v[100:103], v[172:175]
    s_waitcnt lgkmcnt(4)
    ds_read_b64_tr_b16 v[112:113], v4 offset:192
    v_fma_f32 v35, v35, s21, v13
    v_mfma_f32_16x16x32_bf16 v[176:179], v[116:119], v[88:91], v[176:179]
    s_min_u32 s29, s29, s31
    ds_read_b64_tr_b16 v[114:115], v4 offset:704
    v_add_f32 v19, v19, v84
    v_mfma_f32_16x16x32_bf16 v[180:183], v[116:119], v[92:95], v[180:183]
    v_fma_f32 v40, v40, s21, v14
    v_mfma_f32_16x16x32_bf16 v[184:187], v[116:119], v[96:99], v[184:187]
    buffer_load_dwordx4 v6, s[12:15], s25 offen offset:1040 nt lds
    v_mfma_f32_16x16x32_bf16 v[188:191], v[116:119], v[100:103], v[188:191]
    s_waitcnt lgkmcnt(4)
    ds_read_b64_tr_b16 v[116:117], v4 offset:224
    v_max3_f32 v20, v20, v35, v40
    v_mfma_f32_16x16x32_bf16 v[192:195], v[104:107], v[88:91], v[192:195]
    ds_read_b64_tr_b16 v[118:119], v4 offset:736
    v_mfma_f32_16x16x32_bf16 v[196:199], v[104:107], v[92:95], v[196:199]
    v_fma_f32 v41, v41, s21, v14
    v_fma_f32 v42, v42, s21, v14
    v_mfma_f32_16x16x32_bf16 v[200:203], v[104:107], v[96:99], v[200:203]
    v_max3_f32 v20, v20, v41, v42
    v_mfma_f32_16x16x32_bf16 v[204:207], v[104:107], v[100:103], v[204:207]
    s_waitcnt lgkmcnt(4)
    ds_read_b64_tr_b16 v[104:105], v4 offset:256
    v_fma_f32 v43, v43, s21, v14
    v_mfma_f32_16x16x32_bf16 v[208:211], v[108:111], v[88:91], v[208:211]
    ds_read_b64_tr_b16 v[106:107], v4 offset:768
    v_fma_f32 v48, v48, s21, v15
    v_mfma_f32_16x16x32_bf16 v[212:215], v[108:111], v[92:95], v[212:215]
    buffer_load_dwordx4 v7, s[12:15], s25 offen offset:2080 nt lds
    v_mfma_f32_16x16x32_bf16 v[216:219], v[108:111], v[96:99], v[216:219]
    v_max3_f32 v20, v20, v43, v48
    v_mfma_f32_16x16x32_bf16 v[220:223], v[108:111], v[100:103], v[220:223]
    s_waitcnt lgkmcnt(4)
    ds_read_b64_tr_b16 v[108:109], v4 offset:288
    v_fma_f32 v49, v49, s21, v15
    v_mfma_f32_16x16x32_bf16 v[224:227], v[112:115], v[88:91], v[224:227]
    ds_read_b64_tr_b16 v[110:111], v4 offset:800
    v_mfma_f32_16x16x32_bf16 v[228:231], v[112:115], v[92:95], v[228:231]
    v_fma_f32 v50, v50, s21, v15
    v_add_f32 v19, v19, v85
    v_mfma_f32_16x16x32_bf16 v[232:235], v[112:115], v[96:99], v[232:235]
    buffer_load_dwordx4 v8, s[12:15], s25 offen offset:3120 nt lds
    v_mfma_f32_16x16x32_bf16 v[236:239], v[112:115], v[100:103], v[236:239]
    s_waitcnt lgkmcnt(4)
    ds_read_b64_tr_b16 v[112:113], v4 offset:320
    v_max3_f32 v20, v20, v49, v50
    v_mfma_f32_16x16x32_bf16 v[240:243], v[116:119], v[88:91], v[240:243]
    s_add_u32 s25, s25, 0x4000
    ds_read_b64_tr_b16 v[114:115], v4 offset:832
    v_mfma_f32_16x16x32_bf16 v[244:247], v[116:119], v[92:95], v[244:247]
    s_add_u32 m0, s29, s30
    v_fma_f32 v51, v51, s21, v15
    v_fma_f32 v28, v28, s21, v12
    v_mfma_f32_16x16x32_bf16 v[248:251], v[116:119], v[96:99], v[248:251]
    s_add_u32 s29, s29, s38
    buffer_load_dwordx4 v5, s[8:11], s24 offen offset:0 nt lds
    v_mfma_f32_16x16x32_bf16 v[252:255], v[116:119], v[100:103], v[252:255]
    s_waitcnt lgkmcnt(4)
    ds_read_b64_tr_b16 v[116:117], v4 offset:352
    v_mfma_f32_16x16x32_bf16 a[128:131], v[104:107], v[88:91], a[128:131]
    s_sub_u32 s31, s29, s39
    ds_read_b64_tr_b16 v[118:119], v4 offset:864
    v_max3_f32 v20, v20, v51, v28
    v_mfma_f32_16x16x32_bf16 a[132:135], v[104:107], v[92:95], a[132:135]
    s_min_u32 s29, s29, s31
    v_fma_f32 v29, v29, s21, v12
    v_mfma_f32_16x16x32_bf16 a[136:139], v[104:107], v[96:99], a[136:139]
    v_fma_f32 v30, v30, s21, v12
    v_max3_f32 v20, v20, v29, v30
    v_mfma_f32_16x16x32_bf16 a[140:143], v[104:107], v[100:103], a[140:143]
    s_waitcnt lgkmcnt(4)
    ds_read_b64_tr_b16 v[104:105], v4 offset:384
    v_fma_f32 v31, v31, s21, v12
    v_mfma_f32_16x16x32_bf16 a[144:147], v[108:111], v[88:91], a[144:147]
    ds_read_b64_tr_b16 v[106:107], v4 offset:896
    v_mfma_f32_16x16x32_bf16 a[148:151], v[108:111], v[92:95], a[148:151]
    buffer_load_dwordx4 v6, s[8:11], s24 offen offset:1040 nt lds
    v_mfma_f32_16x16x32_bf16 a[152:155], v[108:111], v[96:99], a[152:155]
    v_fma_f32 v36, v36, s21, v13
    v_add_f32 v19, v19, v86
    v_mfma_f32_16x16x32_bf16 a[156:159], v[108:111], v[100:103], a[156:159]
    s_waitcnt lgkmcnt(4)
    ds_read_b64_tr_b16 v[108:109], v4 offset:416
    v_mfma_f32_16x16x32_bf16 a[160:163], v[112:115], v[88:91], a[160:163]
    ds_read_b64_tr_b16 v[110:111], v4 offset:928
    v_max3_f32 v20, v20, v31, v36
    v_mfma_f32_16x16x32_bf16 a[164:167], v[112:115], v[92:95], a[164:167]
    v_fma_f32 v37, v37, s21, v13
    v_fma_f32 v38, v38, s21, v13
    v_mfma_f32_16x16x32_bf16 a[168:171], v[112:115], v[96:99], a[168:171]
    buffer_load_dwordx4 v7, s[8:11], s24 offen offset:2080 nt lds
    v_mfma_f32_16x16x32_bf16 a[172:175], v[112:115], v[100:103], a[172:175]
    s_waitcnt lgkmcnt(4)
    ds_read_b64_tr_b16 v[112:113], v4 offset:448
    v_mfma_f32_16x16x32_bf16 a[176:179], v[116:119], v[88:91], a[176:179]
    ds_read_b64_tr_b16 v[114:115], v4 offset:960
    v_max3_f32 v20, v20, v37, v38
    v_mfma_f32_16x16x32_bf16 a[180:183], v[116:119], v[92:95], a[180:183]
    v_fma_f32 v39, v39, s21, v13
    v_mfma_f32_16x16x32_bf16 a[184:187], v[116:119], v[96:99], a[184:187]
    v_fma_f32 v44, v44, s21, v14
    v_max3_f32 v20, v20, v39, v44
    v_mfma_f32_16x16x32_bf16 a[188:191], v[116:119], v[100:103], a[188:191]
    s_waitcnt lgkmcnt(4)
    ds_read_b64_tr_b16 v[116:117], v4 offset:480
    v_mfma_f32_16x16x32_bf16 a[192:195], v[104:107], v[88:91], a[192:195]
    ds_read_b64_tr_b16 v[118:119], v4 offset:992
    v_fma_f32 v45, v45, s21, v14
    v_mfma_f32_16x16x32_bf16 a[196:199], v[104:107], v[92:95], a[196:199]
    buffer_load_dwordx4 v8, s[8:11], s24 offen offset:3120 nt lds
    v_mfma_f32_16x16x32_bf16 a[200:203], v[104:107], v[96:99], a[200:203]
    s_add_u32 s24, s24, 0x4000
    v_fma_f32 v46, v46, s21, v14
    v_max3_f32 v20, v20, v45, v46
    v_mfma_f32_16x16x32_bf16 a[204:207], v[104:107], v[100:103], a[204:207]
    s_waitcnt lgkmcnt(4)
    ds_read_b128 v[104:107], v3 offset:0
    v_mfma_f32_16x16x32_bf16 a[208:211], v[108:111], v[88:91], a[208:211]
    v_add_f32 v19, v19, v87
    v_fma_f32 v47, v47, s21, v14
    v_mfma_f32_16x16x32_bf16 a[212:215], v[108:111], v[92:95], a[212:215]
    v_fma_f32 v52, v52, s21, v15
    v_mfma_f32_16x16x32_bf16 a[216:219], v[108:111], v[96:99], a[216:219]
    v_max3_f32 v20, v20, v47, v52
    v_fma_f32 v53, v53, s21, v15
    v_mfma_f32_16x16x32_bf16 a[220:223], v[108:111], v[100:103], a[220:223]
    s_waitcnt lgkmcnt(3)
    ds_read_b128 v[108:111], v3 offset:16
    v_mfma_f32_16x16x32_bf16 a[224:227], v[112:115], v[88:91], a[224:227]
    v_fma_f32 v54, v54, s21, v15
    v_max3_f32 v20, v20, v53, v54
    v_mfma_f32_16x16x32_bf16 a[228:231], v[112:115], v[92:95], a[228:231]
    v_fma_f32 v55, v55, s21, v15
    v_mfma_f32_16x16x32_bf16 a[232:235], v[112:115], v[96:99], a[232:235]
    v_max3_f32 v20, v20, v55, v55
    v_mfma_f32_16x16x32_bf16 a[236:239], v[112:115], v[100:103], a[236:239]
    s_waitcnt lgkmcnt(2)
    ds_read_b128 v[112:115], v3 offset:32
    v_mfma_f32_16x16x32_bf16 a[240:243], v[116:119], v[88:91], a[240:243]
    v_mfma_f32_16x16x32_bf16 a[244:247], v[116:119], v[92:95], a[244:247]
    v_cmp_lt_f32 vcc, s35, v20
    v_mfma_f32_16x16x32_bf16 a[248:251], v[116:119], v[96:99], a[248:251]
    v_mfma_f32_16x16x32_bf16 a[252:255], v[116:119], v[100:103], a[252:255]
    s_waitcnt lgkmcnt(1)
    ds_read_b128 v[116:119], v3 offset:48
    s_cbranch_vccnz L_rare_s13
L_cont_s13:
    s_add_u32 s25, s25, 33292288
    v_mfma_f32_16x16x32_bf16 v[56:59], v[104:107], a[0:3], 0
    v_exp_f32 v24, v24
    v_mfma_f32_16x16x32_bf16 v[56:59], v[108:111], a[4:7], v[56:59]
    v_add_u32 v4, s28, v2
    v_add_f32 v16, v16, v24
    v_mfma_f32_16x16x32_bf16 v[64:67], v[104:107], a[32:35], 0
    s_add_u32 s28, s28, s38
    v_exp_f32 v25, v25
    v_mfma_f32_16x16x32_bf16 v[64:67], v[108:111], a[36:39], v[64:67]
    s_sub_u32 s48, s28, s39
    v_exp_f32 v26, v26
    v_mfma_f32_16x16x32_bf16 v[72:75], v[104:107], a[64:67], 0
    s_min_u32 s28, s28, s48
    v_exp_f32 v27, v27
    v_mfma_f32_16x16x32_bf16 v[72:75], v[108:111], a[68:71], v[72:75]
    v_exp_f32 v28, v28
    v_mfma_f32_16x16x32_bf16 v[80:83], v[104:107], a[96:99], 0
    ds_read_b128 v[104:107], v3 offset:256
    v_cvt_pk_bf16_f32 v88, v24, v25
    v_mfma_f32_16x16x32_bf16 v[80:83], v[108:111], a[100:103], v[80:83]
    s_waitcnt lgkmcnt(1)
    ds_read_b128 v[108:111], v3 offset:272
    v_cvt_pk_bf16_f32 v89, v26, v27
    v_mfma_f32_16x16x32_bf16 v[56:59], v[112:115], a[8:11], v[56:59]
    v_exp_f32 v29, v29
    v_mfma_f32_16x16x32_bf16 v[56:59], v[116:119], a[12:15], v[56:59]
    v_exp_f32 v30, v30
    v_mfma_f32_16x16x32_bf16 v[64:67], v[112:115], a[40:43], v[64:67]
    v_exp_f32 v31, v31
    v_mfma_f32_16x16x32_bf16 v[64:67], v[116:119], a[44:47], v[64:67]
    v_exp_f32 v32, v32
    v_mfma_f32_16x16x32_bf16 v[72:75], v[112:115], a[72:75], v[72:75]
    v_exp_f32 v33, v33
    v_mfma_f32_16x16x32_bf16 v[72:75], v[116:119], a[76:79], v[72:75]
    v_exp_f32 v34, v34
    v_mfma_f32_16x16x32_bf16 v[80:83], v[112:115], a[104:107], v[80:83]
    ds_read_b128 v[112:115], v3 offset:288
    v_cvt_pk_bf16_f32 v90, v28, v29
    v_mfma_f32_16x16x32_bf16 v[80:83], v[116:119], a[108:111], v[80:83]
    s_waitcnt lgkmcnt(1)
    ds_read_b128 v[116:119], v3 offset:304
    v_cvt_pk_bf16_f32 v91, v30, v31
    v_mfma_f32_16x16x32_bf16 v[56:59], v[104:107], a[16:19], v[56:59]
    v_exp_f32 v35, v35
    v_mfma_f32_16x16x32_bf16 v[56:59], v[108:111], a[20:23], v[56:59]
    v_exp_f32 v36, v36
    v_mfma_f32_16x16x32_bf16 v[64:67], v[104:107], a[48:51], v[64:67]
    v_exp_f32 v37, v37
    v_mfma_f32_16x16x32_bf16 v[64:67], v[108:111], a[52:55], v[64:67]
    v_exp_f32 v38, v38
    v_mfma_f32_16x16x32_bf16 v[72:75], v[104:107], a[80:83], v[72:75]
    v_exp_f32 v39, v39
    v_mfma_f32_16x16x32_bf16 v[72:75], v[108:111], a[84:87], v[72:75]
    v_exp_f32 v40, v40
    v_mfma_f32_16x16x32_bf16 v[80:83], v[104:107], a[112:115], v[80:83]
    ds_read_b128 v[104:107], v3 offset:512
    v_cvt_pk_bf16_f32 v92, v32, v33
    v_mfma_f32_16x16x32_bf16 v[80:83], v[108:111], a[116:119], v[80:83]
    s_waitcnt lgkmcnt(1)
    ds_read_b128 v[108:111], v3 offset:528
    v_cvt_pk_bf16_f32 v93, v34, v35
    v_mfma_f32_16x16x32_bf16 v[56:59], v[112:115], a[24:27], v[56:59]
    v_exp_f32 v41, v41
    v_mfma_f32_16x16x32_bf16 v[56:59], v[116:119], a[28:31], v[56:59]
    v_exp_f32 v42, v42
    v_mfma_f32_16x16x32_bf16 v[64:67], v[112:115], a[56:59], v[64:67]
    v_exp_f32 v43, v43
    v_mfma_f32_16x16x32_bf16 v[64:67], v[116:119], a[60:63], v[64:67]
    v_exp_f32 v44, v44
    v_mfma_f32_16x16x32_bf16 v[72:75], v[112:115], a[88:91], v[72:75]
    v_exp_f32 v45, v45
    v_mfma_f32_16x16x32_bf16 v[72:75], v[116:119], a[92:95], v[72:75]
    v_exp_f32 v46, v46
    v_mfma_f32_16x16x32_bf16 v[80:83], v[112:115], a[120:123], v[80:83]
    ds_read_b128 v[112:115], v3 offset:544
    v_cvt_pk_bf16_f32 v94, v36, v37
    v_mfma_f32_16x16x32_bf16 v[80:83], v[116:119], a[124:127], v[80:83]
    s_waitcnt lgkmcnt(1)
    ds_read_b128 v[116:119], v3 offset:560
    v_cvt_pk_bf16_f32 v95, v38, v39
    v_mfma_f32_16x16x32_bf16 v[60:63], v[104:107], a[0:3], 0
    v_exp_f32 v47, v47
    v_mfma_f32_16x16x32_bf16 v[60:63], v[108:111], a[4:7], v[60:63]
    v_exp_f32 v48, v48
    v_mfma_f32_16x16x32_bf16 v[68:71], v[104:107], a[32:35], 0
    v_exp_f32 v49, v49
    v_mfma_f32_16x16x32_bf16 v[68:71], v[108:111], a[36:39], v[68:71]
    v_exp_f32 v50, v50
    v_mfma_f32_16x16x32_bf16 v[76:79], v[104:107], a[64:67], 0
    v_exp_f32 v51, v51
    v_mfma_f32_16x16x32_bf16 v[76:79], v[108:111], a[68:71], v[76:79]
    v_exp_f32 v52, v52
    v_mfma_f32_16x16x32_bf16 v[84:87], v[104:107], a[96:99], 0
    ds_read_b128 v[104:107], v3 offset:768
    v_cvt_pk_bf16_f32 v96, v40, v41
    v_mfma_f32_16x16x32_bf16 v[84:87], v[108:111], a[100:103], v[84:87]
    s_waitcnt lgkmcnt(1)
    ds_read_b128 v[108:111], v3 offset:784
    v_cvt_pk_bf16_f32 v97, v42, v43
    v_mfma_f32_16x16x32_bf16 v[60:63], v[112:115], a[8:11], v[60:63]
    v_exp_f32 v53, v53
    v_mfma_f32_16x16x32_bf16 v[60:63], v[116:119], a[12:15], v[60:63]
    v_exp_f32 v54, v54
    v_mfma_f32_16x16x32_bf16 v[68:71], v[112:115], a[40:43], v[68:71]
    v_exp_f32 v55, v55
    v_mfma_f32_16x16x32_bf16 v[68:71], v[116:119], a[44:47], v[68:71]
    v_cvt_pk_bf16_f32 v98, v44, v45
    v_cvt_pk_bf16_f32 v99, v46, v47
    v_mfma_f32_16x16x32_bf16 v[76:79], v[112:115], a[72:75], v[76:79]
    v_cvt_pk_bf16_f32 v100, v48, v49
    v_cvt_pk_bf16_f32 v101, v50, v51
    v_mfma_f32_16x16x32_bf16 v[76:79], v[116:119], a[76:79], v[76:79]
    v_cvt_pk_bf16_f32 v102, v52, v53
    v_cvt_pk_bf16_f32 v103, v54, v55
    v_mfma_f32_16x16x32_bf16 v[84:87], v[112:115], a[104:107], v[84:87]
    ds_read_b128 v[112:115], v3 offset:800
    v_add_f32 v16, v16, v25
    v_mfma_f32_16x16x32_bf16 v[84:87], v[116:119], a[108:111], v[84:87]
    s_waitcnt lgkmcnt(1)
    ds_read_b128 v[116:119], v3 offset:816
    v_add_f32 v16, v16, v26
    v_mfma_f32_16x16x32_bf16 v[60:63], v[104:107], a[16:19], v[60:63]
    v_add_f32 v16, v16, v27
    v_add_f32 v16, v16, v28
    v_mfma_f32_16x16x32_bf16 v[60:63], v[108:111], a[20:23], v[60:63]
    v_add_f32 v16, v16, v29
    v_add_f32 v16, v16, v30
    v_mfma_f32_16x16x32_bf16 v[68:71], v[104:107], a[48:51], v[68:71]
    v_add_f32 v16, v16, v31
    v_add_f32 v17, v17, v32
    v_mfma_f32_16x16x32_bf16 v[68:71], v[108:111], a[52:55], v[68:71]
    v_add_f32 v17, v17, v33
    v_add_f32 v17, v17, v34
    v_mfma_f32_16x16x32_bf16 v[76:79], v[104:107], a[80:83], v[76:79]
    v_add_f32 v17, v17, v35
    v_add_f32 v17, v17, v36
    v_mfma_f32_16x16x32_bf16 v[76:79], v[108:111], a[84:87], v[76:79]
    v_add_f32 v17, v17, v37
    v_add_f32 v17, v17, v38
    v_mfma_f32_16x16x32_bf16 v[84:87], v[104:107], a[112:115], v[84:87]
    ds_read_b64_tr_b16 v[104:105], v4 offset:0
    v_add_f32 v17, v17, v39
    v_mfma_f32_16x16x32_bf16 v[84:87], v[108:111], a[116:119], v[84:87]
    s_waitcnt lgkmcnt(1)
    ds_read_b64_tr_b16 v[106:107], v4 offset:512
    ds_read_b64_tr_b16 v[108:109], v4 offset:32
    v_mfma_f32_16x16x32_bf16 v[60:63], v[112:115], a[24:27], v[60:63]
    ds_read_b64_tr_b16 v[110:111], v4 offset:544
    v_add_f32 v18, v18, v40
    v_mfma_f32_16x16x32_bf16 v[60:63], v[116:119], a[28:31], v[60:63]
    v_add_f32 v18, v18, v41
    v_add_f32 v18, v18, v42
    v_mfma_f32_16x16x32_bf16 v[68:71], v[112:115], a[56:59], v[68:71]
    v_add_f32 v18, v18, v43
    v_add_f32 v18, v18, v44
    v_mfma_f32_16x16x32_bf16 v[68:71], v[116:119], a[60:63], v[68:71]
    v_add_f32 v18, v18, v45
    v_add_f32 v18, v18, v46
    v_mfma_f32_16x16x32_bf16 v[76:79], v[112:115], a[88:91], v[76:79]
    v_add_f32 v18, v18, v47
    v_add_f32 v19, v19, v48
    v_mfma_f32_16x16x32_bf16 v[76:79], v[116:119], a[92:95], v[76:79]
    v_add_f32 v19, v19, v49
    v_add_f32 v19, v19, v50
    v_mfma_f32_16x16x32_bf16 v[84:87], v[112:115], a[120:123], v[84:87]
    ds_read_b64_tr_b16 v[112:113], v4 offset:64
    v_add_f32 v19, v19, v51
    v_mfma_f32_16x16x32_bf16 v[84:87], v[116:119], a[124:127], v[84:87]
    s_waitcnt lgkmcnt(3)
    ds_read_b64_tr_b16 v[114:115], v4 offset:576
    ds_read_b64_tr_b16 v[116:117], v4 offset:96
    v_mfma_f32_16x16x32_bf16 v[128:131], v[104:107], v[88:91], v[128:131]
    ds_read_b64_tr_b16 v[118:119], v4 offset:608
    v_fma_f32 v56, v56, s21, v12
    v_mfma_f32_16x16x32_bf16 v[132:135], v[104:107], v[92:95], v[132:135]
    v_add_f32 v19, v19, v52
    v_fma_f32 v57, v57, s21, v12
    v_mfma_f32_16x16x32_bf16 v[136:139], v[104:107], v[96:99], v[136:139]
    v_fma_f32 v58, v58, s21, v12
    v_max3_f32 v20, v56, v57, v58
    v_mfma_f32_16x16x32_bf16 v[140:143], v[104:107], v[100:103], v[140:143]
    s_waitcnt lgkmcnt(4)
    ds_read_b64_tr_b16 v[104:105], v4 offset:128
    v_fma_f32 v59, v59, s21, v12
    v_mfma_f32_16x16x32_bf16 v[144:147], v[108:111], v[88:91], v[144:147]
    s_waitcnt vmcnt(8)
    ds_read_b64_tr_b16 v[106:107], v4 offset:640
    v_fma_f32 v64, v64, s21, v13
    v_mfma_f32_16x16x32_bf16 v[148:151], v[108:111], v[92:95], v[148:151]
    v_max3_f32 v20, v20, v59, v64
    v_mfma_f32_16x16x32_bf16 v[152:155], v[108:111], v[96:99], v[152:155]
    s_barrier
    v_fma_f32 v65, v65, s21, v13
    v_fma_f32 v66, v66, s21, v13
    v_mfma_f32_16x16x32_bf16 v[156:159], v[108:111], v[100:103], v[156:159]
    s_waitcnt lgkmcnt(4)
    s_add_u32 s33, s28, s80
    ds_read_b64_tr_b16 v[108:109], v4 offset:160
    v_max3_f32 v20, v20, v65, v66
    v_mfma_f32_16x16x32_bf16 v[160:163], v[112:115], v[88:91], v[160:163]
    s_add_u32 m0, s29, s30
    s_sub_u32 s34, s33, s39
    ds_read_b64_tr_b16 v[110:111], v4 offset:672
    v_fma_f32 v67, v67, s21, v13
    v_mfma_f32_16x16x32_bf16 v[164:167], v[112:115], v[92:95], v[164:167]
    s_add_u32 s29, s29, s38
    s_min_u32 s33, s33, s34
    buffer_load_dwordx4 v5, s[4:7], s23 offen offset:0 nt lds
    v_mfma_f32_16x16x32_bf16 v[168:171], v[112:115], v[96:99], v[168:171]
    s_sub_u32 s31, s29, s39
    v_add_u32 v21, s33, v1
    v_fma_f32 v72, v72, s21, v14
    v_mfma_f32_16x16x32_bf16 v[172:175], v[112:115], v[100:103], v[172:175]
    s_waitcnt lgkmcnt(4)
    ds_read_b64_tr_b16 v[112:113], v4 offset:192
    ds_read_b128 a[0:3], v21 offset:0
    v_mfma_f32_16x16x32_bf16 v[176:179], v[116:119], v[88:91], v[176:179]
    s_min_u32 s29, s29, s31
    ds_read_b64_tr_b16 v[114:115], v4 offset:704
    v_mfma_f32_16x16x32_bf16 v[180:183], v[116:119], v[92:95], v[180:183]
    s_add_u32 s28, s28, 66560
    ds_read_b128 a[4:7], v21 offset:16
    v_max3_f32 v20, v20, v67, v72
    v_mfma_f32_16x16x32_bf16 v[184:187], v[116:119], v[96:99], v[184:187]
    s_sub_u32 s48, s28, s39
    buffer_load_dwordx4 v6, s[4:7], s23 offen offset:1040 nt lds
    v_mfma_f32_16x16x32_bf16 v[188:191], v[116:119], v[100:103], v[188:191]
    s_waitcnt lgkmcnt(6)
    ds_read_b64_tr_b16 v[116:117], v4 offset:224
    ds_read_b128 a[8:11], v21 offset:32
    v_mfma_f32_16x16x32_bf16 v[192:195], v[104:107], v[88:91], v[192:195]
    s_min_u32 s28, s28, s48
    ds_read_b64_tr_b16 v[118:119], v4 offset:736
    v_add_f32 v19, v19, v53
    v_mfma_f32_16x16x32_bf16 v[196:199], v[104:107], v[92:95], v[196:199]
    ds_read_b128 a[12:15], v21 offset:48
    v_fma_f32 v73, v73, s21, v14
    v_mfma_f32_16x16x32_bf16 v[200:203], v[104:107], v[96:99], v[200:203]
    v_fma_f32 v74, v74, s21, v14
    v_max3_f32 v20, v20, v73, v74
    v_mfma_f32_16x16x32_bf16 v[204:207], v[104:107], v[100:103], v[204:207]
    s_waitcnt lgkmcnt(8)
    ds_read_b64_tr_b16 v[104:105], v4 offset:256
    ds_read_b128 a[16:19], v21 offset:256
    v_mfma_f32_16x16x32_bf16 v[208:211], v[108:111], v[88:91], v[208:211]
    ds_read_b64_tr_b16 v[106:107], v4 offset:768
    v_fma_f32 v75, v75, s21, v14
    v_mfma_f32_16x16x32_bf16 v[212:215], v[108:111], v[92:95], v[212:215]
    buffer_load_dwordx4 v7, s[4:7], s23 offen offset:2080 nt lds
    v_mfma_f32_16x16x32_bf16 v[216:219], v[108:111], v[96:99], v[216:219]
    ds_read_b128 a[20:23], v21 offset:272
    v_fma_f32 v80, v80, s21, v15
    v_mfma_f32_16x16x32_bf16 v[220:223], v[108:111], v[100:103], v[220:223]
    s_waitcnt lgkmcnt(9)
    ds_read_b64_tr_b16 v[108:109], v4 offset:288
    v_mfma_f32_16x16x32_bf16 v[224:227], v[112:115], v[88:91], v[224:227]
    ds_read_b64_tr_b16 v[110:111], v4 offset:800
    ds_read_b128 a[24:27], v21 offset:288
    v_mfma_f32_16x16x32_bf16 v[228:231], v[112:115], v[92:95], v[228:231]
    v_max3_f32 v20, v20, v75, v80
    v_fma_f32 v81, v81, s21, v15
    v_mfma_f32_16x16x32_bf16 v[232:235], v[112:115], v[96:99], v[232:235]
    buffer_load_dwordx4 v8, s[4:7], s23 offen offset:3120 nt lds
    v_mfma_f32_16x16x32_bf16 v[236:239], v[112:115], v[100:103], v[236:239]
    s_waitcnt lgkmcnt(8)
    ds_read_b64_tr_b16 v[112:113], v4 offset:320
    ds_read_b128 a[28:31], v21 offset:304
    v_mfma_f32_16x16x32_bf16 v[240:243], v[116:119], v[88:91], v[240:243]
    s_add_u32 s23, s23, 0x4000
    ds_read_b64_tr_b16 v[114:115], v4 offset:832
    v_fma_f32 v82, v82, s21, v15
    v_mfma_f32_16x16x32_bf16 v[244:247], v[116:119], v[92:95], v[244:247]
    s_add_u32 m0, s29, s30
    ds_read_b128 a[32:35], v21 offset:512
    v_max3_f32 v20, v20, v81, v82
    v_mfma_f32_16x16x32_bf16 v[248:251], v[116:119], v[96:99], v[248:251]
    s_add_u32 s29, s29, s38
    buffer_load_dwordx4 v5, s[4:7], s23 offen offset:0 nt lds
    v_mfma_f32_16x16x32_bf16 v[252:255], v[116:119], v[100:103], v[252:255]
    s_waitcnt lgkmcnt(8)
    ds_read_b64_tr_b16 v[116:117], v4 offset:352
    ds_read_b128 a[36:39], v21 offset:528
    v_mfma_f32_16x16x32_bf16 a[128:131], v[104:107], v[88:91], a[128:131]
    s_sub_u32 s31, s29, s39
    ds_read_b64_tr_b16 v[118:119], v4 offset:864
    v_fma_f32 v83, v83, s21, v15
    v_mfma_f32_16x16x32_bf16 a[132:135], v[104:107], v[92:95], a[132:135]
    s_min_u32 s29, s29, s31
    ds_read_b128 a[40:43], v21 offset:544
    v_fma_f32 v60, v60, s21, v12
    v_mfma_f32_16x16x32_bf16 a[136:139], v[104:107], v[96:99], a[136:139]
    v_max3_f32 v20, v20, v83, v60
    v_mfma_f32_16x16x32_bf16 a[140:143], v[104:107], v[100:103], a[140:143]
    s_waitcnt lgkmcnt(9)
    ds_read_b64_tr_b16 v[104:105], v4 offset:384
    ds_read_b128 a[44:47], v21 offset:560
    v_mfma_f32_16x16x32_bf16 a[144:147], v[108:111], v[88:91], a[144:147]
    ds_read_b64_tr_b16 v[106:107], v4 offset:896
    v_add_f32 v19, v19, v54
    v_mfma_f32_16x16x32_bf16 a[148:151], v[108:111], v[92:95], a[148:151]
    buffer_load_dwordx4 v6, s[4:7], s23 offen offset:1040 nt lds
    v_mfma_f32_16x16x32_bf16 a[152:155], v[108:111], v[96:99], a[152:155]
    ds_read_b128 a[48:51], v21 offset:768
    v_fma_f32 v61, v61, s21, v12
    v_mfma_f32_16x16x32_bf16 a[156:159], v[108:111], v[100:103], a[156:159]
    s_waitcnt lgkmcnt(9)
    ds_read_b64_tr_b16 v[108:109], v4 offset:416
    v_fma_f32 v62, v62, s21, v12
    v_mfma_f32_16x16x32_bf16 a[160:163], v[112:115], v[88:91], a[160:163]
    ds_read_b64_tr_b16 v[110:111], v4 offset:928
    ds_read_b128 a[52:55], v21 offset:784
    v_mfma_f32_16x16x32_bf16 a[164:167], v[112:115], v[92:95], a[164:167]
    v_max3_f32 v20, v20, v61, v62
    v_fma_f32 v63, v63, s21, v12
    v_mfma_f32_16x16x32_bf16 a[168:171], v[112:115], v[96:99], a[168:171]
    buffer_load_dwordx4 v7, s[4:7], s23 offen offset:2080 nt lds
    v_mfma_f32_16x16x32_bf16 a[172:175], v[112:115], v[100:103], a[172:175]
    s_waitcnt lgkmcnt(8)
    ds_read_b64_tr_b16 v[112:113], v4 offset:448
    ds_read_b128 a[56:59], v21 offset:800
    v_mfma_f32_16x16x32_bf16 a[176:179], v[116:119], v[88:91], a[176:179]
    ds_read_b64_tr_b16 v[114:115], v4 offset:960
    v_fma_f32 v68, v68, s21, v13
    v_mfma_f32_16x16x32_bf16 a[180:183], v[116:119], v[92:95], a[180:183]
    ds_read_b128 a[60:63], v21 offset:816
    v_mfma_f32_16x16x32_bf16 a[184:187], v[116:119], v[96:99], a[184:187]
    v_max3_f32 v20, v20, v63, v68
    v_fma_f32 v69, v69, s21, v13
    v_mfma_f32_16x16x32_bf16 a[188:191], v[116:119], v[100:103], a[188:191]
    s_waitcnt lgkmcnt(8)
    ds_read_b64_tr_b16 v[116:117], v4 offset:480
    v_fma_f32 v70, v70, s21, v13
    v_mfma_f32_16x16x32_bf16 a[192:195], v[104:107], v[88:91], a[192:195]
    ds_read_b64_tr_b16 v[118:119], v4 offset:992
    v_max3_f32 v20, v20, v69, v70
    v_mfma_f32_16x16x32_bf16 a[196:199], v[104:107], v[92:95], a[196:199]
    buffer_load_dwordx4 v8, s[4:7], s23 offen offset:3120 nt lds
    v_mfma_f32_16x16x32_bf16 a[200:203], v[104:107], v[96:99], a[200:203]
    s_add_u32 s23, s23, 0x4000
    v_fma_f32 v71, v71, s21, v13
    v_fma_f32 v76, v76, s21, v14
    v_mfma_f32_16x16x32_bf16 a[204:207], v[104:107], v[100:103], a[204:207]
    s_waitcnt lgkmcnt(7)
    v_max3_f32 v20, v20, v71, v76
    v_mfma_f32_16x16x32_bf16 a[208:211], v[108:111], v[88:91], a[208:211]
    v_add_f32 v19, v19, v55
    v_fma_f32 v77, v77, s21, v14
    v_mfma_f32_16x16x32_bf16 a[212:215], v[108:111], v[92:95], a[212:215]
    v_fma_f32 v78, v78, s21, v14
    v_max3_f32 v20, v20, v77, v78
    v_mfma_f32_16x16x32_bf16 a[216:219], v[108:111], v[96:99], a[216:219]
    v_fma_f32 v79, v79, s21, v14
    v_fma_f32 v84, v84, s21, v15
    v_mfma_f32_16x16x32_bf16 a[220:223], v[108:111], v[100:103], a[220:223]
    s_waitcnt lgkmcnt(3)
    v_max3_f32 v20, v20, v79, v84
    v_mfma_f32_16x16x32_bf16 a[224:227], v[112:115], v[88:91], a[224:227]
    v_fma_f32 v85, v85, s21, v15
    v_fma_f32 v86, v86, s21, v15
    v_mfma_f32_16x16x32_bf16 a[228:231], v[112:115], v[92:95], a[228:231]
    v_max3_f32 v20, v20, v85, v86
    v_fma_f32 v87, v87, s21, v15
    v_mfma_f32_16x16x32_bf16 a[232:235], v[112:115], v[96:99], a[232:235]
    v_max3_f32 v20, v20, v87, v87
    v_mfma_f32_16x16x32_bf16 a[236:239], v[112:115], v[100:103], a[236:239]
    s_waitcnt lgkmcnt(0)
    v_mfma_f32_16x16x32_bf16 a[240:243], v[116:119], v[88:91], a[240:243]
    v_mfma_f32_16x16x32_bf16 a[244:247], v[116:119], v[92:95], a[244:247]
    v_cmp_lt_f32 vcc, s35, v20
    v_mfma_f32_16x16x32_bf16 a[248:251], v[116:119], v[96:99], a[248:251]
    v_mfma_f32_16x16x32_bf16 a[252:255], v[116:119], v[100:103], a[252:255]
    s_cbranch_vccnz L_rare_s14
L_cont_s14:
    s_waitcnt vmcnt(8)
    v_exp_f32 v56, v56
    v_add_u32 v4, s28, v2
    v_exp_f32 v57, v57
    v_add_f32 v16, v16, v56
    s_barrier
    s_add_u32 m0, s29, s30
    s_add_u32 s29, s29, s38
    s_sub_u32 s31, s29, s39
    s_min_u32 s29, s29, s31
    buffer_load_dwordx4 v5, s[4:7], s23 offen offset:0 nt lds
    v_exp_f32 v58, v58
    v_cvt_pk_bf16_f32 v88, v56, v57
    v_add_f32 v16, v16, v57
    s_add_u32 s28, s28, s38
    v_exp_f32 v59, v59
    v_add_f32 v16, v16, v58
    s_sub_u32 s48, s28, s39
    v_exp_f32 v60, v60
    v_cvt_pk_bf16_f32 v89, v58, v59
    v_add_f32 v16, v16, v59
    s_min_u32 s28, s28, s48
    v_exp_f32 v61, v61
    v_add_f32 v16, v16, v60
    v_exp_f32 v62, v62
    v_cvt_pk_bf16_f32 v90, v60, v61
    v_add_f32 v16, v16, v61
    v_exp_f32 v63, v63
    v_add_f32 v16, v16, v62
    v_exp_f32 v64, v64
    v_cvt_pk_bf16_f32 v91, v62, v63
    v_add_f32 v16, v16, v63
    buffer_load_dwordx4 v6, s[4:7], s23 offen offset:1040 nt lds
    v_exp_f32 v65, v65
    v_add_f32 v17, v17, v64
    v_exp_f32 v66, v66
    v_cvt_pk_bf16_f32 v92, v64, v65
    v_add_f32 v17, v17, v65
    v_exp_f32 v67, v67
    v_add_f32 v17, v17, v66
    v_exp_f32 v68, v68
    v_cvt_pk_bf16_f32 v93, v66, v67
    v_add_f32 v17, v17, v67
    v_exp_f32 v69, v69
    v_add_f32 v17, v17, v68
    v_exp_f32 v70, v70
    v_cvt_pk_bf16_f32 v94, v68, v69
    v_add_f32 v17, v17, v69
    v_exp_f32 v71, v71
    v_add_f32 v17, v17, v70
    v_exp_f32 v72, v72
    v_cvt_pk_bf16_f32 v95, v70, v71
    v_add_f32 v17, v17, v71
    buffer_load_dwordx4 v7, s[4:7], s23 offen offset:2080 nt lds
    v_exp_f32 v73, v73
    v_add_f32 v18, v18, v72
    v_exp_f32 v74, v74
    v_cvt_pk_bf16_f32 v96, v72, v73
    v_add_f32 v18, v18, v73
    v_exp_f32 v75, v75
    v_add_f32 v18, v18, v74
    v_exp_f32 v76, v76
    v_cvt_pk_bf16_f32 v97, v74, v75
    v_add_f32 v18, v18, v75
    v_exp_f32 v77, v77
    v_add_f32 v18, v18, v76
    v_exp_f32 v78, v78
    v_cvt_pk_bf16_f32 v98, v76, v77
    v_add_f32 v18, v18, v77
    v_exp_f32 v79, v79
    v_add_f32 v18, v18, v78
    v_exp_f32 v80, v80
    v_cvt_pk_bf16_f32 v99, v78, v79
    v_add_f32 v18, v18, v79
    buffer_load_dwordx4 v8, s[4:7], s23 offen offset:3120 nt lds
    s_add_u32 s23, s23, 0x4000
    v_exp_f32 v81, v81
    v_add_f32 v19, v19, v80
    v_exp_f32 v82, v82
    v_cvt_pk_bf16_f32 v100, v80, v81
    v_add_f32 v19, v19, v81
    v_exp_f32 v83, v83
    v_add_f32 v19, v19, v82
    v_exp_f32 v84, v84
    v_cvt_pk_bf16_f32 v101, v82, v83
    v_add_f32 v19, v19, v83
    v_exp_f32 v85, v85
    v_add_f32 v19, v19, v84
    v_exp_f32 v86, v86
    v_cvt_pk_bf16_f32 v102, v84, v85
    v_add_f32 v19, v19, v85
    v_exp_f32 v87, v87
    v_add_f32 v19, v19, v86
    v_cvt_pk_bf16_f32 v103, v86, v87
    v_add_f32 v19, v19, v87
    ds_read_b64_tr_b16 v[104:105], v4 offset:0
    ds_read_b64_tr_b16 v[106:107], v4 offset:512
    ds_read_b64_tr_b16 v[108:109], v4 offset:32
    s_add_u32 m0, s29, s30
    s_add_u32 s29, s29, s38
    s_sub_u32 s31, s29, s39
    s_min_u32 s29, s29, s31
    buffer_load_dwordx4 v5, s[4:7], s23 offen offset:0 nt lds
    ds_read_b64_tr_b16 v[110:111], v4 offset:544
    ds_read_b64_tr_b16 v[112:113], v4 offset:64
    ds_read_b64_tr_b16 v[114:115], v4 offset:576
    s_waitcnt lgkmcnt(4)
    ds_read_b64_tr_b16 v[116:117], v4 offset:96
    v_mfma_f32_16x16x32_bf16 v[128:131], v[104:107], v[88:91], v[128:131]
    ds_read_b64_tr_b16 v[118:119], v4 offset:608
    v_mfma_f32_16x16x32_bf16 v[132:135], v[104:107], v[92:95], v[132:135]
    v_mfma_f32_16x16x32_bf16 v[136:139], v[104:107], v[96:99], v[136:139]
    v_mfma_f32_16x16x32_bf16 v[140:143], v[104:107], v[100:103], v[140:143]
    s_waitcnt lgkmcnt(4)
    ds_read_b64_tr_b16 v[104:105], v4 offset:128
    v_mfma_f32_16x16x32_bf16 v[144:147], v[108:111], v[88:91], v[144:147]
    ds_read_b64_tr_b16 v[106:107], v4 offset:640
    v_mfma_f32_16x16x32_bf16 v[148:151], v[108:111], v[92:95], v[148:151]
    buffer_load_dwordx4 v6, s[4:7], s23 offen offset:1040 nt lds
    v_mfma_f32_16x16x32_bf16 v[152:155], v[108:111], v[96:99], v[152:155]
    v_mfma_f32_16x16x32_bf16 v[156:159], v[108:111], v[100:103], v[156:159]
    s_waitcnt lgkmcnt(4)
    ds_read_b64_tr_b16 v[108:109], v4 offset:160
    v_mfma_f32_16x16x32_bf16 v[160:163], v[112:115], v[88:91], v[160:163]
    ds_read_b64_tr_b16 v[110:111], v4 offset:672
    v_mfma_f32_16x16x32_bf16 v[164:167], v[112:115], v[92:95], v[164:167]
    v_mfma_f32_16x16x32_bf16 v[168:171], v[112:115], v[96:99], v[168:171]
    v_mfma_f32_16x16x32_bf16 v[172:175], v[112:115], v[100:103], v[172:175]
    s_waitcnt lgkmcnt(4)
    ds_read_b64_tr_b16 v[112:113], v4 offset:192
    v_mfma_f32_16x16x32_bf16 v[176:179], v[116:119], v[88:91], v[176:179]
    ds_read_b64_tr_b16 v[114:115], v4 offset:704
    buffer_load_dwordx4 v7, s[4:7], s23 offen offset:2080 nt lds
    v_mfma_f32_16x16x32_bf16 v[180:183], v[116:119], v[92:95], v[180:183]
    v_mfma_f32_16x16x32_bf16 v[184:187], v[116:119], v[96:99], v[184:187]
    v_mfma_f32_16x16x32_bf16 v[188:191], v[116:119], v[100:103], v[188:191]
    s_waitcnt lgkmcnt(4)
    ds_read_b64_tr_b16 v[116:117], v4 offset:224
    v_mfma_f32_16x16x32_bf16 v[192:195], v[104:107], v[88:91], v[192:195]
    ds_read_b64_tr_b16 v[118:119], v4 offset:736
    v_mfma_f32_16x16x32_bf16 v[196:199], v[104:107], v[92:95], v[196:199]
    v_mfma_f32_16x16x32_bf16 v[200:203], v[104:107], v[96:99], v[200:203]
    v_mfma_f32_16x16x32_bf16 v[204:207], v[104:107], v[100:103], v[204:207]
    s_waitcnt lgkmcnt(4)
    ds_read_b64_tr_b16 v[104:105], v4 offset:256
    buffer_load_dwordx4 v8, s[4:7], s23 offen offset:3120 nt lds
    s_add_u32 s23, s23, 0x4000
    v_mfma_f32_16x16x32_bf16 v[208:211], v[108:111], v[88:91], v[208:211]
    ds_read_b64_tr_b16 v[106:107], v4 offset:768
    v_mfma_f32_16x16x32_bf16 v[212:215], v[108:111], v[92:95], v[212:215]
    v_mfma_f32_16x16x32_bf16 v[216:219], v[108:111], v[96:99], v[216:219]
    v_mfma_f32_16x16x32_bf16 v[220:223], v[108:111], v[100:103], v[220:223]
    s_waitcnt lgkmcnt(4)
    ds_read_b64_tr_b16 v[108:109], v4 offset:288
    v_mfma_f32_16x16x32_bf16 v[224:227], v[112:115], v[88:91], v[224:227]
    ds_read_b64_tr_b16 v[110:111], v4 offset:800
    v_mfma_f32_16x16x32_bf16 v[228:231], v[112:115], v[92:95], v[228:231]
    v_mfma_f32_16x16x32_bf16 v[232:235], v[112:115], v[96:99], v[232:235]
    s_add_u32 m0, s29, s30
    s_add_u32 s29, s29, s38
    s_sub_u32 s31, s29, s39
    s_min_u32 s29, s29, s31
    buffer_load_dwordx4 v5, s[8:11], s24 offen offset:0 nt lds
    v_mfma_f32_16x16x32_bf16 v[236:239], v[112:115], v[100:103], v[236:239]
    s_waitcnt lgkmcnt(4)
    ds_read_b64_tr_b16 v[112:113], v4 offset:320
    v_mfma_f32_16x16x32_bf16 v[240:243], v[116:119], v[88:91], v[240:243]
    ds_read_b64_tr_b16 v[114:115], v4 offset:832
    v_mfma_f32_16x16x32_bf16 v[244:247], v[116:119], v[92:95], v[244:247]
    v_mfma_f32_16x16x32_bf16 v[248:251], v[116:119], v[96:99], v[248:251]
    v_mfma_f32_16x16x32_bf16 v[252:255], v[116:119], v[100:103], v[252:255]
    s_waitcnt lgkmcnt(4)
    ds_read_b64_tr_b16 v[116:117], v4 offset:352
    v_mfma_f32_16x16x32_bf16 a[128:131], v[104:107], v[88:91], a[128:131]
    ds_read_b64_tr_b16 v[118:119], v4 offset:864
    v_mfma_f32_16x16x32_bf16 a[132:135], v[104:107], v[92:95], a[132:135]
    buffer_load_dwordx4 v6, s[8:11], s24 offen offset:1040 nt lds
    v_mfma_f32_16x16x32_bf16 a[136:139], v[104:107], v[96:99], a[136:139]
    v_mfma_f32_16x16x32_bf16 a[140:143], v[104:107], v[100:103], a[140:143]
    s_waitcnt lgkmcnt(4)
    ds_read_b64_tr_b16 v[104:105], v4 offset:384
    v_mfma_f32_16x16x32_bf16 a[144:147], v[108:111], v[88:91], a[144:147]
    ds_read_b64_tr_b16 v[106:107], v4 offset:896
    v_mfma_f32_16x16x32_bf16 a[148:151], v[108:111], v[92:95], a[148:151]
    v_mfma_f32_16x16x32_bf16 a[152:155], v[108:111], v[96:99], a[152:155]
    v_mfma_f32_16x16x32_bf16 a[156:159], v[108:111], v[100:103], a[156:159]
    s_waitcnt lgkmcnt(4)
    ds_read_b64_tr_b16 v[108:109], v4 offset:416
    v_mfma_f32_16x16x32_bf16 a[160:163], v[112:115], v[88:91], a[160:163]
    ds_read_b64_tr_b16 v[110:111], v4 offset:928
    buffer_load_dwordx4 v7, s[8:11], s24 offen offset:2080 nt lds
    v_mfma_f32_16x16x32_bf16 a[164:167], v[112:115], v[92:95], a[164:167]
    v_mfma_f32_16x16x32_bf16 a[168:171], v[112:115], v[96:99], a[168:171]
    v_mfma_f32_16x16x32_bf16 a[172:175], v[112:115], v[100:103], a[172:175]
    s_waitcnt lgkmcnt(4)
    ds_read_b64_tr_b16 v[112:113], v4 offset:448
    v_mfma_f32_16x16x32_bf16 a[176:179], v[116:119], v[88:91], a[176:179]
    ds_read_b64_tr_b16 v[114:115], v4 offset:960
    v_mfma_f32_16x16x32_bf16 a[180:183], v[116:119], v[92:95], a[180:183]
    v_mfma_f32_16x16x32_bf16 a[184:187], v[116:119], v[96:99], a[184:187]
    v_mfma_f32_16x16x32_bf16 a[188:191], v[116:119], v[100:103], a[188:191]
    s_waitcnt lgkmcnt(4)
    ds_read_b64_tr_b16 v[116:117], v4 offset:480
    buffer_load_dwordx4 v8, s[8:11], s24 offen offset:3120 nt lds
    s_add_u32 s24, s24, 0x4000
    v_mfma_f32_16x16x32_bf16 a[192:195], v[104:107], v[88:91], a[192:195]
    ds_read_b64_tr_b16 v[118:119], v4 offset:992
    v_mfma_f32_16x16x32_bf16 a[196:199], v[104:107], v[92:95], a[196:199]
    v_mfma_f32_16x16x32_bf16 a[200:203], v[104:107], v[96:99], a[200:203]
    v_mfma_f32_16x16x32_bf16 a[204:207], v[104:107], v[100:103], a[204:207]
    s_waitcnt lgkmcnt(4)
    v_mfma_f32_16x16x32_bf16 a[208:211], v[108:111], v[88:91], a[208:211]
    v_mfma_f32_16x16x32_bf16 a[212:215], v[108:111], v[92:95], a[212:215]
    v_mfma_f32_16x16x32_bf16 a[216:219], v[108:111], v[96:99], a[216:219]
    v_mfma_f32_16x16x32_bf16 a[220:223], v[108:111], v[100:103], a[220:223]
    s_waitcnt lgkmcnt(2)
    v_mfma_f32_16x16x32_bf16 a[224:227], v[112:115], v[88:91], a[224:227]
    v_mfma_f32_16x16x32_bf16 a[228:231], v[112:115], v[92:95], a[228:231]
    v_mfma_f32_16x16x32_bf16 a[232:235], v[112:115], v[96:99], a[232:235]
    v_mfma_f32_16x16x32_bf16 a[236:239], v[112:115], v[100:103], a[236:239]
    s_waitcnt lgkmcnt(0)
    v_mfma_f32_16x16x32_bf16 a[240:243], v[116:119], v[88:91], a[240:243]
    v_mfma_f32_16x16x32_bf16 a[244:247], v[116:119], v[92:95], a[244:247]
    v_mfma_f32_16x16x32_bf16 a[248:251], v[116:119], v[96:99], a[248:251]
    v_mfma_f32_16x16x32_bf16 a[252:255], v[116:119], v[100:103], a[252:255]
    s_mov_b32 s22, 1
    s_nop 7
    s_add_u32 m0, s29, s30
    s_add_u32 s29, s29, s38
    s_sub_u32 s31, s29, s39
    s_min_u32 s29, s29, s31
    buffer_load_dwordx4 v5, s[12:15], s25 offen offset:0 nt lds
    v_add_u32 v3, s28, v1
    ds_read_b128 v[104:107], v3 offset:0
    ds_read_b128 v[108:111], v3 offset:16
    ds_read_b128 v[112:115], v3 offset:32
    ds_read_b128 v[116:119], v3 offset:48
    s_waitcnt lgkmcnt(3)
    v_mfma_f32_16x16x32_bf16 v[24:27], v[104:107], a[0:3], 0
    v_mfma_f32_16x16x32_bf16 v[32:35], v[104:107], a[32:35], 0
    s_waitcnt lgkmcnt(2)
    ds_read_b128 v[104:107], v3 offset:256
    v_mfma_f32_16x16x32_bf16 v[24:27], v[108:111], a[4:7], v[24:27]
    v_mfma_f32_16x16x32_bf16 v[32:35], v[108:111], a[36:39], v[32:35]
    s_waitcnt lgkmcnt(2)
    buffer_load_dwordx4 v6, s[12:15], s25 offen offset:1040 nt lds
    ds_read_b128 v[108:111], v3 offset:272
    v_mfma_f32_16x16x32_bf16 v[24:27], v[112:115], a[8:11], v[24:27]
    v_mfma_f32_16x16x32_bf16 v[32:35], v[112:115], a[40:43], v[32:35]
    s_waitcnt lgkmcnt(2)
    ds_read_b128 v[112:115], v3 offset:288
    v_mfma_f32_16x16x32_bf16 v[24:27], v[116:119], a[12:15], v[24:27]
    v_mfma_f32_16x16x32_bf16 v[32:35], v[116:119], a[44:47], v[32:35]
    s_waitcnt lgkmcnt(2)
    buffer_load_dwordx4 v7, s[12:15], s25 offen offset:2080 nt lds
    ds_read_b128 v[116:119], v3 offset:304
    v_mfma_f32_16x16x32_bf16 v[24:27], v[104:107], a[16:19], v[24:27]
    v_mfma_f32_16x16x32_bf16 v[32:35], v[104:107], a[48:51], v[32:35]
    s_waitcnt lgkmcnt(2)
    ds_read_b128 v[104:107], v3 offset:512
    v_mfma_f32_16x16x32_bf16 v[24:27], v[108:111], a[20:23], v[24:27]
    v_mfma_f32_16x16x32_bf16 v[32:35], v[108:111], a[52:55], v[32:35]
    s_waitcnt lgkmcnt(2)
    ds_read_b128 v[108:111], v3 offset:528
    buffer_load_dwordx4 v8, s[12:15], s25 offen offset:3120 nt lds
    s_add_u32 s25, s25, 0x4000
    v_mfma_f32_16x16x32_bf16 v[24:27], v[112:115], a[24:27], v[24:27]
    v_mfma_f32_16x16x32_bf16 v[32:35], v[112:115], a[56:59], v[32:35]
    s_waitcnt lgkmcnt(2)
    ds_read_b128 v[112:115], v3 offset:544
    v_mfma_f32_16x16x32_bf16 v[24:27], v[116:119], a[28:31], v[24:27]
    v_mfma_f32_16x16x32_bf16 v[32:35], v[116:119], a[60:63], v[32:35]
    s_waitcnt lgkmcnt(2)
    ds_read_b128 v[116:119], v3 offset:560
    v_mfma_f32_16x16x32_bf16 v[28:31], v[104:107], a[0:3], 0
    s_add_u32 m0, s29, s30
    s_add_u32 s29, s29, s38
    s_sub_u32 s31, s29, s39
    s_min_u32 s29, s29, s31
    buffer_load_dwordx4 v5, s[8:11], s24 offen offset:0 nt lds
    v_mfma_f32_16x16x32_bf16 v[36:39], v[104:107], a[32:35], 0
    s_waitcnt lgkmcnt(2)
    ds_read_b128 v[104:107], v3 offset:768
    v_mfma_f32_16x16x32_bf16 v[28:31], v[108:111], a[4:7], v[28:31]
    v_mfma_f32_16x16x32_bf16 v[36:39], v[108:111], a[36:39], v[36:39]
    s_waitcnt lgkmcnt(2)
    ds_read_b128 v[108:111], v3 offset:784
    v_mfma_f32_16x16x32_bf16 v[28:31], v[112:115], a[8:11], v[28:31]
    buffer_load_dwordx4 v6, s[8:11], s24 offen offset:1040 nt lds
    v_mfma_f32_16x16x32_bf16 v[36:39], v[112:115], a[40:43], v[36:39]
    s_waitcnt lgkmcnt(2)
    ds_read_b128 v[112:115], v3 offset:800
    v_mfma_f32_16x16x32_bf16 v[28:31], v[116:119], a[12:15], v[28:31]
    v_mfma_f32_16x16x32_bf16 v[36:39], v[116:119], a[44:47], v[36:39]
    s_waitcnt lgkmcnt(2)
    ds_read_b128 v[116:119], v3 offset:816
    v_mfma_f32_16x16x32_bf16 v[28:31], v[104:107], a[16:19], v[28:31]
    buffer_load_dwordx4 v7, s[8:11], s24 offen offset:2080 nt lds
    v_mfma_f32_16x16x32_bf16 v[36:39], v[104:107], a[48:51], v[36:39]
    s_waitcnt lgkmcnt(2)
    v_mfma_f32_16x16x32_bf16 v[28:31], v[108:111], a[20:23], v[28:31]
    v_mfma_f32_16x16x32_bf16 v[36:39], v[108:111], a[52:55], v[36:39]
    s_waitcnt lgkmcnt(1)
    v_mfma_f32_16x16x32_bf16 v[28:31], v[112:115], a[24:27], v[28:31]
    v_mfma_f32_16x16x32_bf16 v[36:39], v[112:115], a[56:59], v[36:39]
    s_waitcnt lgkmcnt(0)
    buffer_load_dwordx4 v8, s[8:11], s24 offen offset:3120 nt lds
    s_add_u32 s24, s24, 0x4000
    v_mfma_f32_16x16x32_bf16 v[28:31], v[116:119], a[28:31], v[28:31]
    v_mfma_f32_16x16x32_bf16 v[36:39], v[116:119], a[60:63], v[36:39]
    v_mov_b32 v56, v16
    v_mov_b32 v57, v16
    v_mov_b32 v58, v17
    v_mov_b32 v59, v17
    v_mov_b32 v60, v18
    v_mov_b32 v61, v18
    v_mov_b32 v62, v19
    v_mov_b32 v63, v19
    s_nop 1
    v_permlane16_swap_b32 v56, v57
    v_permlane16_swap_b32 v58, v59
    v_permlane16_swap_b32 v60, v61
    v_permlane16_swap_b32 v62, v63
    v_add_f32 v56, v56, v57
    v_add_f32 v58, v58, v59
    v_add_f32 v60, v60, v61
    v_add_f32 v62, v62, v63
    v_mov_b32 v57, v56
    v_mov_b32 v59, v58
    v_mov_b32 v61, v60
    v_mov_b32 v63, v62
    s_nop 1
    v_permlane32_swap_b32 v56, v57
    v_permlane32_swap_b32 v58, v59
    v_permlane32_swap_b32 v60, v61
    v_permlane32_swap_b32 v62, v63
    v_add_f32 v56, v56, v57
    v_add_f32 v58, v58, v59
    v_add_f32 v60, v60, v61
    v_add_f32 v62, v62, v63
    v_rcp_f32 v56, v56
    v_rcp_f32 v58, v58
    v_rcp_f32 v60, v60
    v_rcp_f32 v62, v62
    s_nop 1
    v_accvgpr_read_b32 v64, a128
    v_accvgpr_read_b32 v65, a129
    v_accvgpr_read_b32 v66, a130
    v_accvgpr_read_b32 v67, a131
    v_accvgpr_read_b32 v68, a144
    v_accvgpr_read_b32 v69, a145
    v_accvgpr_read_b32 v70, a146
    v_accvgpr_read_b32 v71, a147
    v_accvgpr_read_b32 v72, a160
    v_accvgpr_read_b32 v73, a161
    v_accvgpr_read_b32 v74, a162
    v_accvgpr_read_b32 v75, a163
    v_accvgpr_read_b32 v76, a176
    v_accvgpr_read_b32 v77, a177
    v_accvgpr_read_b32 v78, a178
    v_accvgpr_read_b32 v79, a179
    v_pk_mul_f32 v[64:65], v[64:65], v[56:57] op_sel_hi:[1,0]
    v_pk_mul_f32 v[66:67], v[66:67], v[56:57] op_sel_hi:[1,0]
    v_pk_mul_f32 v[68:69], v[68:69], v[56:57] op_sel_hi:[1,0]
    v_pk_mul_f32 v[70:71], v[70:71], v[56:57] op_sel_hi:[1,0]
    v_pk_mul_f32 v[72:73], v[72:73], v[56:57] op_sel_hi:[1,0]
    v_pk_mul_f32 v[74:75], v[74:75], v[56:57] op_sel_hi:[1,0]
    v_pk_mul_f32 v[76:77], v[76:77], v[56:57] op_sel_hi:[1,0]
    v_pk_mul_f32 v[78:79], v[78:79], v[56:57] op_sel_hi:[1,0]
    v_cvt_pk_bf16_f32 v80, v64, v65
    v_cvt_pk_bf16_f32 v81, v66, v67
    v_cvt_pk_bf16_f32 v82, v68, v69
    v_cvt_pk_bf16_f32 v83, v70, v71
    v_cvt_pk_bf16_f32 v84, v72, v73
    v_cvt_pk_bf16_f32 v85, v74, v75
    v_cvt_pk_bf16_f32 v86, v76, v77
    v_cvt_pk_bf16_f32 v87, v78, v79
    v_permlane16_swap_b32 v80, v82
    v_permlane16_swap_b32 v81, v83
    v_permlane16_swap_b32 v84, v86
    v_permlane16_swap_b32 v85, v87
    v_accvgpr_read_b32 v64, a132
    v_accvgpr_read_b32 v65, a133
    v_accvgpr_read_b32 v66, a134
    v_accvgpr_read_b32 v67, a135
    v_accvgpr_read_b32 v68, a148
    v_accvgpr_read_b32 v69, a149
    ds_write_b128 v120, v[80:83]
    v_accvgpr_read_b32 v70, a150
    v_accvgpr_read_b32 v71, a151
    v_accvgpr_read_b32 v72, a164
    v_accvgpr_read_b32 v73, a165
    v_accvgpr_read_b32 v74, a166
    v_accvgpr_read_b32 v75, a167
    ds_write_b128 v121, v[84:87]
    v_accvgpr_read_b32 v76, a180
    v_accvgpr_read_b32 v77, a181
    v_accvgpr_read_b32 v78, a182
    v_accvgpr_read_b32 v79, a183
    v_pk_mul_f32 v[64:65], v[64:65], v[58:59] op_sel_hi:[1,0]
    v_pk_mul_f32 v[66:67], v[66:67], v[58:59] op_sel_hi:[1,0]
    v_pk_mul_f32 v[68:69], v[68:69], v[58:59] op_sel_hi:[1,0]
    ds_read_b128 a[128:131], v11
    v_pk_mul_f32 v[70:71], v[70:71], v[58:59] op_sel_hi:[1,0]
    v_pk_mul_f32 v[72:73], v[72:73], v[58:59] op_sel_hi:[1,0]
    v_pk_mul_f32 v[74:75], v[74:75], v[58:59] op_sel_hi:[1,0]
    v_pk_mul_f32 v[76:77], v[76:77], v[58:59] op_sel_hi:[1,0]
    v_pk_mul_f32 v[78:79], v[78:79], v[58:59] op_sel_hi:[1,0]
    v_cvt_pk_bf16_f32 v104, v64, v65
    ds_read_b128 a[144:147], v122
    v_cvt_pk_bf16_f32 v105, v66, v67
    v_cvt_pk_bf16_f32 v106, v68, v69
    v_cvt_pk_bf16_f32 v107, v70, v71
    v_cvt_pk_bf16_f32 v108, v72, v73
    v_cvt_pk_bf16_f32 v109, v74, v75
    v_cvt_pk_bf16_f32 v110, v76, v77
    v_cvt_pk_bf16_f32 v111, v78, v79
    v_permlane16_swap_b32 v104, v106
    v_permlane16_swap_b32 v105, v107
    v_permlane16_swap_b32 v108, v110
    v_permlane16_swap_b32 v109, v111
    v_accvgpr_read_b32 v64, a136
    v_accvgpr_read_b32 v65, a137
    v_accvgpr_read_b32 v66, a138
    v_accvgpr_read_b32 v67, a139
    v_accvgpr_read_b32 v68, a152
    v_accvgpr_read_b32 v69, a153
    ds_write_b128 v120, v[104:107]
    v_accvgpr_read_b32 v70, a154
    v_accvgpr_read_b32 v71, a155
    v_accvgpr_read_b32 v72, a168
    v_accvgpr_read_b32 v73, a169
    v_accvgpr_read_b32 v74, a170
    v_accvgpr_read_b32 v75, a171
    ds_write_b128 v121, v[108:111]
    v_accvgpr_read_b32 v76, a184
    v_accvgpr_read_b32 v77, a185
    v_accvgpr_read_b32 v78, a186
    v_accvgpr_read_b32 v79, a187
    v_pk_mul_f32 v[64:65], v[64:65], v[60:61] op_sel_hi:[1,0]
    v_pk_mul_f32 v[66:67], v[66:67], v[60:61] op_sel_hi:[1,0]
    v_pk_mul_f32 v[68:69], v[68:69], v[60:61] op_sel_hi:[1,0]
    ds_read_b128 a[132:135], v11
    v_pk_mul_f32 v[70:71], v[70:71], v[60:61] op_sel_hi:[1,0]
    v_pk_mul_f32 v[72:73], v[72:73], v[60:61] op_sel_hi:[1,0]
    v_pk_mul_f32 v[74:75], v[74:75], v[60:61] op_sel_hi:[1,0]
    v_pk_mul_f32 v[76:77], v[76:77], v[60:61] op_sel_hi:[1,0]
    v_pk_mul_f32 v[78:79], v[78:79], v[60:61] op_sel_hi:[1,0]
    v_cvt_pk_bf16_f32 v112, v64, v65
    ds_read_b128 a[148:151], v122
    v_cvt_pk_bf16_f32 v113, v66, v67
    v_cvt_pk_bf16_f32 v114, v68, v69
    v_cvt_pk_bf16_f32 v115, v70, v71
    v_cvt_pk_bf16_f32 v116, v72, v73
    v_cvt_pk_bf16_f32 v117, v74, v75
    v_cvt_pk_bf16_f32 v118, v76, v77
    v_cvt_pk_bf16_f32 v119, v78, v79
    s_waitcnt lgkmcnt(5)
    buffer_store_dwordx4 a[128:131], v9, s[16:19], s76 offen offset:256 sc0 sc1
    v_permlane16_swap_b32 v112, v114
    v_permlane16_swap_b32 v113, v115
    v_permlane16_swap_b32 v116, v118
    v_permlane16_swap_b32 v117, v119
    v_accvgpr_read_b32 v64, a140
    v_accvgpr_read_b32 v65, a141
    v_accvgpr_read_b32 v66, a142
    v_accvgpr_read_b32 v67, a143
    v_accvgpr_read_b32 v68, a156
    v_accvgpr_read_b32 v69, a157
    ds_write_b128 v120, v[112:115]
    v_accvgpr_read_b32 v70, a158
    v_accvgpr_read_b32 v71, a159
    v_accvgpr_read_b32 v72, a172
    v_accvgpr_read_b32 v73, a173
    v_accvgpr_read_b32 v74, a174
    v_accvgpr_read_b32 v75, a175
    ds_write_b128 v121, v[116:119]
    v_accvgpr_read_b32 v76, a188
    v_accvgpr_read_b32 v77, a189
    v_accvgpr_read_b32 v78, a190
    v_accvgpr_read_b32 v79, a191
    v_pk_mul_f32 v[64:65], v[64:65], v[62:63] op_sel_hi:[1,0]
    s_waitcnt lgkmcnt(6)
    buffer_store_dwordx4 a[144:147], v10, s[16:19], s76 offen offset:256 sc0 sc1
    v_pk_mul_f32 v[66:67], v[66:67], v[62:63] op_sel_hi:[1,0]
    v_pk_mul_f32 v[68:69], v[68:69], v[62:63] op_sel_hi:[1,0]
    ds_read_b128 a[136:139], v11
    v_pk_mul_f32 v[70:71], v[70:71], v[62:63] op_sel_hi:[1,0]
    v_pk_mul_f32 v[72:73], v[72:73], v[62:63] op_sel_hi:[1,0]
    v_pk_mul_f32 v[74:75], v[74:75], v[62:63] op_sel_hi:[1,0]
    v_pk_mul_f32 v[76:77], v[76:77], v[62:63] op_sel_hi:[1,0]
    v_pk_mul_f32 v[78:79], v[78:79], v[62:63] op_sel_hi:[1,0]
    v_cvt_pk_bf16_f32 v80, v64, v65
    ds_read_b128 a[152:155], v122
    v_cvt_pk_bf16_f32 v81, v66, v67
    v_cvt_pk_bf16_f32 v82, v68, v69
    v_cvt_pk_bf16_f32 v83, v70, v71
    v_cvt_pk_bf16_f32 v84, v72, v73
    v_cvt_pk_bf16_f32 v85, v74, v75
    v_cvt_pk_bf16_f32 v86, v76, v77
    v_cvt_pk_bf16_f32 v87, v78, v79
    s_waitcnt lgkmcnt(5)
    buffer_store_dwordx4 a[132:135], v9, s[16:19], s77 offen offset:256 sc0 sc1
    v_permlane16_swap_b32 v80, v82
    v_permlane16_swap_b32 v81, v83
    v_permlane16_swap_b32 v84, v86
    v_permlane16_swap_b32 v85, v87
    v_accvgpr_read_b32 v64, a192
    v_accvgpr_read_b32 v65, a193
    v_accvgpr_read_b32 v66, a194
    v_accvgpr_read_b32 v67, a195
    v_accvgpr_read_b32 v68, a208
    v_accvgpr_read_b32 v69, a209
    ds_write_b128 v120, v[80:83]
    v_accvgpr_read_b32 v70, a210
    v_accvgpr_read_b32 v71, a211
    v_accvgpr_read_b32 v72, a224
    v_accvgpr_read_b32 v73, a225
    v_accvgpr_read_b32 v74, a226
    v_accvgpr_read_b32 v75, a227
    ds_write_b128 v121, v[84:87]
    v_accvgpr_read_b32 v76, a240
    v_accvgpr_read_b32 v77, a241
    v_accvgpr_read_b32 v78, a242
    v_accvgpr_read_b32 v79, a243
    v_pk_mul_f32 v[64:65], v[64:65], v[56:57] op_sel_hi:[1,0]
    s_waitcnt lgkmcnt(6)
    buffer_store_dwordx4 a[148:151], v10, s[16:19], s77 offen offset:256 sc0 sc1
    v_pk_mul_f32 v[66:67], v[66:67], v[56:57] op_sel_hi:[1,0]
    v_pk_mul_f32 v[68:69], v[68:69], v[56:57] op_sel_hi:[1,0]
    ds_read_b128 a[140:143], v11
    v_pk_mul_f32 v[70:71], v[70:71], v[56:57] op_sel_hi:[1,0]
    v_pk_mul_f32 v[72:73], v[72:73], v[56:57] op_sel_hi:[1,0]
    v_pk_mul_f32 v[74:75], v[74:75], v[56:57] op_sel_hi:[1,0]
    v_pk_mul_f32 v[76:77], v[76:77], v[56:57] op_sel_hi:[1,0]
    v_pk_mul_f32 v[78:79], v[78:79], v[56:57] op_sel_hi:[1,0]
    v_cvt_pk_bf16_f32 v104, v64, v65
    ds_read_b128 a[156:159], v122
    v_cvt_pk_bf16_f32 v105, v66, v67
    v_cvt_pk_bf16_f32 v106, v68, v69
    v_cvt_pk_bf16_f32 v107, v70, v71
    v_cvt_pk_bf16_f32 v108, v72, v73
    v_cvt_pk_bf16_f32 v109, v74, v75
    v_cvt_pk_bf16_f32 v110, v76, v77
    v_cvt_pk_bf16_f32 v111, v78, v79
    v_permlane16_swap_b32 v104, v106
    v_permlane16_swap_b32 v105, v107
    v_permlane16_swap_b32 v108, v110
    v_permlane16_swap_b32 v109, v111
    v_accvgpr_read_b32 v64, a196
    v_accvgpr_read_b32 v65, a197
    v_accvgpr_read_b32 v66, a198
    v_accvgpr_read_b32 v67, a199
    v_accvgpr_read_b32 v68, a212
    v_accvgpr_read_b32 v69, a213
    ds_write_b128 v120, v[104:107]
    v_accvgpr_read_b32 v70, a214
    v_accvgpr_read_b32 v71, a215
    v_accvgpr_read_b32 v72, a228
    v_accvgpr_read_b32 v73, a229
    v_accvgpr_read_b32 v74, a230
    v_accvgpr_read_b32 v75, a231
    ds_write_b128 v121, v[108:111]
    v_accvgpr_read_b32 v76, a244
    v_accvgpr_read_b32 v77, a245
    v_accvgpr_read_b32 v78, a246
    v_accvgpr_read_b32 v79, a247
    v_pk_mul_f32 v[64:65], v[64:65], v[58:59] op_sel_hi:[1,0]
    v_pk_mul_f32 v[66:67], v[66:67], v[58:59] op_sel_hi:[1,0]
    v_pk_mul_f32 v[68:69], v[68:69], v[58:59] op_sel_hi:[1,0]
    ds_read_b128 a[160:163], v11
    v_pk_mul_f32 v[70:71], v[70:71], v[58:59] op_sel_hi:[1,0]
    v_pk_mul_f32 v[72:73], v[72:73], v[58:59] op_sel_hi:[1,0]
    v_pk_mul_f32 v[74:75], v[74:75], v[58:59] op_sel_hi:[1,0]
    v_pk_mul_f32 v[76:77], v[76:77], v[58:59] op_sel_hi:[1,0]
    v_pk_mul_f32 v[78:79], v[78:79], v[58:59] op_sel_hi:[1,0]
    v_cvt_pk_bf16_f32 v112, v64, v65
    ds_read_b128 a[176:179], v122
    v_cvt_pk_bf16_f32 v113, v66, v67
    v_cvt_pk_bf16_f32 v114, v68, v69
    v_cvt_pk_bf16_f32 v115, v70, v71
    v_cvt_pk_bf16_f32 v116, v72, v73
    v_cvt_pk_bf16_f32 v117, v74, v75
    v_cvt_pk_bf16_f32 v118, v76, v77
    v_cvt_pk_bf16_f32 v119, v78, v79
    v_permlane16_swap_b32 v112, v114
    v_permlane16_swap_b32 v113, v115
    v_permlane16_swap_b32 v116, v118
    v_permlane16_swap_b32 v117, v119
    v_accvgpr_read_b32 v64, a200
    v_accvgpr_read_b32 v65, a201
    v_accvgpr_read_b32 v66, a202
    v_accvgpr_read_b32 v67, a203
    v_accvgpr_read_b32 v68, a216
    v_accvgpr_read_b32 v69, a217
    ds_write_b128 v120, v[112:115]
    v_accvgpr_read_b32 v70, a218
    v_accvgpr_read_b32 v71, a219
    v_accvgpr_read_b32 v72, a232
    v_accvgpr_read_b32 v73, a233
    v_accvgpr_read_b32 v74, a234
    v_accvgpr_read_b32 v75, a235
    ds_write_b128 v121, v[116:119]
    v_accvgpr_read_b32 v76, a248
    v_accvgpr_read_b32 v77, a249
    v_accvgpr_read_b32 v78, a250
    v_accvgpr_read_b32 v79, a251
    v_pk_mul_f32 v[64:65], v[64:65], v[60:61] op_sel_hi:[1,0]
    v_pk_mul_f32 v[66:67], v[66:67], v[60:61] op_sel_hi:[1,0]
    v_pk_mul_f32 v[68:69], v[68:69], v[60:61] op_sel_hi:[1,0]
    ds_read_b128 a[164:167], v11
    v_pk_mul_f32 v[70:71], v[70:71], v[60:61] op_sel_hi:[1,0]
    v_pk_mul_f32 v[72:73], v[72:73], v[60:61] op_sel_hi:[1,0]
    v_pk_mul_f32 v[74:75], v[74:75], v[60:61] op_sel_hi:[1,0]
    s_waitcnt lgkmcnt(12)
    buffer_store_dwordx4 a[136:139], v9, s[16:19], s78 offen offset:256 sc0 sc1
    v_pk_mul_f32 v[76:77], v[76:77], v[60:61] op_sel_hi:[1,0]
    v_pk_mul_f32 v[78:79], v[78:79], v[60:61] op_sel_hi:[1,0]
    v_cvt_pk_bf16_f32 v80, v64, v65
    ds_read_b128 a[180:183], v122
    v_cvt_pk_bf16_f32 v81, v66, v67
    v_cvt_pk_bf16_f32 v82, v68, v69
    v_cvt_pk_bf16_f32 v83, v70, v71
    v_cvt_pk_bf16_f32 v84, v72, v73
    v_cvt_pk_bf16_f32 v85, v74, v75
    v_cvt_pk_bf16_f32 v86, v76, v77
    v_cvt_pk_bf16_f32 v87, v78, v79
    v_permlane16_swap_b32 v80, v82
    v_permlane16_swap_b32 v81, v83
    v_permlane16_swap_b32 v84, v86
    v_permlane16_swap_b32 v85, v87
    v_accvgpr_read_b32 v64, a204
    v_accvgpr_read_b32 v65, a205
    v_accvgpr_read_b32 v66, a206
    v_accvgpr_read_b32 v67, a207
    v_accvgpr_read_b32 v68, a220
    v_accvgpr_read_b32 v69, a221
    ds_write_b128 v120, v[80:83]
    s_waitcnt lgkmcnt(13)
    buffer_store_dwordx4 a[152:155], v10, s[16:19], s78 offen offset:256 sc0 sc1
    v_accvgpr_read_b32 v70, a222
    v_accvgpr_read_b32 v71, a223
    v_accvgpr_read_b32 v72, a236
    v_accvgpr_read_b32 v73, a237
    v_accvgpr_read_b32 v74, a238
    v_accvgpr_read_b32 v75, a239
    ds_write_b128 v121, v[84:87]
    v_accvgpr_read_b32 v76, a252
    v_accvgpr_read_b32 v77, a253
    v_accvgpr_read_b32 v78, a254
    v_accvgpr_read_b32 v79, a255
    v_pk_mul_f32 v[64:65], v[64:65], v[62:63] op_sel_hi:[1,0]
    v_pk_mul_f32 v[66:67], v[66:67], v[62:63] op_sel_hi:[1,0]
    v_pk_mul_f32 v[68:69], v[68:69], v[62:63] op_sel_hi:[1,0]
    ds_read_b128 a[168:171], v11
    v_pk_mul_f32 v[70:71], v[70:71], v[62:63] op_sel_hi:[1,0]
    v_pk_mul_f32 v[72:73], v[72:73], v[62:63] op_sel_hi:[1,0]
    v_pk_mul_f32 v[74:75], v[74:75], v[62:63] op_sel_hi:[1,0]
    s_waitcnt lgkmcnt(12)
    buffer_store_dwordx4 a[140:143], v9, s[16:19], s79 offen offset:256 sc0 sc1
    v_pk_mul_f32 v[76:77], v[76:77], v[62:63] op_sel_hi:[1,0]
    v_pk_mul_f32 v[78:79], v[78:79], v[62:63] op_sel_hi:[1,0]
    v_cvt_pk_bf16_f32 v104, v64, v65
    ds_read_b128 a[184:187], v122
    v_cvt_pk_bf16_f32 v105, v66, v67
    v_cvt_pk_bf16_f32 v106, v68, v69
    v_cvt_pk_bf16_f32 v107, v70, v71
    v_cvt_pk_bf16_f32 v108, v72, v73
    v_cvt_pk_bf16_f32 v109, v74, v75
    v_cvt_pk_bf16_f32 v110, v76, v77
    v_cvt_pk_bf16_f32 v111, v78, v79
    v_permlane16_swap_b32 v104, v106
    v_permlane16_swap_b32 v105, v107
    v_permlane16_swap_b32 v108, v110
    v_permlane16_swap_b32 v109, v111
    v_pk_mul_f32 v[128:129], v[128:129], v[56:57] op_sel_hi:[1,0]
    v_pk_mul_f32 v[130:131], v[130:131], v[56:57] op_sel_hi:[1,0]
    v_pk_mul_f32 v[144:145], v[144:145], v[56:57] op_sel_hi:[1,0]
    ds_write_b128 v120, v[104:107]
    s_waitcnt lgkmcnt(13)
    buffer_store_dwordx4 a[156:159], v10, s[16:19], s79 offen offset:256 sc0 sc1
    v_pk_mul_f32 v[146:147], v[146:147], v[56:57] op_sel_hi:[1,0]
    v_pk_mul_f32 v[160:161], v[160:161], v[56:57] op_sel_hi:[1,0]
    v_pk_mul_f32 v[162:163], v[162:163], v[56:57] op_sel_hi:[1,0]
    ds_write_b128 v121, v[108:111]
    v_pk_mul_f32 v[176:177], v[176:177], v[56:57] op_sel_hi:[1,0]
    v_pk_mul_f32 v[178:179], v[178:179], v[56:57] op_sel_hi:[1,0]
    v_cvt_pk_bf16_f32 v112, v128, v129
    ds_read_b128 a[172:175], v11
    v_cvt_pk_bf16_f32 v113, v130, v131
    v_cvt_pk_bf16_f32 v114, v144, v145
    v_cvt_pk_bf16_f32 v115, v146, v147
    ds_read_b128 a[188:191], v122
    v_cvt_pk_bf16_f32 v116, v160, v161
    v_cvt_pk_bf16_f32 v117, v162, v163
    v_cvt_pk_bf16_f32 v118, v176, v177
    v_cvt_pk_bf16_f32 v119, v178, v179
    v_permlane16_swap_b32 v112, v114
    v_permlane16_swap_b32 v113, v115
    v_permlane16_swap_b32 v116, v118
    s_waitcnt lgkmcnt(13)
    buffer_store_dwordx4 a[160:163], v9, s[16:19], s76 offen offset:384 sc0 sc1
    v_permlane16_swap_b32 v117, v119
    v_pk_mul_f32 v[132:133], v[132:133], v[58:59] op_sel_hi:[1,0]
    v_pk_mul_f32 v[134:135], v[134:135], v[58:59] op_sel_hi:[1,0]
    v_pk_mul_f32 v[148:149], v[148:149], v[58:59] op_sel_hi:[1,0]
    ds_write_b128 v120, v[112:115]
    v_pk_mul_f32 v[150:151], v[150:151], v[58:59] op_sel_hi:[1,0]
    v_pk_mul_f32 v[164:165], v[164:165], v[58:59] op_sel_hi:[1,0]
    v_pk_mul_f32 v[166:167], v[166:167], v[58:59] op_sel_hi:[1,0]
    ds_write_b128 v121, v[116:119]
    v_pk_mul_f32 v[180:181], v[180:181], v[58:59] op_sel_hi:[1,0]
    v_pk_mul_f32 v[182:183], v[182:183], v[58:59] op_sel_hi:[1,0]
    v_cvt_pk_bf16_f32 v80, v132, v133
    ds_read_b128 a[192:195], v11
    v_cvt_pk_bf16_f32 v81, v134, v135
    v_cvt_pk_bf16_f32 v82, v148, v149
    s_waitcnt lgkmcnt(15)
    buffer_store_dwordx4 a[176:179], v10, s[16:19], s76 offen offset:384 sc0 sc1
    v_cvt_pk_bf16_f32 v83, v150, v151
    ds_read_b128 a[208:211], v122
    v_cvt_pk_bf16_f32 v84, v164, v165
    v_cvt_pk_bf16_f32 v85, v166, v167
    v_cvt_pk_bf16_f32 v86, v180, v181
    v_cvt_pk_bf16_f32 v87, v182, v183
    v_permlane16_swap_b32 v80, v82
    v_permlane16_swap_b32 v81, v83
    v_permlane16_swap_b32 v84, v86
    v_permlane16_swap_b32 v85, v87
    v_pk_mul_f32 v[136:137], v[136:137], v[60:61] op_sel_hi:[1,0]
    v_pk_mul_f32 v[138:139], v[138:139], v[60:61] op_sel_hi:[1,0]
    v_pk_mul_f32 v[152:153], v[152:153], v[60:61] op_sel_hi:[1,0]
    ds_write_b128 v120, v[80:83]
    v_pk_mul_f32 v[154:155], v[154:155], v[60:61] op_sel_hi:[1,0]
    v_pk_mul_f32 v[168:169], v[168:169], v[60:61] op_sel_hi:[1,0]
    v_pk_mul_f32 v[170:171], v[170:171], v[60:61] op_sel_hi:[1,0]
    ds_write_b128 v121, v[84:87]
    s_waitcnt lgkmcnt(15)
    buffer_store_dwordx4 a[164:167], v9, s[16:19], s77 offen offset:384 sc0 sc1
    v_pk_mul_f32 v[184:185], v[184:185], v[60:61] op_sel_hi:[1,0]
    v_pk_mul_f32 v[186:187], v[186:187], v[60:61] op_sel_hi:[1,0]
    v_cvt_pk_bf16_f32 v104, v136, v137
    ds_read_b128 a[196:199], v11
    v_cvt_pk_bf16_f32 v105, v138, v139
    v_cvt_pk_bf16_f32 v106, v152, v153
    v_cvt_pk_bf16_f32 v107, v154, v155
    ds_read_b128 a[212:215], v122
    v_cvt_pk_bf16_f32 v108, v168, v169
    v_cvt_pk_bf16_f32 v109, v170, v171
    v_cvt_pk_bf16_f32 v110, v184, v185
    v_cvt_pk_bf16_f32 v111, v186, v187
    v_permlane16_swap_b32 v104, v106
    v_permlane16_swap_b32 v105, v107
    v_permlane16_swap_b32 v108, v110
    v_permlane16_swap_b32 v109, v111
    v_pk_mul_f32 v[140:141], v[140:141], v[62:63] op_sel_hi:[1,0]
    v_pk_mul_f32 v[142:143], v[142:143], v[62:63] op_sel_hi:[1,0]
    v_pk_mul_f32 v[156:157], v[156:157], v[62:63] op_sel_hi:[1,0]
    s_waitcnt lgkmcnt(15)
    buffer_store_dwordx4 a[180:183], v10, s[16:19], s77 offen offset:384 sc0 sc1
    ds_write_b128 v120, v[104:107]
    v_pk_mul_f32 v[158:159], v[158:159], v[62:63] op_sel_hi:[1,0]
    v_pk_mul_f32 v[172:173], v[172:173], v[62:63] op_sel_hi:[1,0]
    v_pk_mul_f32 v[174:175], v[174:175], v[62:63] op_sel_hi:[1,0]
    ds_write_b128 v121, v[108:111]
    v_pk_mul_f32 v[188:189], v[188:189], v[62:63] op_sel_hi:[1,0]
    v_pk_mul_f32 v[190:191], v[190:191], v[62:63] op_sel_hi:[1,0]
    v_cvt_pk_bf16_f32 v112, v140, v141
    ds_read_b128 a[200:203], v11
    v_cvt_pk_bf16_f32 v113, v142, v143
    v_cvt_pk_bf16_f32 v114, v156, v157
    v_cvt_pk_bf16_f32 v115, v158, v159
    ds_read_b128 a[216:219], v122
    v_cvt_pk_bf16_f32 v116, v172, v173
    v_cvt_pk_bf16_f32 v117, v174, v175
    v_cvt_pk_bf16_f32 v118, v188, v189
    v_cvt_pk_bf16_f32 v119, v190, v191
    v_permlane16_swap_b32 v112, v114
    s_waitcnt lgkmcnt(15)
    buffer_store_dwordx4 a[168:171], v9, s[16:19], s78 offen offset:384 sc0 sc1
    v_permlane16_swap_b32 v113, v115
    v_permlane16_swap_b32 v116, v118
    v_permlane16_swap_b32 v117, v119
    v_pk_mul_f32 v[192:193], v[192:193], v[56:57] op_sel_hi:[1,0]
    v_pk_mul_f32 v[194:195], v[194:195], v[56:57] op_sel_hi:[1,0]
    v_pk_mul_f32 v[208:209], v[208:209], v[56:57] op_sel_hi:[1,0]
    ds_write_b128 v120, v[112:115]
    v_pk_mul_f32 v[210:211], v[210:211], v[56:57] op_sel_hi:[1,0]
    v_pk_mul_f32 v[224:225], v[224:225], v[56:57] op_sel_hi:[1,0]
    v_pk_mul_f32 v[226:227], v[226:227], v[56:57] op_sel_hi:[1,0]
    ds_write_b128 v121, v[116:119]
    v_pk_mul_f32 v[240:241], v[240:241], v[56:57] op_sel_hi:[1,0]
    v_pk_mul_f32 v[242:243], v[242:243], v[56:57] op_sel_hi:[1,0]
    v_cvt_pk_bf16_f32 v80, v192, v193
    ds_read_b128 a[204:207], v11
    buffer_store_dwordx4 a[184:187], v10, s[16:19], s78 offen offset:384 sc0 sc1
    v_cvt_pk_bf16_f32 v81, v194, v195
    v_cvt_pk_bf16_f32 v82, v208, v209
    v_cvt_pk_bf16_f32 v83, v210, v211
    ds_read_b128 a[220:223], v122
    v_cvt_pk_bf16_f32 v84, v224, v225
    v_cvt_pk_bf16_f32 v85, v226, v227
    v_cvt_pk_bf16_f32 v86, v240, v241
    v_cvt_pk_bf16_f32 v87, v242, v243
    v_permlane16_swap_b32 v80, v82
    v_permlane16_swap_b32 v81, v83
    v_permlane16_swap_b32 v84, v86
    v_permlane16_swap_b32 v85, v87
    v_pk_mul_f32 v[196:197], v[196:197], v[58:59] op_sel_hi:[1,0]
    v_pk_mul_f32 v[198:199], v[198:199], v[58:59] op_sel_hi:[1,0]
    v_pk_mul_f32 v[212:213], v[212:213], v[58:59] op_sel_hi:[1,0]
    ds_write_b128 v120, v[80:83]
    v_pk_mul_f32 v[214:215], v[214:215], v[58:59] op_sel_hi:[1,0]
    v_pk_mul_f32 v[228:229], v[228:229], v[58:59] op_sel_hi:[1,0]
    v_pk_mul_f32 v[230:231], v[230:231], v[58:59] op_sel_hi:[1,0]
    s_waitcnt lgkmcnt(15)
    buffer_store_dwordx4 a[172:175], v9, s[16:19], s79 offen offset:384 sc0 sc1
    ds_write_b128 v121, v[84:87]
    v_pk_mul_f32 v[244:245], v[244:245], v[58:59] op_sel_hi:[1,0]
    v_pk_mul_f32 v[246:247], v[246:247], v[58:59] op_sel_hi:[1,0]
    v_cvt_pk_bf16_f32 v104, v196, v197
    ds_read_b128 a[224:227], v11
    v_cvt_pk_bf16_f32 v105, v198, v199
    v_cvt_pk_bf16_f32 v106, v212, v213
    v_cvt_pk_bf16_f32 v107, v214, v215
    ds_read_b128 a[240:243], v122
    v_cvt_pk_bf16_f32 v108, v228, v229
    v_cvt_pk_bf16_f32 v109, v230, v231
    v_cvt_pk_bf16_f32 v110, v244, v245
    v_cvt_pk_bf16_f32 v111, v246, v247
    v_permlane16_swap_b32 v104, v106
    v_permlane16_swap_b32 v105, v107
    v_permlane16_swap_b32 v108, v110
    v_permlane16_swap_b32 v109, v111
    v_pk_mul_f32 v[200:201], v[200:201], v[60:61] op_sel_hi:[1,0]
    v_pk_mul_f32 v[202:203], v[202:203], v[60:61] op_sel_hi:[1,0]
    buffer_store_dwordx4 a[188:191], v10, s[16:19], s79 offen offset:384 sc0 sc1
    v_pk_mul_f32 v[216:217], v[216:217], v[60:61] op_sel_hi:[1,0]
    ds_write_b128 v120, v[104:107]
    v_pk_mul_f32 v[218:219], v[218:219], v[60:61] op_sel_hi:[1,0]
    v_pk_mul_f32 v[232:233], v[232:233], v[60:61] op_sel_hi:[1,0]
    v_pk_mul_f32 v[234:235], v[234:235], v[60:61] op_sel_hi:[1,0]
    ds_write_b128 v121, v[108:111]
    v_pk_mul_f32 v[248:249], v[248:249], v[60:61] op_sel_hi:[1,0]
    v_pk_mul_f32 v[250:251], v[250:251], v[60:61] op_sel_hi:[1,0]
    v_cvt_pk_bf16_f32 v112, v200, v201
    ds_read_b128 a[228:231], v11
    v_cvt_pk_bf16_f32 v113, v202, v203
    v_cvt_pk_bf16_f32 v114, v216, v217
    v_cvt_pk_bf16_f32 v115, v218, v219
    ds_read_b128 a[244:247], v122
    v_cvt_pk_bf16_f32 v116, v232, v233
    v_cvt_pk_bf16_f32 v117, v234, v235
    v_cvt_pk_bf16_f32 v118, v248, v249
    v_cvt_pk_bf16_f32 v119, v250, v251
    v_permlane16_swap_b32 v112, v114
    v_permlane16_swap_b32 v113, v115
    v_permlane16_swap_b32 v116, v118
    v_permlane16_swap_b32 v117, v119
    v_pk_mul_f32 v[204:205], v[204:205], v[62:63] op_sel_hi:[1,0]
    v_pk_mul_f32 v[206:207], v[206:207], v[62:63] op_sel_hi:[1,0]
    v_pk_mul_f32 v[220:221], v[220:221], v[62:63] op_sel_hi:[1,0]
    ds_write_b128 v120, v[112:115]
    v_pk_mul_f32 v[222:223], v[222:223], v[62:63] op_sel_hi:[1,0]
    v_pk_mul_f32 v[236:237], v[236:237], v[62:63] op_sel_hi:[1,0]
    v_pk_mul_f32 v[238:239], v[238:239], v[62:63] op_sel_hi:[1,0]
    ds_write_b128 v121, v[116:119]
    v_pk_mul_f32 v[252:253], v[252:253], v[62:63] op_sel_hi:[1,0]
    v_pk_mul_f32 v[254:255], v[254:255], v[62:63] op_sel_hi:[1,0]
    v_cvt_pk_bf16_f32 v80, v204, v205
    ds_read_b128 a[232:235], v11
    v_cvt_pk_bf16_f32 v81, v206, v207
    v_cvt_pk_bf16_f32 v82, v220, v221
    v_cvt_pk_bf16_f32 v83, v222, v223
    ds_read_b128 a[248:251], v122
    v_cvt_pk_bf16_f32 v84, v236, v237
    v_cvt_pk_bf16_f32 v85, v238, v239
    v_cvt_pk_bf16_f32 v86, v252, v253
    v_cvt_pk_bf16_f32 v87, v254, v255
    v_permlane16_swap_b32 v80, v82
    v_permlane16_swap_b32 v81, v83
    v_permlane16_swap_b32 v84, v86
    v_permlane16_swap_b32 v85, v87
    ds_write_b128 v120, v[80:83]
    ds_write_b128 v121, v[84:87]
    ds_read_b128 a[236:239], v11
    ds_read_b128 a[252:255], v122
    s_waitcnt vmcnt(28)
    s_barrier
    s_add_u32 s33, s28, s80
    s_add_u32 s33, s33, s38
    s_sub_u32 s34, s33, s39
    s_min_u32 s33, s33, s34
    v_add_u32 v21, s33, v1
    s_add_u32 s28, s28, 83200
    s_sub_u32 s48, s28, s39
    s_min_u32 s28, s28, s48
    ds_read_b128 a[64:67], v21 offset:0
    ds_read_b128 a[96:99], v21 offset:512
    ds_read_b128 a[68:71], v21 offset:16
    ds_read_b128 a[100:103], v21 offset:528
    ds_read_b128 a[72:75], v21 offset:32
    ds_read_b128 a[104:107], v21 offset:544
    ds_read_b128 a[76:79], v21 offset:48
    ds_read_b128 a[108:111], v21 offset:560
    ds_read_b128 v[104:107], v3 offset:0
    ds_read_b128 v[108:111], v3 offset:16
    ds_read_b128 v[112:115], v3 offset:32
    ds_read_b128 v[116:119], v3 offset:48
    s_waitcnt lgkmcnt(3)
    v_mfma_f32_16x16x32_bf16 v[40:43], v[104:107], a[64:67], 0
    ds_read_b128 a[80:83], v21 offset:256
    v_mfma_f32_16x16x32_bf16 v[48:51], v[104:107], a[96:99], 0
    s_waitcnt lgkmcnt(3)
    ds_read_b128 v[104:107], v3 offset:256
    ds_read_b128 a[112:115], v21 offset:768
    v_mfma_f32_16x16x32_bf16 v[40:43], v[108:111], a[68:71], v[40:43]
    buffer_store_dwordx4 a[192:195], v9, s[16:19], s76 offen offset:0 sc0 sc1
    ds_read_b128 a[84:87], v21 offset:272
    v_mfma_f32_16x16x32_bf16 v[48:51], v[108:111], a[100:103], v[48:51]
    s_waitcnt lgkmcnt(5)
    ds_read_b128 v[108:111], v3 offset:272
    ds_read_b128 a[116:119], v21 offset:784
    v_mfma_f32_16x16x32_bf16 v[40:43], v[112:115], a[72:75], v[40:43]
    ds_read_b128 a[88:91], v21 offset:288
    v_mfma_f32_16x16x32_bf16 v[48:51], v[112:115], a[104:107], v[48:51]
    s_waitcnt lgkmcnt(7)
    ds_read_b128 v[112:115], v3 offset:288
    ds_read_b128 a[120:123], v21 offset:800
    v_mfma_f32_16x16x32_bf16 v[40:43], v[116:119], a[76:79], v[40:43]
    ds_read_b128 a[92:95], v21 offset:304
    v_mfma_f32_16x16x32_bf16 v[48:51], v[116:119], a[108:111], v[48:51]
    s_waitcnt lgkmcnt(7)
    ds_read_b128 v[116:119], v3 offset:304
    ds_read_b128 a[124:127], v21 offset:816
    v_mfma_f32_16x16x32_bf16 v[40:43], v[104:107], a[80:83], v[40:43]
    buffer_store_dwordx4 a[208:211], v10, s[16:19], s76 offen offset:0 sc0 sc1
    v_mfma_f32_16x16x32_bf16 v[48:51], v[104:107], a[112:115], v[48:51]
    s_waitcnt lgkmcnt(6)
    ds_read_b128 v[104:107], v3 offset:512
    v_mfma_f32_16x16x32_bf16 v[40:43], v[108:111], a[84:87], v[40:43]
    v_mfma_f32_16x16x32_bf16 v[48:51], v[108:111], a[116:119], v[48:51]
    s_waitcnt lgkmcnt(4)
    ds_read_b128 v[108:111], v3 offset:528
    v_mfma_f32_16x16x32_bf16 v[40:43], v[112:115], a[88:91], v[40:43]
    v_mfma_f32_16x16x32_bf16 v[48:51], v[112:115], a[120:123], v[48:51]
    s_waitcnt lgkmcnt(2)
    ds_read_b128 v[112:115], v3 offset:544
    v_mfma_f32_16x16x32_bf16 v[40:43], v[116:119], a[92:95], v[40:43]
    buffer_store_dwordx4 a[196:199], v9, s[16:19], s77 offen offset:0 sc0 sc1
    v_mfma_f32_16x16x32_bf16 v[48:51], v[116:119], a[124:127], v[48:51]
    s_waitcnt lgkmcnt(2)
    ds_read_b128 v[116:119], v3 offset:560
    v_mfma_f32_16x16x32_bf16 v[44:47], v[104:107], a[64:67], 0
    v_mfma_f32_16x16x32_bf16 v[52:55], v[104:107], a[96:99], 0
    s_waitcnt lgkmcnt(2)
    ds_read_b128 v[104:107], v3 offset:768
    v_mfma_f32_16x16x32_bf16 v[44:47], v[108:111], a[68:71], v[44:47]
    v_mfma_f32_16x16x32_bf16 v[52:55], v[108:111], a[100:103], v[52:55]
    s_waitcnt lgkmcnt(2)
    ds_read_b128 v[108:111], v3 offset:784
    v_mfma_f32_16x16x32_bf16 v[44:47], v[112:115], a[72:75], v[44:47]
    buffer_store_dwordx4 a[212:215], v10, s[16:19], s77 offen offset:0 sc0 sc1
    v_mfma_f32_16x16x32_bf16 v[52:55], v[112:115], a[104:107], v[52:55]
    s_waitcnt lgkmcnt(2)
    ds_read_b128 v[112:115], v3 offset:800
    v_mfma_f32_16x16x32_bf16 v[44:47], v[116:119], a[76:79], v[44:47]
    v_mfma_f32_16x16x32_bf16 v[52:55], v[116:119], a[108:111], v[52:55]
    s_waitcnt lgkmcnt(2)
    ds_read_b128 v[116:119], v3 offset:816
    v_mfma_f32_16x16x32_bf16 v[44:47], v[104:107], a[80:83], v[44:47]
    v_mfma_f32_16x16x32_bf16 v[52:55], v[104:107], a[112:115], v[52:55]
    s_waitcnt lgkmcnt(2)
    v_mfma_f32_16x16x32_bf16 v[44:47], v[108:111], a[84:87], v[44:47]
    v_mfma_f32_16x16x32_bf16 v[52:55], v[108:111], a[116:119], v[52:55]
    s_waitcnt lgkmcnt(1)
    buffer_store_dwordx4 a[200:203], v9, s[16:19], s78 offen offset:0 sc0 sc1
    v_mfma_f32_16x16x32_bf16 v[44:47], v[112:115], a[88:91], v[44:47]
    v_mfma_f32_16x16x32_bf16 v[52:55], v[112:115], a[120:123], v[52:55]
    s_waitcnt lgkmcnt(0)
    v_mfma_f32_16x16x32_bf16 v[44:47], v[116:119], a[92:95], v[44:47]
    v_mfma_f32_16x16x32_bf16 v[52:55], v[116:119], a[124:127], v[52:55]
    s_waitcnt vmcnt(25)
    s_barrier
    v_add_u32 v3, s28, v1
    s_add_u32 s28, s28, s38
    s_sub_u32 s48, s28, s39
    s_min_u32 s28, s28, s48
    ds_read_b128 v[104:107], v3 offset:0
    ds_read_b128 v[108:111], v3 offset:16
    ds_read_b128 v[112:115], v3 offset:32
    ds_read_b128 v[116:119], v3 offset:48
    buffer_store_dwordx4 a[216:219], v10, s[16:19], s78 offen offset:0 sc0 sc1
    v_max3_f32 v56, v24, v25, v26
    v_max3_f32 v56, v56, v27, v28
    v_max3_f32 v56, v56, v29, v30
    v_max_f32 v56, v56, v31
    v_mov_b32 v57, v56
    v_max3_f32 v58, v32, v33, v34
    v_max3_f32 v58, v58, v35, v36
    v_max3_f32 v58, v58, v37, v38
    v_max_f32 v58, v58, v39
    v_mov_b32 v59, v58
    v_max3_f32 v60, v40, v41, v42
    v_max3_f32 v60, v60, v43, v44
    v_max3_f32 v60, v60, v45, v46
    v_max_f32 v60, v60, v47
    v_mov_b32 v61, v60
    v_max3_f32 v62, v48, v49, v50
    v_max3_f32 v62, v62, v51, v52
    v_max3_f32 v62, v62, v53, v54
    v_max_f32 v62, v62, v55
    v_mov_b32 v63, v62
    s_nop 1
    v_permlane16_swap_b32 v56, v57
    v_permlane16_swap_b32 v58, v59
    v_permlane16_swap_b32 v60, v61
    s_add_u32 m0, s29, s30
    s_add_u32 s29, s29, s38
    s_sub_u32 s31, s29, s39
    s_min_u32 s29, s29, s31
    buffer_load_dwordx4 v5, s[12:15], s25 offen offset:0 nt lds
    v_permlane16_swap_b32 v62, v63
    v_max_f32 v56, v56, v57
    v_max_f32 v58, v58, v59
    v_max_f32 v60, v60, v61
    v_max_f32 v62, v62, v63
    v_mov_b32 v57, v56
    v_mov_b32 v59, v58
    v_mov_b32 v61, v60
    v_mov_b32 v63, v62
    s_nop 1
    v_permlane32_swap_b32 v56, v57
    v_permlane32_swap_b32 v58, v59
    v_permlane32_swap_b32 v60, v61
    v_permlane32_swap_b32 v62, v63
    v_max_f32 v56, v56, v57
    v_max_f32 v58, v58, v59
    v_max_f32 v60, v60, v61
    v_max_f32 v62, v62, v63
    v_mul_f32 v12, s21, v56
    v_sub_f32 v12, 0, v12
    v_mov_b32 v16, 0
    v_mul_f32 v13, s21, v58
    v_sub_f32 v13, 0, v13
    v_mov_b32 v17, 0
    buffer_load_dwordx4 v6, s[12:15], s25 offen offset:1040 nt lds
    v_mul_f32 v14, s21, v60
    v_sub_f32 v14, 0, v14
    v_mov_b32 v18, 0
    v_mul_f32 v15, s21, v62
    v_sub_f32 v15, 0, v15
    v_mov_b32 v19, 0
    v_fma_f32 v24, v24, s21, v12
    v_fma_f32 v25, v25, s21, v12
    v_fma_f32 v26, v26, s21, v12
    v_fma_f32 v27, v27, s21, v12
    v_fma_f32 v28, v28, s21, v12
    v_fma_f32 v29, v29, s21, v12
    v_fma_f32 v30, v30, s21, v12
    v_fma_f32 v31, v31, s21, v12
    v_fma_f32 v32, v32, s21, v13
    v_fma_f32 v33, v33, s21, v13
    v_fma_f32 v34, v34, s21, v13
    v_fma_f32 v35, v35, s21, v13
    v_fma_f32 v36, v36, s21, v13
    v_fma_f32 v37, v37, s21, v13
    v_fma_f32 v38, v38, s21, v13
    v_fma_f32 v39, v39, s21, v13
    v_fma_f32 v40, v40, s21, v14
    v_fma_f32 v41, v41, s21, v14
    v_fma_f32 v42, v42, s21, v14
    buffer_load_dwordx4 v7, s[12:15], s25 offen offset:2080 nt lds
    v_fma_f32 v43, v43, s21, v14
    v_fma_f32 v44, v44, s21, v14
    v_fma_f32 v45, v45, s21, v14
    v_fma_f32 v46, v46, s21, v14
    v_fma_f32 v47, v47, s21, v14
    v_fma_f32 v48, v48, s21, v15
    v_fma_f32 v49, v49, s21, v15
    v_fma_f32 v50, v50, s21, v15
    v_fma_f32 v51, v51, s21, v15
    v_fma_f32 v52, v52, s21, v15
    v_fma_f32 v53, v53, s21, v15
    v_fma_f32 v54, v54, s21, v15
    v_fma_f32 v55, v55, s21, v15
    s_waitcnt lgkmcnt(2)
    v_mfma_f32_16x16x32_bf16 v[56:59], v[104:107], a[0:3], 0
    v_exp_f32 v24, v24
    v_mfma_f32_16x16x32_bf16 v[56:59], v[108:111], a[4:7], v[56:59]
    v_add_u32 v4, s28, v2
    v_add_f32 v16, v16, v24
    v_mfma_f32_16x16x32_bf16 v[64:67], v[104:107], a[32:35], 0
    s_add_u32 s28, s28, s38
    v_exp_f32 v25, v25
    buffer_load_dwordx4 v8, s[12:15], s25 offen offset:3120 nt lds
    s_add_u32 s25, s25, 0x4000
    v_mfma_f32_16x16x32_bf16 v[64:67], v[108:111], a[36:39], v[64:67]
    s_sub_u32 s48, s28, s39
    v_exp_f32 v26, v26
    v_mfma_f32_16x16x32_bf16 v[72:75], v[104:107], a[64:67], 0
    s_min_u32 s28, s28, s48
    v_exp_f32 v27, v27
    v_mfma_f32_16x16x32_bf16 v[72:75], v[108:111], a[68:71], v[72:75]
    v_exp_f32 v28, v28
    v_mfma_f32_16x16x32_bf16 v[80:83], v[104:107], a[96:99], 0
    ds_read_b128 v[104:107], v3 offset:256
    v_cvt_pk_bf16_f32 v88, v24, v25
    v_mfma_f32_16x16x32_bf16 v[80:83], v[108:111], a[100:103], v[80:83]
    s_waitcnt lgkmcnt(1)
    ds_read_b128 v[108:111], v3 offset:272
    v_cvt_pk_bf16_f32 v89, v26, v27
    v_mfma_f32_16x16x32_bf16 v[56:59], v[112:115], a[8:11], v[56:59]
    v_exp_f32 v29, v29
    v_mfma_f32_16x16x32_bf16 v[56:59], v[116:119], a[12:15], v[56:59]
    buffer_store_dwordx4 a[204:207], v9, s[16:19], s79 offen offset:0 sc0 sc1
    v_exp_f32 v30, v30
    v_mfma_f32_16x16x32_bf16 v[64:67], v[112:115], a[40:43], v[64:67]
    v_exp_f32 v31, v31
    v_mfma_f32_16x16x32_bf16 v[64:67], v[116:119], a[44:47], v[64:67]
    v_exp_f32 v32, v32
    v_mfma_f32_16x16x32_bf16 v[72:75], v[112:115], a[72:75], v[72:75]
    v_exp_f32 v33, v33
    v_mfma_f32_16x16x32_bf16 v[72:75], v[116:119], a[76:79], v[72:75]
    v_exp_f32 v34, v34
    v_mfma_f32_16x16x32_bf16 v[80:83], v[112:115], a[104:107], v[80:83]
    ds_read_b128 v[112:115], v3 offset:288
    v_cvt_pk_bf16_f32 v90, v28, v29
    v_mfma_f32_16x16x32_bf16 v[80:83], v[116:119], a[108:111], v[80:83]
    s_waitcnt lgkmcnt(1)
    buffer_store_dwordx4 a[220:223], v10, s[16:19], s79 offen offset:0 sc0 sc1
    ds_read_b128 v[116:119], v3 offset:304
    v_cvt_pk_bf16_f32 v91, v30, v31
    v_mfma_f32_16x16x32_bf16 v[56:59], v[104:107], a[16:19], v[56:59]
    v_exp_f32 v35, v35
    v_mfma_f32_16x16x32_bf16 v[56:59], v[108:111], a[20:23], v[56:59]
    v_exp_f32 v36, v36
    v_mfma_f32_16x16x32_bf16 v[64:67], v[104:107], a[48:51], v[64:67]
    v_exp_f32 v37, v37
    v_mfma_f32_16x16x32_bf16 v[64:67], v[108:111], a[52:55], v[64:67]
    v_exp_f32 v38, v38
    v_mfma_f32_16x16x32_bf16 v[72:75], v[104:107], a[80:83], v[72:75]
    v_exp_f32 v39, v39
    v_mfma_f32_16x16x32_bf16 v[72:75], v[108:111], a[84:87], v[72:75]
    v_exp_f32 v40, v40
    v_mfma_f32_16x16x32_bf16 v[80:83], v[104:107], a[112:115], v[80:83]
    ds_read_b128 v[104:107], v3 offset:512
    v_cvt_pk_bf16_f32 v92, v32, v33
    v_mfma_f32_16x16x32_bf16 v[80:83], v[108:111], a[116:119], v[80:83]
    s_waitcnt lgkmcnt(1)
    ds_read_b128 v[108:111], v3 offset:528
    v_cvt_pk_bf16_f32 v93, v34, v35
    v_mfma_f32_16x16x32_bf16 v[56:59], v[112:115], a[24:27], v[56:59]
    v_exp_f32 v41, v41
    v_mfma_f32_16x16x32_bf16 v[56:59], v[116:119], a[28:31], v[56:59]
    v_exp_f32 v42, v42
    v_mfma_f32_16x16x32_bf16 v[64:67], v[112:115], a[56:59], v[64:67]
    v_exp_f32 v43, v43
    v_mfma_f32_16x16x32_bf16 v[64:67], v[116:119], a[60:63], v[64:67]
    v_exp_f32 v44, v44
    v_mfma_f32_16x16x32_bf16 v[72:75], v[112:115], a[88:91], v[72:75]
    v_exp_f32 v45, v45
    v_mfma_f32_16x16x32_bf16 v[72:75], v[116:119], a[92:95], v[72:75]
    v_exp_f32 v46, v46
    v_mfma_f32_16x16x32_bf16 v[80:83], v[112:115], a[120:123], v[80:83]
    ds_read_b128 v[112:115], v3 offset:544
    v_cvt_pk_bf16_f32 v94, v36, v37
    v_mfma_f32_16x16x32_bf16 v[80:83], v[116:119], a[124:127], v[80:83]
    s_waitcnt lgkmcnt(1)
    ds_read_b128 v[116:119], v3 offset:560
    v_cvt_pk_bf16_f32 v95, v38, v39
    v_mfma_f32_16x16x32_bf16 v[60:63], v[104:107], a[0:3], 0
    v_exp_f32 v47, v47
    v_mfma_f32_16x16x32_bf16 v[60:63], v[108:111], a[4:7], v[60:63]
    v_exp_f32 v48, v48
    v_mfma_f32_16x16x32_bf16 v[68:71], v[104:107], a[32:35], 0
    v_exp_f32 v49, v49
    v_mfma_f32_16x16x32_bf16 v[68:71], v[108:111], a[36:39], v[68:71]
    v_exp_f32 v50, v50
    v_mfma_f32_16x16x32_bf16 v[76:79], v[104:107], a[64:67], 0
    v_exp_f32 v51, v51
    v_mfma_f32_16x16x32_bf16 v[76:79], v[108:111], a[68:71], v[76:79]
    v_exp_f32 v52, v52
    v_mfma_f32_16x16x32_bf16 v[84:87], v[104:107], a[96:99], 0
    ds_read_b128 v[104:107], v3 offset:768
    v_cvt_pk_bf16_f32 v96, v40, v41
    v_mfma_f32_16x16x32_bf16 v[84:87], v[108:111], a[100:103], v[84:87]
    s_waitcnt lgkmcnt(1)
    ds_read_b128 v[108:111], v3 offset:784
    v_cvt_pk_bf16_f32 v97, v42, v43
    v_mfma_f32_16x16x32_bf16 v[60:63], v[112:115], a[8:11], v[60:63]
    buffer_store_dwordx4 a[224:227], v9, s[16:19], s76 offen offset:128 sc0 sc1
    v_exp_f32 v53, v53
    v_mfma_f32_16x16x32_bf16 v[60:63], v[116:119], a[12:15], v[60:63]
    v_exp_f32 v54, v54
    v_mfma_f32_16x16x32_bf16 v[68:71], v[112:115], a[40:43], v[68:71]
    v_exp_f32 v55, v55
    v_mfma_f32_16x16x32_bf16 v[68:71], v[116:119], a[44:47], v[68:71]
    v_cvt_pk_bf16_f32 v98, v44, v45
    v_cvt_pk_bf16_f32 v99, v46, v47
    v_mfma_f32_16x16x32_bf16 v[76:79], v[112:115], a[72:75], v[76:79]
    v_cvt_pk_bf16_f32 v100, v48, v49
    v_cvt_pk_bf16_f32 v101, v50, v51
    v_mfma_f32_16x16x32_bf16 v[76:79], v[116:119], a[76:79], v[76:79]
    v_cvt_pk_bf16_f32 v102, v52, v53
    v_cvt_pk_bf16_f32 v103, v54, v55
    v_mfma_f32_16x16x32_bf16 v[84:87], v[112:115], a[104:107], v[84:87]
    ds_read_b128 v[112:115], v3 offset:800
    buffer_store_dwordx4 a[240:243], v10, s[16:19], s76 offen offset:128 sc0 sc1
    v_add_f32 v16, v16, v25
    v_mfma_f32_16x16x32_bf16 v[84:87], v[116:119], a[108:111], v[84:87]
    s_waitcnt lgkmcnt(1)
    ds_read_b128 v[116:119], v3 offset:816
    v_add_f32 v16, v16, v26
    v_mfma_f32_16x16x32_bf16 v[60:63], v[104:107], a[16:19], v[60:63]
    v_add_f32 v16, v16, v27
    v_add_f32 v16, v16, v28
    v_mfma_f32_16x16x32_bf16 v[60:63], v[108:111], a[20:23], v[60:63]
    v_add_u32 v3, s28, v1
    v_add_f32 v16, v16, v29
    v_mfma_f32_16x16x32_bf16 v[68:71], v[104:107], a[48:51], v[68:71]
    s_add_u32 s28, s28, s38
    v_add_f32 v16, v16, v30
    v_add_f32 v16, v16, v31
    v_mfma_f32_16x16x32_bf16 v[68:71], v[108:111], a[52:55], v[68:71]
    s_sub_u32 s48, s28, s39
    v_add_f32 v17, v17, v32
    v_add_f32 v17, v17, v33
    v_mfma_f32_16x16x32_bf16 v[76:79], v[104:107], a[80:83], v[76:79]
    s_min_u32 s28, s28, s48
    v_add_f32 v17, v17, v34
    v_add_f32 v17, v17, v35
    buffer_store_dwordx4 a[228:231], v9, s[16:19], s77 offen offset:128 sc0 sc1
    v_mfma_f32_16x16x32_bf16 v[76:79], v[108:111], a[84:87], v[76:79]
    v_add_f32 v17, v17, v36
    v_add_f32 v17, v17, v37
    v_mfma_f32_16x16x32_bf16 v[84:87], v[104:107], a[112:115], v[84:87]
    ds_read_b64_tr_b16 v[104:105], v4 offset:0
    v_add_f32 v17, v17, v38
    v_mfma_f32_16x16x32_bf16 v[84:87], v[108:111], a[116:119], v[84:87]
    s_waitcnt lgkmcnt(1)
    ds_read_b64_tr_b16 v[106:107], v4 offset:512
    ds_read_b64_tr_b16 v[108:109], v4 offset:32
    v_mfma_f32_16x16x32_bf16 v[60:63], v[112:115], a[24:27], v[60:63]
    ds_read_b64_tr_b16 v[110:111], v4 offset:544
    v_add_f32 v17, v17, v39
    v_mfma_f32_16x16x32_bf16 v[60:63], v[116:119], a[28:31], v[60:63]
    v_add_f32 v18, v18, v40
    v_add_f32 v18, v18, v41
    v_mfma_f32_16x16x32_bf16 v[68:71], v[112:115], a[56:59], v[68:71]
    v_add_f32 v18, v18, v42
    v_add_f32 v18, v18, v43
    v_mfma_f32_16x16x32_bf16 v[68:71], v[116:119], a[60:63], v[68:71]
    buffer_store_dwordx4 a[244:247], v10, s[16:19], s77 offen offset:128 sc0 sc1
    v_add_f32 v18, v18, v44
    v_add_f32 v18, v18, v45
    v_mfma_f32_16x16x32_bf16 v[76:79], v[112:115], a[88:91], v[76:79]
    v_add_f32 v18, v18, v46
    v_add_f32 v18, v18, v47
    v_mfma_f32_16x16x32_bf16 v[76:79], v[116:119], a[92:95], v[76:79]
    v_add_f32 v19, v19, v48
    v_add_f32 v19, v19, v49
    v_mfma_f32_16x16x32_bf16 v[84:87], v[112:115], a[120:123], v[84:87]
    ds_read_b64_tr_b16 v[112:113], v4 offset:64
    v_add_f32 v19, v19, v50
    v_mfma_f32_16x16x32_bf16 v[84:87], v[116:119], a[124:127], v[84:87]
    s_waitcnt lgkmcnt(3)
    ds_read_b64_tr_b16 v[114:115], v4 offset:576
    ds_read_b64_tr_b16 v[116:117], v4 offset:96
    v_mfma_f32_16x16x32_bf16 v[128:131], v[104:107], v[88:91], 0
    ds_read_b64_tr_b16 v[118:119], v4 offset:608
    v_fma_f32 v56, v56, s21, v12
    v_mfma_f32_16x16x32_bf16 v[132:135], v[104:107], v[92:95], 0
    s_add_u32 m0, s29, s30
    s_add_u32 s29, s29, s38
    s_sub_u32 s31, s29, s39
    s_min_u32 s29, s29, s31
    buffer_load_dwordx4 v5, s[8:11], s24 offen offset:0 nt lds
    v_add_f32 v19, v19, v51
    v_fma_f32 v57, v57, s21, v12
    buffer_load_dwordx4 v6, s[8:11], s24 offen offset:1040 nt lds
    buffer_load_dwordx4 v7, s[8:11], s24 offen offset:2080 nt lds
    buffer_load_dwordx4 v8, s[8:11], s24 offen offset:3120 nt lds
    s_add_u32 s24, s24, 0x4000
    s_add_u32 m0, s29, s30
    s_add_u32 s29, s29, s38
    s_sub_u32 s31, s29, s39
    s_min_u32 s29, s29, s31
    buffer_load_dwordx4 v5, s[12:15], s25 offen offset:0 nt lds
    buffer_load_dwordx4 v6, s[12:15], s25 offen offset:1040 nt lds
    buffer_load_dwordx4 v7, s[12:15], s25 offen offset:2080 nt lds
    buffer_load_dwordx4 v8, s[12:15], s25 offen offset:3120 nt lds
    s_add_u32 s25, s25, 0x4000
    v_mfma_f32_16x16x32_bf16 v[136:139], v[104:107], v[96:99], 0
    v_fma_f32 v58, v58, s21, v12
    v_mfma_f32_16x16x32_bf16 v[140:143], v[104:107], v[100:103], 0
    s_waitcnt lgkmcnt(4)
    ds_read_b64_tr_b16 v[104:105], v4 offset:128
    v_max3_f32 v20, v56, v57, v58
    v_mfma_f32_16x16x32_bf16 v[144:147], v[108:111], v[88:91], 0
    s_waitcnt vmcnt(14)
    ds_read_b64_tr_b16 v[106:107], v4 offset:640
    v_mfma_f32_16x16x32_bf16 v[148:151], v[108:111], v[92:95], 0
    v_fma_f32 v59, v59, s21, v12
    v_fma_f32 v64, v64, s21, v13
    v_mfma_f32_16x16x32_bf16 v[152:155], v[108:111], v[96:99], 0
    s_barrier
    v_max3_f32 v20, v20, v59, v64
    v_mfma_f32_16x16x32_bf16 v[156:159], v[108:111], v[100:103], 0
    s_waitcnt lgkmcnt(4)
    ds_read_b64_tr_b16 v[108:109], v4 offset:160
    v_fma_f32 v65, v65, s21, v13
    v_mfma_f32_16x16x32_bf16 v[160:163], v[112:115], v[88:91], 0
    s_add_u32 m0, s29, s30
    ds_read_b64_tr_b16 v[110:111], v4 offset:672
    v_fma_f32 v66, v66, s21, v13
    v_mfma_f32_16x16x32_bf16 v[164:167], v[112:115], v[92:95], 0
    s_add_u32 s29, s29, s38
    buffer_load_dwordx4 v5, s[8:11], s24 offen offset:0 nt lds
    v_mfma_f32_16x16x32_bf16 v[168:171], v[112:115], v[96:99], 0
    s_sub_u32 s31, s29, s39
    v_max3_f32 v20, v20, v65, v66
    v_mfma_f32_16x16x32_bf16 v[172:175], v[112:115], v[100:103], 0
    s_waitcnt lgkmcnt(4)
    ds_read_b64_tr_b16 v[112:113], v4 offset:192
    v_fma_f32 v67, v67, s21, v13
    v_mfma_f32_16x16x32_bf16 v[176:179], v[116:119], v[88:91], 0
    s_min_u32 s29, s29, s31
    ds_read_b64_tr_b16 v[114:115], v4 offset:704
    v_add_f32 v19, v19, v52
    v_mfma_f32_16x16x32_bf16 v[180:183], v[116:119], v[92:95], 0
    v_fma_f32 v72, v72, s21, v14
    v_mfma_f32_16x16x32_bf16 v[184:187], v[116:119], v[96:99], 0
    buffer_load_dwordx4 v6, s[8:11], s24 offen offset:1040 nt lds
    v_mfma_f32_16x16x32_bf16 v[188:191], v[116:119], v[100:103], 0
    s_waitcnt lgkmcnt(4)
    ds_read_b64_tr_b16 v[116:117], v4 offset:224
    v_max3_f32 v20, v20, v67, v72
    v_mfma_f32_16x16x32_bf16 v[192:195], v[104:107], v[88:91], 0
    ds_read_b64_tr_b16 v[118:119], v4 offset:736
    v_mfma_f32_16x16x32_bf16 v[196:199], v[104:107], v[92:95], 0
    v_fma_f32 v73, v73, s21, v14
    v_fma_f32 v74, v74, s21, v14
    v_mfma_f32_16x16x32_bf16 v[200:203], v[104:107], v[96:99], 0
    v_max3_f32 v20, v20, v73, v74
    v_mfma_f32_16x16x32_bf16 v[204:207], v[104:107], v[100:103], 0
    s_waitcnt lgkmcnt(4)
    ds_read_b64_tr_b16 v[104:105], v4 offset:256
    v_fma_f32 v75, v75, s21, v14
    v_mfma_f32_16x16x32_bf16 v[208:211], v[108:111], v[88:91], 0
    ds_read_b64_tr_b16 v[106:107], v4 offset:768
    v_fma_f32 v80, v80, s21, v15
    v_mfma_f32_16x16x32_bf16 v[212:215], v[108:111], v[92:95], 0
    buffer_load_dwordx4 v7, s[8:11], s24 offen offset:2080 nt lds
    v_mfma_f32_16x16x32_bf16 v[216:219], v[108:111], v[96:99], 0
    v_max3_f32 v20, v20, v75, v80
    v_mfma_f32_16x16x32_bf16 v[220:223], v[108:111], v[100:103], 0
    s_waitcnt lgkmcnt(4)
    ds_read_b64_tr_b16 v[108:109], v4 offset:288
    v_fma_f32 v81, v81, s21, v15
    v_mfma_f32_16x16x32_bf16 v[224:227], v[112:115], v[88:91], 0
    ds_read_b64_tr_b16 v[110:111], v4 offset:800
    v_mfma_f32_16x16x32_bf16 v[228:231], v[112:115], v[92:95], 0
    v_fma_f32 v82, v82, s21, v15
    v_add_f32 v19, v19, v53
    v_mfma_f32_16x16x32_bf16 v[232:235], v[112:115], v[96:99], 0
    buffer_load_dwordx4 v8, s[8:11], s24 offen offset:3120 nt lds
    v_mfma_f32_16x16x32_bf16 v[236:239], v[112:115], v[100:103], 0
    s_waitcnt lgkmcnt(4)
    ds_read_b64_tr_b16 v[112:113], v4 offset:320
    v_max3_f32 v20, v20, v81, v82
    v_mfma_f32_16x16x32_bf16 v[240:243], v[116:119], v[88:91], 0
    s_add_u32 s24, s24, 0x4000
    ds_read_b64_tr_b16 v[114:115], v4 offset:832
    v_mfma_f32_16x16x32_bf16 v[244:247], v[116:119], v[92:95], 0
    s_add_u32 m0, s29, s30
    v_fma_f32 v83, v83, s21, v15
    v_fma_f32 v60, v60, s21, v12
    v_mfma_f32_16x16x32_bf16 v[248:251], v[116:119], v[96:99], 0
    s_add_u32 s29, s29, s38
    buffer_load_dwordx4 v5, s[12:15], s25 offen offset:0 nt lds
    v_mfma_f32_16x16x32_bf16 v[252:255], v[116:119], v[100:103], 0
    s_waitcnt lgkmcnt(4)
    ds_read_b64_tr_b16 v[116:117], v4 offset:352
    v_mfma_f32_16x16x32_bf16 a[128:131], v[104:107], v[88:91], 0
    s_sub_u32 s31, s29, s39
    ds_read_b64_tr_b16 v[118:119], v4 offset:864
    v_max3_f32 v20, v20, v83, v60
    v_mfma_f32_16x16x32_bf16 a[132:135], v[104:107], v[92:95], 0
    s_min_u32 s29, s29, s31
    v_fma_f32 v61, v61, s21, v12
    v_mfma_f32_16x16x32_bf16 a[136:139], v[104:107], v[96:99], 0
    v_fma_f32 v62, v62, s21, v12
    v_max3_f32 v20, v20, v61, v62
    v_mfma_f32_16x16x32_bf16 a[140:143], v[104:107], v[100:103], 0
    s_waitcnt lgkmcnt(4)
    ds_read_b64_tr_b16 v[104:105], v4 offset:384
    v_fma_f32 v63, v63, s21, v12
    v_mfma_f32_16x16x32_bf16 a[144:147], v[108:111], v[88:91], 0
    ds_read_b64_tr_b16 v[106:107], v4 offset:896
    v_mfma_f32_16x16x32_bf16 a[148:151], v[108:111], v[92:95], 0
    buffer_load_dwordx4 v6, s[12:15], s25 offen offset:1040 nt lds
    v_mfma_f32_16x16x32_bf16 a[152:155], v[108:111], v[96:99], 0
    v_fma_f32 v68, v68, s21, v13
    v_add_f32 v19, v19, v54
    v_mfma_f32_16x16x32_bf16 a[156:159], v[108:111], v[100:103], 0
    s_waitcnt lgkmcnt(4)
    ds_read_b64_tr_b16 v[108:109], v4 offset:416
    v_mfma_f32_16x16x32_bf16 a[160:163], v[112:115], v[88:91], 0
    ds_read_b64_tr_b16 v[110:111], v4 offset:928
    v_max3_f32 v20, v20, v63, v68
    v_mfma_f32_16x16x32_bf16 a[164:167], v[112:115], v[92:95], 0
    v_fma_f32 v69, v69, s21, v13
    v_fma_f32 v70, v70, s21, v13
    v_mfma_f32_16x16x32_bf16 a[168:171], v[112:115], v[96:99], 0
    buffer_load_dwordx4 v7, s[12:15], s25 offen offset:2080 nt lds
    v_mfma_f32_16x16x32_bf16 a[172:175], v[112:115], v[100:103], 0
    s_waitcnt lgkmcnt(4)
    ds_read_b64_tr_b16 v[112:113], v4 offset:448
    v_mfma_f32_16x16x32_bf16 a[176:179], v[116:119], v[88:91], 0
    ds_read_b64_tr_b16 v[114:115], v4 offset:960
    v_max3_f32 v20, v20, v69, v70
    v_mfma_f32_16x16x32_bf16 a[180:183], v[116:119], v[92:95], 0
    v_fma_f32 v71, v71, s21, v13
    v_mfma_f32_16x16x32_bf16 a[184:187], v[116:119], v[96:99], 0
    v_fma_f32 v76, v76, s21, v14
    v_max3_f32 v20, v20, v71, v76
    v_mfma_f32_16x16x32_bf16 a[188:191], v[116:119], v[100:103], 0
    s_waitcnt lgkmcnt(4)
    ds_read_b64_tr_b16 v[116:117], v4 offset:480
    v_mfma_f32_16x16x32_bf16 a[192:195], v[104:107], v[88:91], 0
    ds_read_b64_tr_b16 v[118:119], v4 offset:992
    v_fma_f32 v77, v77, s21, v14
    v_mfma_f32_16x16x32_bf16 a[196:199], v[104:107], v[92:95], 0
    buffer_load_dwordx4 v8, s[12:15], s25 offen offset:3120 nt lds
    v_mfma_f32_16x16x32_bf16 a[200:203], v[104:107], v[96:99], 0
    s_add_u32 s25, s25, 0x4000
    v_fma_f32 v78, v78, s21, v14
    v_max3_f32 v20, v20, v77, v78
    v_mfma_f32_16x16x32_bf16 a[204:207], v[104:107], v[100:103], 0
    s_waitcnt lgkmcnt(4)
    ds_read_b128 v[104:107], v3 offset:0
    v_mfma_f32_16x16x32_bf16 a[208:211], v[108:111], v[88:91], 0
    v_add_f32 v19, v19, v55
    v_fma_f32 v79, v79, s21, v14
    v_mfma_f32_16x16x32_bf16 a[212:215], v[108:111], v[92:95], 0
    v_fma_f32 v84, v84, s21, v15
    v_mfma_f32_16x16x32_bf16 a[216:219], v[108:111], v[96:99], 0
    v_max3_f32 v20, v20, v79, v84
    v_fma_f32 v85, v85, s21, v15
    v_mfma_f32_16x16x32_bf16 a[220:223], v[108:111], v[100:103], 0
    s_waitcnt lgkmcnt(3)
    ds_read_b128 v[108:111], v3 offset:16
    buffer_store_dwordx4 a[232:235], v9, s[16:19], s78 offen offset:128 sc0 sc1
    v_mfma_f32_16x16x32_bf16 a[224:227], v[112:115], v[88:91], 0
    v_fma_f32 v86, v86, s21, v15
    v_max3_f32 v20, v20, v85, v86
    buffer_store_dwordx4 a[248:251], v10, s[16:19], s78 offen offset:128 sc0 sc1
    buffer_store_dwordx4 a[236:239], v9, s[16:19], s79 offen offset:128 sc0 sc1
    v_mfma_f32_16x16x32_bf16 a[228:231], v[112:115], v[92:95], 0
    v_fma_f32 v87, v87, s21, v15
    v_mfma_f32_16x16x32_bf16 a[232:235], v[112:115], v[96:99], 0
    v_max3_f32 v20, v20, v87, v87
    v_mfma_f32_16x16x32_bf16 a[236:239], v[112:115], v[100:103], 0
    s_waitcnt lgkmcnt(2)
    ds_read_b128 v[112:115], v3 offset:32
    v_mfma_f32_16x16x32_bf16 a[240:243], v[116:119], v[88:91], 0
    buffer_store_dwordx4 a[252:255], v10, s[16:19], s79 offen offset:128 sc0 sc1
    v_mfma_f32_16x16x32_bf16 a[244:247], v[116:119], v[92:95], 0
    v_cmp_lt_f32 vcc, s35, v20
    v_mfma_f32_16x16x32_bf16 a[248:251], v[116:119], v[96:99], 0
    v_mfma_f32_16x16x32_bf16 a[252:255], v[116:119], v[100:103], 0
    s_waitcnt lgkmcnt(1)
    ds_read_b128 v[116:119], v3 offset:48
    s_cbranch_vccnz L_rare_s0b
L_cont_s0b:
    s_add_u32 s76, s76, 33554432
    s_add_u32 s77, s77, 33554432
    s_add_u32 s78, s78, 33554432
    s_add_u32 s79, s79, 33554432
L_s1c:
    v_mfma_f32_16x16x32_bf16 v[24:27], v[104:107], a[0:3], 0
    v_exp_f32 v56, v56
    v_mfma_f32_16x16x32_bf16 v[24:27], v[108:111], a[4:7], v[24:27]
    v_add_u32 v4, s28, v2
    v_add_f32 v16, v16, v56
    v_mfma_f32_16x16x32_bf16 v[32:35], v[104:107], a[32:35], 0
    s_add_u32 s28, s28, s38
    v_exp_f32 v57, v57
    v_mfma_f32_16x16x32_bf16 v[32:35], v[108:111], a[36:39], v[32:35]
    s_sub_u32 s48, s28, s39
    v_exp_f32 v58, v58
    v_mfma_f32_16x16x32_bf16 v[40:43], v[104:107], a[64:67], 0
    s_min_u32 s28, s28, s48
    v_exp_f32 v59, v59
    v_mfma_f32_16x16x32_bf16 v[40:43], v[108:111], a[68:71], v[40:43]
    v_exp_f32 v60, v60
    v_mfma_f32_16x16x32_bf16 v[48:51], v[104:107], a[96:99], 0
    ds_read_b128 v[104:107], v3 offset:256
    v_cvt_pk_bf16_f32 v88, v56, v57
    v_mfma_f32_16x16x32_bf16 v[48:51], v[108:111], a[100:103], v[48:51]
    s_waitcnt lgkmcnt(1)
    ds_read_b128 v[108:111], v3 offset:272
    v_cvt_pk_bf16_f32 v89, v58, v59
    v_mfma_f32_16x16x32_bf16 v[24:27], v[112:115], a[8:11], v[24:27]
    v_exp_f32 v61, v61
    v_mfma_f32_16x16x32_bf16 v[24:27], v[116:119], a[12:15], v[24:27]
    v_exp_f32 v62, v62
    v_mfma_f32_16x16x32_bf16 v[32:35], v[112:115], a[40:43], v[32:35]
    v_exp_f32 v63, v63
    v_mfma_f32_16x16x32_bf16 v[32:35], v[116:119], a[44:47], v[32:35]
    v_exp_f32 v64, v64
    v_mfma_f32_16x16x32_bf16 v[40:43], v[112:115], a[72:75], v[40:43]
    v_exp_f32 v65, v65
    v_mfma_f32_16x16x32_bf16 v[40:43], v[116:119], a[76:79], v[40:43]
    v_exp_f32 v66, v66
    v_mfma_f32_16x16x32_bf16 v[48:51], v[112:115], a[104:107], v[48:51]
    ds_read_b128 v[112:115], v3 offset:288
    v_cvt_pk_bf16_f32 v90, v60, v61
    v_mfma_f32_16x16x32_bf16 v[48:51], v[116:119], a[108:111], v[48:51]
    s_waitcnt lgkmcnt(1)
    ds_read_b128 v[116:119], v3 offset:304
    v_cvt_pk_bf16_f32 v91, v62, v63
    v_mfma_f32_16x16x32_bf16 v[24:27], v[104:107], a[16:19], v[24:27]
    v_exp_f32 v67, v67
    v_mfma_f32_16x16x32_bf16 v[24:27], v[108:111], a[20:23], v[24:27]
    v_exp_f32 v68, v68
    v_mfma_f32_16x16x32_bf16 v[32:35], v[104:107], a[48:51], v[32:35]
    v_exp_f32 v69, v69
    v_mfma_f32_16x16x32_bf16 v[32:35], v[108:111], a[52:55], v[32:35]
    v_exp_f32 v70, v70
    v_mfma_f32_16x16x32_bf16 v[40:43], v[104:107], a[80:83], v[40:43]
    v_exp_f32 v71, v71
    v_mfma_f32_16x16x32_bf16 v[40:43], v[108:111], a[84:87], v[40:43]
    v_exp_f32 v72, v72
    v_mfma_f32_16x16x32_bf16 v[48:51], v[104:107], a[112:115], v[48:51]
    ds_read_b128 v[104:107], v3 offset:512
    v_cvt_pk_bf16_f32 v92, v64, v65
    v_mfma_f32_16x16x32_bf16 v[48:51], v[108:111], a[116:119], v[48:51]
    s_waitcnt lgkmcnt(1)
    ds_read_b128 v[108:111], v3 offset:528
    v_cvt_pk_bf16_f32 v93, v66, v67
    v_mfma_f32_16x16x32_bf16 v[24:27], v[112:115], a[24:27], v[24:27]
    v_exp_f32 v73, v73
    v_mfma_f32_16x16x32_bf16 v[24:27], v[116:119], a[28:31], v[24:27]
    v_exp_f32 v74, v74
    v_mfma_f32_16x16x32_bf16 v[32:35], v[112:115], a[56:59], v[32:35]
    v_exp_f32 v75, v75
    v_mfma_f32_16x16x32_bf16 v[32:35], v[116:119], a[60:63], v[32:35]
    v_exp_f32 v76, v76
    v_mfma_f32_16x16x32_bf16 v[40:43], v[112:115], a[88:91], v[40:43]
    v_exp_f32 v77, v77
    v_mfma_f32_16x16x32_bf16 v[40:43], v[116:119], a[92:95], v[40:43]
    v_exp_f32 v78, v78
    v_mfma_f32_16x16x32_bf16 v[48:51], v[112:115], a[120:123], v[48:51]
    ds_read_b128 v[112:115], v3 offset:544
    v_cvt_pk_bf16_f32 v94, v68, v69
    v_mfma_f32_16x16x32_bf16 v[48:51], v[116:119], a[124:127], v[48:51]
    s_waitcnt lgkmcnt(1)
    ds_read_b128 v[116:119], v3 offset:560
    v_cvt_pk_bf16_f32 v95, v70, v71
    v_mfma_f32_16x16x32_bf16 v[28:31], v[104:107], a[0:3], 0
    v_exp_f32 v79, v79
    v_mfma_f32_16x16x32_bf16 v[28:31], v[108:111], a[4:7], v[28:31]
    v_exp_f32 v80, v80
    v_mfma_f32_16x16x32_bf16 v[36:39], v[104:107], a[32:35], 0
    v_exp_f32 v81, v81
    v_mfma_f32_16x16x32_bf16 v[36:39], v[108:111], a[36:39], v[36:39]
    v_exp_f32 v82, v82
    v_mfma_f32_16x16x32_bf16 v[44:47], v[104:107], a[64:67], 0
    v_exp_f32 v83, v83
    v_mfma_f32_16x16x32_bf16 v[44:47], v[108:111], a[68:71], v[44:47]
    v_exp_f32 v84, v84
    v_mfma_f32_16x16x32_bf16 v[52:55], v[104:107], a[96:99], 0
    ds_read_b128 v[104:107], v3 offset:768
    v_cvt_pk_bf16_f32 v96, v72, v73
    v_mfma_f32_16x16x32_bf16 v[52:55], v[108:111], a[100:103], v[52:55]
    s_waitcnt lgkmcnt(1)
    ds_read_b128 v[108:111], v3 offset:784
    v_cvt_pk_bf16_f32 v97, v74, v75
    v_mfma_f32_16x16x32_bf16 v[28:31], v[112:115], a[8:11], v[28:31]
    v_exp_f32 v85, v85
    v_mfma_f32_16x16x32_bf16 v[28:31], v[116:119], a[12:15], v[28:31]
    v_exp_f32 v86, v86
    v_mfma_f32_16x16x32_bf16 v[36:39], v[112:115], a[40:43], v[36:39]
    v_exp_f32 v87, v87
    v_mfma_f32_16x16x32_bf16 v[36:39], v[116:119], a[44:47], v[36:39]
    v_cvt_pk_bf16_f32 v98, v76, v77
    v_cvt_pk_bf16_f32 v99, v78, v79
    v_mfma_f32_16x16x32_bf16 v[44:47], v[112:115], a[72:75], v[44:47]
    v_cvt_pk_bf16_f32 v100, v80, v81
    v_cvt_pk_bf16_f32 v101, v82, v83
    v_mfma_f32_16x16x32_bf16 v[44:47], v[116:119], a[76:79], v[44:47]
    v_cvt_pk_bf16_f32 v102, v84, v85
    v_cvt_pk_bf16_f32 v103, v86, v87
    v_mfma_f32_16x16x32_bf16 v[52:55], v[112:115], a[104:107], v[52:55]
    ds_read_b128 v[112:115], v3 offset:800
    v_add_f32 v16, v16, v57
    v_mfma_f32_16x16x32_bf16 v[52:55], v[116:119], a[108:111], v[52:55]
    s_waitcnt lgkmcnt(1)
    ds_read_b128 v[116:119], v3 offset:816
    v_add_f32 v16, v16, v58
    v_mfma_f32_16x16x32_bf16 v[28:31], v[104:107], a[16:19], v[28:31]
    v_add_f32 v16, v16, v59
    v_add_f32 v16, v16, v60
    v_mfma_f32_16x16x32_bf16 v[28:31], v[108:111], a[20:23], v[28:31]
    v_add_u32 v3, s28, v1
    v_add_f32 v16, v16, v61
    v_mfma_f32_16x16x32_bf16 v[36:39], v[104:107], a[48:51], v[36:39]
    s_add_u32 s28, s28, s38
    v_add_f32 v16, v16, v62
    v_add_f32 v16, v16, v63
    v_mfma_f32_16x16x32_bf16 v[36:39], v[108:111], a[52:55], v[36:39]
    s_sub_u32 s48, s28, s39
    v_add_f32 v17, v17, v64
    v_add_f32 v17, v17, v65
    v_mfma_f32_16x16x32_bf16 v[44:47], v[104:107], a[80:83], v[44:47]
    s_min_u32 s28, s28, s48
    v_add_f32 v17, v17, v66
    v_add_f32 v17, v17, v67
    v_mfma_f32_16x16x32_bf16 v[44:47], v[108:111], a[84:87], v[44:47]
    v_add_f32 v17, v17, v68
    v_add_f32 v17, v17, v69
    v_mfma_f32_16x16x32_bf16 v[52:55], v[104:107], a[112:115], v[52:55]
    ds_read_b64_tr_b16 v[104:105], v4 offset:0
    v_add_f32 v17, v17, v70
    v_mfma_f32_16x16x32_bf16 v[52:55], v[108:111], a[116:119], v[52:55]
    s_waitcnt lgkmcnt(1)
    ds_read_b64_tr_b16 v[106:107], v4 offset:512
    ds_read_b64_tr_b16 v[108:109], v4 offset:32
    v_mfma_f32_16x16x32_bf16 v[28:31], v[112:115], a[24:27], v[28:31]
    ds_read_b64_tr_b16 v[110:111], v4 offset:544
    v_add_f32 v17, v17, v71
    v_mfma_f32_16x16x32_bf16 v[28:31], v[116:119], a[28:31], v[28:31]
    v_add_f32 v18, v18, v72
    v_add_f32 v18, v18, v73
    v_mfma_f32_16x16x32_bf16 v[36:39], v[112:115], a[56:59], v[36:39]
    v_add_f32 v18, v18, v74
    v_add_f32 v18, v18, v75
    v_mfma_f32_16x16x32_bf16 v[36:39], v[116:119], a[60:63], v[36:39]
    v_add_f32 v18, v18, v76
    v_add_f32 v18, v18, v77
    v_mfma_f32_16x16x32_bf16 v[44:47], v[112:115], a[88:91], v[44:47]
    v_add_f32 v18, v18, v78
    v_add_f32 v18, v18, v79
    v_mfma_f32_16x16x32_bf16 v[44:47], v[116:119], a[92:95], v[44:47]
    v_add_f32 v19, v19, v80
    v_add_f32 v19, v19, v81
    v_mfma_f32_16x16x32_bf16 v[52:55], v[112:115], a[120:123], v[52:55]
    ds_read_b64_tr_b16 v[112:113], v4 offset:64
    v_add_f32 v19, v19, v82
    v_mfma_f32_16x16x32_bf16 v[52:55], v[116:119], a[124:127], v[52:55]
    s_waitcnt lgkmcnt(3)
    ds_read_b64_tr_b16 v[114:115], v4 offset:576
    ds_read_b64_tr_b16 v[116:117], v4 offset:96
    v_mfma_f32_16x16x32_bf16 v[128:131], v[104:107], v[88:91], v[128:131]
    ds_read_b64_tr_b16 v[118:119], v4 offset:608
    v_fma_f32 v24, v24, s21, v12
    v_mfma_f32_16x16x32_bf16 v[132:135], v[104:107], v[92:95], v[132:135]
    v_add_f32 v19, v19, v83
    v_fma_f32 v25, v25, s21, v12
    v_mfma_f32_16x16x32_bf16 v[136:139], v[104:107], v[96:99], v[136:139]
    v_fma_f32 v26, v26, s21, v12
    v_mfma_f32_16x16x32_bf16 v[140:143], v[104:107], v[100:103], v[140:143]
    s_waitcnt lgkmcnt(4)
    ds_read_b64_tr_b16 v[104:105], v4 offset:128
    v_max3_f32 v20, v24, v25, v26
    v_mfma_f32_16x16x32_bf16 v[144:147], v[108:111], v[88:91], v[144:147]
    s_waitcnt vmcnt(8)
    ds_read_b64_tr_b16 v[106:107], v4 offset:640
    v_fma_f32 v27, v27, s21, v12
    v_mfma_f32_16x16x32_bf16 v[148:151], v[108:111], v[92:95], v[148:151]
    v_fma_f32 v32, v32, s21, v13
    v_max3_f32 v20, v20, v27, v32
    v_mfma_f32_16x16x32_bf16 v[152:155], v[108:111], v[96:99], v[152:155]
    s_barrier
    v_fma_f32 v33, v33, s21, v13
    v_mfma_f32_16x16x32_bf16 v[156:159], v[108:111], v[100:103], v[156:159]
    s_waitcnt lgkmcnt(4)
    ds_read_b64_tr_b16 v[108:109], v4 offset:160
    v_fma_f32 v34, v34, s21, v13
    v_mfma_f32_16x16x32_bf16 v[160:163], v[112:115], v[88:91], v[160:163]
    s_add_u32 m0, s29, s30
    ds_read_b64_tr_b16 v[110:111], v4 offset:672
    v_max3_f32 v20, v20, v33, v34
    v_mfma_f32_16x16x32_bf16 v[164:167], v[112:115], v[92:95], v[164:167]
    s_add_u32 s29, s29, s38
    buffer_load_dwordx4 v5, s[8:11], s24 offen offset:0 nt lds
    v_mfma_f32_16x16x32_bf16 v[168:171], v[112:115], v[96:99], v[168:171]
    s_sub_u32 s31, s29, s39
    v_fma_f32 v35, v35, s21, v13
    v_mfma_f32_16x16x32_bf16 v[172:175], v[112:115], v[100:103], v[172:175]
    s_waitcnt lgkmcnt(4)
    ds_read_b64_tr_b16 v[112:113], v4 offset:192
    v_add_f32 v19, v19, v84
    v_mfma_f32_16x16x32_bf16 v[176:179], v[116:119], v[88:91], v[176:179]
    s_min_u32 s29, s29, s31
    ds_read_b64_tr_b16 v[114:115], v4 offset:704
    v_fma_f32 v40, v40, s21, v14
    v_mfma_f32_16x16x32_bf16 v[180:183], v[116:119], v[92:95], v[180:183]
    buffer_load_dwordx4 v6, s[8:11], s24 offen offset:1040 nt lds
    v_mfma_f32_16x16x32_bf16 v[184:187], v[116:119], v[96:99], v[184:187]
    v_max3_f32 v20, v20, v35, v40
    v_fma_f32 v41, v41, s21, v14
    v_mfma_f32_16x16x32_bf16 v[188:191], v[116:119], v[100:103], v[188:191]
    s_waitcnt lgkmcnt(4)
    ds_read_b64_tr_b16 v[116:117], v4 offset:224
    v_mfma_f32_16x16x32_bf16 v[192:195], v[104:107], v[88:91], v[192:195]
    ds_read_b64_tr_b16 v[118:119], v4 offset:736
    v_fma_f32 v42, v42, s21, v14
    v_mfma_f32_16x16x32_bf16 v[196:199], v[104:107], v[92:95], v[196:199]
    buffer_load_dwordx4 v7, s[8:11], s24 offen offset:2080 nt lds
    v_mfma_f32_16x16x32_bf16 v[200:203], v[104:107], v[96:99], v[200:203]
    v_max3_f32 v20, v20, v41, v42
    v_fma_f32 v43, v43, s21, v14
    v_mfma_f32_16x16x32_bf16 v[204:207], v[104:107], v[100:103], v[204:207]
    s_waitcnt lgkmcnt(4)
    ds_read_b64_tr_b16 v[104:105], v4 offset:256
    v_mfma_f32_16x16x32_bf16 v[208:211], v[108:111], v[88:91], v[208:211]
    ds_read_b64_tr_b16 v[106:107], v4 offset:768
    v_fma_f32 v48, v48, s21, v15
    v_mfma_f32_16x16x32_bf16 v[212:215], v[108:111], v[92:95], v[212:215]
    buffer_load_dwordx4 v8, s[8:11], s24 offen offset:3120 nt lds
    v_mfma_f32_16x16x32_bf16 v[216:219], v[108:111], v[96:99], v[216:219]
    s_add_u32 s24, s24, 0x4000
    v_max3_f32 v20, v20, v43, v48
    v_fma_f32 v49, v49, s21, v15
    v_mfma_f32_16x16x32_bf16 v[220:223], v[108:111], v[100:103], v[220:223]
    s_waitcnt lgkmcnt(4)
    ds_read_b64_tr_b16 v[108:109], v4 offset:288
    v_fma_f32 v50, v50, s21, v15
    v_mfma_f32_16x16x32_bf16 v[224:227], v[112:115], v[88:91], v[224:227]
    s_add_u32 m0, s29, s30
    ds_read_b64_tr_b16 v[110:111], v4 offset:800
    v_mfma_f32_16x16x32_bf16 v[228:231], v[112:115], v[92:95], v[228:231]
    s_add_u32 s29, s29, s38
    buffer_load_dwordx4 v5, s[12:15], s25 offen offset:0 nt lds
    v_mfma_f32_16x16x32_bf16 v[232:235], v[112:115], v[96:99], v[232:235]
    s_sub_u32 s31, s29, s39
    v_add_f32 v19, v19, v85
    v_max3_f32 v20, v20, v49, v50
    v_mfma_f32_16x16x32_bf16 v[236:239], v[112:115], v[100:103], v[236:239]
    s_waitcnt lgkmcnt(4)
    ds_read_b64_tr_b16 v[112:113], v4 offset:320
    v_fma_f32 v51, v51, s21, v15
    v_mfma_f32_16x16x32_bf16 v[240:243], v[116:119], v[88:91], v[240:243]
    s_min_u32 s29, s29, s31
    ds_read_b64_tr_b16 v[114:115], v4 offset:832
    v_fma_f32 v28, v28, s21, v12
    v_mfma_f32_16x16x32_bf16 v[244:247], v[116:119], v[92:95], v[244:247]
    buffer_load_dwordx4 v6, s[12:15], s25 offen offset:1040 nt lds
    v_mfma_f32_16x16x32_bf16 v[248:251], v[116:119], v[96:99], v[248:251]
    v_max3_f32 v20, v20, v51, v28
    v_mfma_f32_16x16x32_bf16 v[252:255], v[116:119], v[100:103], v[252:255]
    s_waitcnt lgkmcnt(4)
    ds_read_b64_tr_b16 v[116:117], v4 offset:352
    v_fma_f32 v29, v29, s21, v12
    v_mfma_f32_16x16x32_bf16 a[128:131], v[104:107], v[88:91], a[128:131]
    ds_read_b64_tr_b16 v[118:119], v4 offset:864
    v_fma_f32 v30, v30, s21, v12
    v_mfma_f32_16x16x32_bf16 a[132:135], v[104:107], v[92:95], a[132:135]
    buffer_load_dwordx4 v7, s[12:15], s25 offen offset:2080 nt lds
    v_mfma_f32_16x16x32_bf16 a[136:139], v[104:107], v[96:99], a[136:139]
    v_max3_f32 v20, v20, v29, v30
    v_mfma_f32_16x16x32_bf16 a[140:143], v[104:107], v[100:103], a[140:143]
    s_waitcnt lgkmcnt(4)
    ds_read_b64_tr_b16 v[104:105], v4 offset:384
    v_fma_f32 v31, v31, s21, v12
    v_mfma_f32_16x16x32_bf16 a[144:147], v[108:111], v[88:91], a[144:147]
    ds_read_b64_tr_b16 v[106:107], v4 offset:896
    v_fma_f32 v36, v36, s21, v13
    v_mfma_f32_16x16x32_bf16 a[148:151], v[108:111], v[92:95], a[148:151]
    buffer_load_dwordx4 v8, s[12:15], s25 offen offset:3120 nt lds
    v_mfma_f32_16x16x32_bf16 a[152:155], v[108:111], v[96:99], a[152:155]
    s_add_u32 s25, s25, 0x4000
    v_add_f32 v19, v19, v86
    v_max3_f32 v20, v20, v31, v36
    v_mfma_f32_16x16x32_bf16 a[156:159], v[108:111], v[100:103], a[156:159]
    s_waitcnt lgkmcnt(4)
    ds_read_b64_tr_b16 v[108:109], v4 offset:416
    v_mfma_f32_16x16x32_bf16 a[160:163], v[112:115], v[88:91], a[160:163]
    s_add_u32 m0, s29, s30
    ds_read_b64_tr_b16 v[110:111], v4 offset:928
    v_fma_f32 v37, v37, s21, v13
    v_mfma_f32_16x16x32_bf16 a[164:167], v[112:115], v[92:95], a[164:167]
    s_add_u32 s29, s29, s38
    buffer_load_dwordx4 v5, s[8:11], s24 offen offset:0 nt lds
    v_mfma_f32_16x16x32_bf16 a[168:171], v[112:115], v[96:99], a[168:171]
    s_sub_u32 s31, s29, s39
    v_fma_f32 v38, v38, s21, v13
    v_max3_f32 v20, v20, v37, v38
    v_mfma_f32_16x16x32_bf16 a[172:175], v[112:115], v[100:103], a[172:175]
    s_waitcnt lgkmcnt(4)
    ds_read_b64_tr_b16 v[112:113], v4 offset:448
    v_mfma_f32_16x16x32_bf16 a[176:179], v[116:119], v[88:91], a[176:179]
    s_min_u32 s29, s29, s31
    ds_read_b64_tr_b16 v[114:115], v4 offset:960
    v_fma_f32 v39, v39, s21, v13
    v_mfma_f32_16x16x32_bf16 a[180:183], v[116:119], v[92:95], a[180:183]
    buffer_load_dwordx4 v6, s[8:11], s24 offen offset:1040 nt lds
    v_mfma_f32_16x16x32_bf16 a[184:187], v[116:119], v[96:99], a[184:187]
    v_fma_f32 v44, v44, s21, v14
    v_max3_f32 v20, v20, v39, v44
    v_mfma_f32_16x16x32_bf16 a[188:191], v[116:119], v[100:103], a[188:191]
    s_waitcnt lgkmcnt(4)
    ds_read_b64_tr_b16 v[116:117], v4 offset:480
    v_fma_f32 v45, v45, s21, v14
    v_mfma_f32_16x16x32_bf16 a[192:195], v[104:107], v[88:91], a[192:195]
    ds_read_b64_tr_b16 v[118:119], v4 offset:992
    v_mfma_f32_16x16x32_bf16 a[196:199], v[104:107], v[92:95], a[196:199]
    buffer_load_dwordx4 v7, s[8:11], s24 offen offset:2080 nt lds
    v_mfma_f32_16x16x32_bf16 a[200:203], v[104:107], v[96:99], a[200:203]
    v_fma_f32 v46, v46, s21, v14
    v_max3_f32 v20, v20, v45, v46
    v_mfma_f32_16x16x32_bf16 a[204:207], v[104:107], v[100:103], a[204:207]
    s_waitcnt lgkmcnt(4)
    ds_read_b128 v[104:107], v3 offset:0
    v_add_f32 v19, v19, v87
    v_mfma_f32_16x16x32_bf16 a[208:211], v[108:111], v[88:91], a[208:211]
    buffer_load_dwordx4 v8, s[8:11], s24 offen offset:3120 nt lds
    v_mfma_f32_16x16x32_bf16 a[212:215], v[108:111], v[92:95], a[212:215]
    s_add_u32 s24, s24, 0x4000
    v_fma_f32 v47, v47, s21, v14
    v_mfma_f32_16x16x32_bf16 a[216:219], v[108:111], v[96:99], a[216:219]
    v_fma_f32 v52, v52, s21, v15
    v_max3_f32 v20, v20, v47, v52
    v_mfma_f32_16x16x32_bf16 a[220:223], v[108:111], v[100:103], a[220:223]
    s_waitcnt lgkmcnt(3)
    ds_read_b128 v[108:111], v3 offset:16
    v_fma_f32 v53, v53, s21, v15
    v_mfma_f32_16x16x32_bf16 a[224:227], v[112:115], v[88:91], a[224:227]
    v_fma_f32 v54, v54, s21, v15
    v_mfma_f32_16x16x32_bf16 a[228:231], v[112:115], v[92:95], a[228:231]
    v_max3_f32 v20, v20, v53, v54
    v_fma_f32 v55, v55, s21, v15
    v_mfma_f32_16x16x32_bf16 a[232:235], v[112:115], v[96:99], a[232:235]
    v_max3_f32 v20, v20, v55, v55
    v_mfma_f32_16x16x32_bf16 a[236:239], v[112:115], v[100:103], a[236:239]
    s_waitcnt lgkmcnt(2)
    ds_read_b128 v[112:115], v3 offset:32
    v_mfma_f32_16x16x32_bf16 a[240:243], v[116:119], v[88:91], a[240:243]
    v_mfma_f32_16x16x32_bf16 a[244:247], v[116:119], v[92:95], a[244:247]
    v_cmp_lt_f32 vcc, s35, v20
    v_mfma_f32_16x16x32_bf16 a[248:251], v[116:119], v[96:99], a[248:251]
    v_mfma_f32_16x16x32_bf16 a[252:255], v[116:119], v[100:103], a[252:255]
    s_waitcnt lgkmcnt(1)
    ds_read_b128 v[116:119], v3 offset:48
    s_cbranch_vccnz L_rare_s1c
L_cont_s1c:
    v_mfma_f32_16x16x32_bf16 v[56:59], v[104:107], a[0:3], 0
    v_exp_f32 v24, v24
    v_mfma_f32_16x16x32_bf16 v[56:59], v[108:111], a[4:7], v[56:59]
    v_add_u32 v4, s28, v2
    v_add_f32 v16, v16, v24
    v_mfma_f32_16x16x32_bf16 v[64:67], v[104:107], a[32:35], 0
    s_add_u32 s28, s28, s38
    v_exp_f32 v25, v25
    v_mfma_f32_16x16x32_bf16 v[64:67], v[108:111], a[36:39], v[64:67]
    s_sub_u32 s48, s28, s39
    v_exp_f32 v26, v26
    v_mfma_f32_16x16x32_bf16 v[72:75], v[104:107], a[64:67], 0
    s_min_u32 s28, s28, s48
    v_exp_f32 v27, v27
    v_mfma_f32_16x16x32_bf16 v[72:75], v[108:111], a[68:71], v[72:75]
    v_exp_f32 v28, v28
    v_mfma_f32_16x16x32_bf16 v[80:83], v[104:107], a[96:99], 0
    ds_read_b128 v[104:107], v3 offset:256
    v_cvt_pk_bf16_f32 v88, v24, v25
    v_mfma_f32_16x16x32_bf16 v[80:83], v[108:111], a[100:103], v[80:83]
    s_waitcnt lgkmcnt(1)
    ds_read_b128 v[108:111], v3 offset:272
    v_cvt_pk_bf16_f32 v89, v26, v27
    v_mfma_f32_16x16x32_bf16 v[56:59], v[112:115], a[8:11], v[56:59]
    v_exp_f32 v29, v29
    v_mfma_f32_16x16x32_bf16 v[56:59], v[116:119], a[12:15], v[56:59]
    v_exp_f32 v30, v30
    v_mfma_f32_16x16x32_bf16 v[64:67], v[112:115], a[40:43], v[64:67]
    v_exp_f32 v31, v31
    v_mfma_f32_16x16x32_bf16 v[64:67], v[116:119], a[44:47], v[64:67]
    v_exp_f32 v32, v32
    v_mfma_f32_16x16x32_bf16 v[72:75], v[112:115], a[72:75], v[72:75]
    v_exp_f32 v33, v33
    v_mfma_f32_16x16x32_bf16 v[72:75], v[116:119], a[76:79], v[72:75]
    v_exp_f32 v34, v34
    v_mfma_f32_16x16x32_bf16 v[80:83], v[112:115], a[104:107], v[80:83]
    ds_read_b128 v[112:115], v3 offset:288
    v_cvt_pk_bf16_f32 v90, v28, v29
    v_mfma_f32_16x16x32_bf16 v[80:83], v[116:119], a[108:111], v[80:83]
    s_waitcnt lgkmcnt(1)
    ds_read_b128 v[116:119], v3 offset:304
    v_cvt_pk_bf16_f32 v91, v30, v31
    v_mfma_f32_16x16x32_bf16 v[56:59], v[104:107], a[16:19], v[56:59]
    v_exp_f32 v35, v35
    v_mfma_f32_16x16x32_bf16 v[56:59], v[108:111], a[20:23], v[56:59]
    v_exp_f32 v36, v36
    v_mfma_f32_16x16x32_bf16 v[64:67], v[104:107], a[48:51], v[64:67]
    v_exp_f32 v37, v37
    v_mfma_f32_16x16x32_bf16 v[64:67], v[108:111], a[52:55], v[64:67]
    v_exp_f32 v38, v38
    v_mfma_f32_16x16x32_bf16 v[72:75], v[104:107], a[80:83], v[72:75]
    v_exp_f32 v39, v39
    v_mfma_f32_16x16x32_bf16 v[72:75], v[108:111], a[84:87], v[72:75]
    v_exp_f32 v40, v40
    v_mfma_f32_16x16x32_bf16 v[80:83], v[104:107], a[112:115], v[80:83]
    ds_read_b128 v[104:107], v3 offset:512
    v_cvt_pk_bf16_f32 v92, v32, v33
    v_mfma_f32_16x16x32_bf16 v[80:83], v[108:111], a[116:119], v[80:83]
    s_waitcnt lgkmcnt(1)
    ds_read_b128 v[108:111], v3 offset:528
    v_cvt_pk_bf16_f32 v93, v34, v35
    v_mfma_f32_16x16x32_bf16 v[56:59], v[112:115], a[24:27], v[56:59]
    v_exp_f32 v41, v41
    v_mfma_f32_16x16x32_bf16 v[56:59], v[116:119], a[28:31], v[56:59]
    v_exp_f32 v42, v42
    v_mfma_f32_16x16x32_bf16 v[64:67], v[112:115], a[56:59], v[64:67]
    v_exp_f32 v43, v43
    v_mfma_f32_16x16x32_bf16 v[64:67], v[116:119], a[60:63], v[64:67]
    v_exp_f32 v44, v44
    v_mfma_f32_16x16x32_bf16 v[72:75], v[112:115], a[88:91], v[72:75]
    v_exp_f32 v45, v45
    v_mfma_f32_16x16x32_bf16 v[72:75], v[116:119], a[92:95], v[72:75]
    v_exp_f32 v46, v46
    v_mfma_f32_16x16x32_bf16 v[80:83], v[112:115], a[120:123], v[80:83]
    ds_read_b128 v[112:115], v3 offset:544
    v_cvt_pk_bf16_f32 v94, v36, v37
    v_mfma_f32_16x16x32_bf16 v[80:83], v[116:119], a[124:127], v[80:83]
    s_waitcnt lgkmcnt(1)
    ds_read_b128 v[116:119], v3 offset:560
    v_cvt_pk_bf16_f32 v95, v38, v39
    v_mfma_f32_16x16x32_bf16 v[60:63], v[104:107], a[0:3], 0
    v_exp_f32 v47, v47
    v_mfma_f32_16x16x32_bf16 v[60:63], v[108:111], a[4:7], v[60:63]
    v_exp_f32 v48, v48
    v_mfma_f32_16x16x32_bf16 v[68:71], v[104:107], a[32:35], 0
    v_exp_f32 v49, v49
    v_mfma_f32_16x16x32_bf16 v[68:71], v[108:111], a[36:39], v[68:71]
    v_exp_f32 v50, v50
    v_mfma_f32_16x16x32_bf16 v[76:79], v[104:107], a[64:67], 0
    v_exp_f32 v51, v51
    v_mfma_f32_16x16x32_bf16 v[76:79], v[108:111], a[68:71], v[76:79]
    v_exp_f32 v52, v52
    v_mfma_f32_16x16x32_bf16 v[84:87], v[104:107], a[96:99], 0
    ds_read_b128 v[104:107], v3 offset:768
    v_cvt_pk_bf16_f32 v96, v40, v41
    v_mfma_f32_16x16x32_bf16 v[84:87], v[108:111], a[100:103], v[84:87]
    s_waitcnt lgkmcnt(1)
    ds_read_b128 v[108:111], v3 offset:784
    v_cvt_pk_bf16_f32 v97, v42, v43
    v_mfma_f32_16x16x32_bf16 v[60:63], v[112:115], a[8:11], v[60:63]
    v_exp_f32 v53, v53
    v_mfma_f32_16x16x32_bf16 v[60:63], v[116:119], a[12:15], v[60:63]
    v_exp_f32 v54, v54
    v_mfma_f32_16x16x32_bf16 v[68:71], v[112:115], a[40:43], v[68:71]
    v_exp_f32 v55, v55
    v_mfma_f32_16x16x32_bf16 v[68:71], v[116:119], a[44:47], v[68:71]
    v_cvt_pk_bf16_f32 v98, v44, v45
    v_cvt_pk_bf16_f32 v99, v46, v47
    v_mfma_f32_16x16x32_bf16 v[76:79], v[112:115], a[72:75], v[76:79]
    v_cvt_pk_bf16_f32 v100, v48, v49
    v_cvt_pk_bf16_f32 v101, v50, v51
    v_mfma_f32_16x16x32_bf16 v[76:79], v[116:119], a[76:79], v[76:79]
    v_cvt_pk_bf16_f32 v102, v52, v53
    v_cvt_pk_bf16_f32 v103, v54, v55
    v_mfma_f32_16x16x32_bf16 v[84:87], v[112:115], a[104:107], v[84:87]
    ds_read_b128 v[112:115], v3 offset:800
    v_add_f32 v16, v16, v25
    v_mfma_f32_16x16x32_bf16 v[84:87], v[116:119], a[108:111], v[84:87]
    s_waitcnt lgkmcnt(1)
    ds_read_b128 v[116:119], v3 offset:816
    v_add_f32 v16, v16, v26
    v_mfma_f32_16x16x32_bf16 v[60:63], v[104:107], a[16:19], v[60:63]
    v_add_f32 v16, v16, v27
    v_add_f32 v16, v16, v28
    v_mfma_f32_16x16x32_bf16 v[60:63], v[108:111], a[20:23], v[60:63]
    v_add_u32 v3, s28, v1
    v_add_f32 v16, v16, v29
    v_mfma_f32_16x16x32_bf16 v[68:71], v[104:107], a[48:51], v[68:71]
    s_add_u32 s28, s28, s38
    v_add_f32 v16, v16, v30
    v_add_f32 v16, v16, v31
    v_mfma_f32_16x16x32_bf16 v[68:71], v[108:111], a[52:55], v[68:71]
    s_sub_u32 s48, s28, s39
    v_add_f32 v17, v17, v32
    v_add_f32 v17, v17, v33
    v_mfma_f32_16x16x32_bf16 v[76:79], v[104:107], a[80:83], v[76:79]
    s_min_u32 s28, s28, s48
    v_add_f32 v17, v17, v34
    v_add_f32 v17, v17, v35
    v_mfma_f32_16x16x32_bf16 v[76:79], v[108:111], a[84:87], v[76:79]
    v_add_f32 v17, v17, v36
    v_add_f32 v17, v17, v37
    v_mfma_f32_16x16x32_bf16 v[84:87], v[104:107], a[112:115], v[84:87]
    ds_read_b64_tr_b16 v[104:105], v4 offset:0
    v_add_f32 v17, v17, v38
    v_mfma_f32_16x16x32_bf16 v[84:87], v[108:111], a[116:119], v[84:87]
    s_waitcnt lgkmcnt(1)
    ds_read_b64_tr_b16 v[106:107], v4 offset:512
    ds_read_b64_tr_b16 v[108:109], v4 offset:32
    v_mfma_f32_16x16x32_bf16 v[60:63], v[112:115], a[24:27], v[60:63]
    ds_read_b64_tr_b16 v[110:111], v4 offset:544
    v_add_f32 v17, v17, v39
    v_mfma_f32_16x16x32_bf16 v[60:63], v[116:119], a[28:31], v[60:63]
    v_add_f32 v18, v18, v40
    v_add_f32 v18, v18, v41
    v_mfma_f32_16x16x32_bf16 v[68:71], v[112:115], a[56:59], v[68:71]
    v_add_f32 v18, v18, v42
    v_add_f32 v18, v18, v43
    v_mfma_f32_16x16x32_bf16 v[68:71], v[116:119], a[60:63], v[68:71]
    v_add_f32 v18, v18, v44
    v_add_f32 v18, v18, v45
    v_mfma_f32_16x16x32_bf16 v[76:79], v[112:115], a[88:91], v[76:79]
    v_add_f32 v18, v18, v46
    v_add_f32 v18, v18, v47
    v_mfma_f32_16x16x32_bf16 v[76:79], v[116:119], a[92:95], v[76:79]
    v_add_f32 v19, v19, v48
    v_add_f32 v19, v19, v49
    v_mfma_f32_16x16x32_bf16 v[84:87], v[112:115], a[120:123], v[84:87]
    ds_read_b64_tr_b16 v[112:113], v4 offset:64
    v_add_f32 v19, v19, v50
    v_mfma_f32_16x16x32_bf16 v[84:87], v[116:119], a[124:127], v[84:87]
    s_waitcnt lgkmcnt(3)
    ds_read_b64_tr_b16 v[114:115], v4 offset:576
    ds_read_b64_tr_b16 v[116:117], v4 offset:96
    v_mfma_f32_16x16x32_bf16 v[128:131], v[104:107], v[88:91], v[128:131]
    ds_read_b64_tr_b16 v[118:119], v4 offset:608
    v_fma_f32 v56, v56, s21, v12
    v_mfma_f32_16x16x32_bf16 v[132:135], v[104:107], v[92:95], v[132:135]
    v_add_f32 v19, v19, v51
    v_fma_f32 v57, v57, s21, v12
    v_mfma_f32_16x16x32_bf16 v[136:139], v[104:107], v[96:99], v[136:139]
    v_fma_f32 v58, v58, s21, v12
    v_mfma_f32_16x16x32_bf16 v[140:143], v[104:107], v[100:103], v[140:143]
    s_waitcnt lgkmcnt(4)
    ds_read_b64_tr_b16 v[104:105], v4 offset:128
    v_max3_f32 v20, v56, v57, v58
    v_mfma_f32_16x16x32_bf16 v[144:147], v[108:111], v[88:91], v[144:147]
    s_waitcnt vmcnt(12)
    ds_read_b64_tr_b16 v[106:107], v4 offset:640
    v_fma_f32 v59, v59, s21, v12
    v_mfma_f32_16x16x32_bf16 v[148:151], v[108:111], v[92:95], v[148:151]
    v_fma_f32 v64, v64, s21, v13
    v_max3_f32 v20, v20, v59, v64
    v_mfma_f32_16x16x32_bf16 v[152:155], v[108:111], v[96:99], v[152:155]
    s_barrier
    v_fma_f32 v65, v65, s21, v13
    v_mfma_f32_16x16x32_bf16 v[156:159], v[108:111], v[100:103], v[156:159]
    s_waitcnt lgkmcnt(4)
    ds_read_b64_tr_b16 v[108:109], v4 offset:160
    v_fma_f32 v66, v66, s21, v13
    v_mfma_f32_16x16x32_bf16 v[160:163], v[112:115], v[88:91], v[160:163]
    s_add_u32 m0, s29, s30
    ds_read_b64_tr_b16 v[110:111], v4 offset:672
    v_max3_f32 v20, v20, v65, v66
    v_mfma_f32_16x16x32_bf16 v[164:167], v[112:115], v[92:95], v[164:167]
    s_add_u32 s29, s29, s38
    buffer_load_dwordx4 v5, s[12:15], s25 offen offset:0 nt lds
    v_mfma_f32_16x16x32_bf16 v[168:171], v[112:115], v[96:99], v[168:171]
    s_sub_u32 s31, s29, s39
    v_fma_f32 v67, v67, s21, v13
    v_mfma_f32_16x16x32_bf16 v[172:175], v[112:115], v[100:103], v[172:175]
    s_waitcnt lgkmcnt(4)
    ds_read_b64_tr_b16 v[112:113], v4 offset:192
    v_add_f32 v19, v19, v52
    v_mfma_f32_16x16x32_bf16 v[176:179], v[116:119], v[88:91], v[176:179]
    s_min_u32 s29, s29, s31
    ds_read_b64_tr_b16 v[114:115], v4 offset:704
    v_fma_f32 v72, v72, s21, v14
    v_mfma_f32_16x16x32_bf16 v[180:183], v[116:119], v[92:95], v[180:183]
    buffer_load_dwordx4 v6, s[12:15], s25 offen offset:1040 nt lds
    v_mfma_f32_16x16x32_bf16 v[184:187], v[116:119], v[96:99], v[184:187]
    v_max3_f32 v20, v20, v67, v72
    v_fma_f32 v73, v73, s21, v14
    v_mfma_f32_16x16x32_bf16 v[188:191], v[116:119], v[100:103], v[188:191]
    s_waitcnt lgkmcnt(4)
    ds_read_b64_tr_b16 v[116:117], v4 offset:224
    v_mfma_f32_16x16x32_bf16 v[192:195], v[104:107], v[88:91], v[192:195]
    ds_read_b64_tr_b16 v[118:119], v4 offset:736
    v_fma_f32 v74, v74, s21, v14
    v_mfma_f32_16x16x32_bf16 v[196:199], v[104:107], v[92:95], v[196:199]
    buffer_load_dwordx4 v7, s[12:15], s25 offen offset:2080 nt lds
    v_mfma_f32_16x16x32_bf16 v[200:203], v[104:107], v[96:99], v[200:203]
    v_max3_f32 v20, v20, v73, v74
    v_fma_f32 v75, v75, s21, v14
    v_mfma_f32_16x16x32_bf16 v[204:207], v[104:107], v[100:103], v[204:207]
    s_waitcnt lgkmcnt(4)
    ds_read_b64_tr_b16 v[104:105], v4 offset:256
    v_mfma_f32_16x16x32_bf16 v[208:211], v[108:111], v[88:91], v[208:211]
    ds_read_b64_tr_b16 v[106:107], v4 offset:768
    v_fma_f32 v80, v80, s21, v15
    v_mfma_f32_16x16x32_bf16 v[212:215], v[108:111], v[92:95], v[212:215]
    buffer_load_dwordx4 v8, s[12:15], s25 offen offset:3120 nt lds
    v_mfma_f32_16x16x32_bf16 v[216:219], v[108:111], v[96:99], v[216:219]
    s_add_u32 s25, s25, 0x4000
    v_max3_f32 v20, v20, v75, v80
    v_fma_f32 v81, v81, s21, v15
    v_mfma_f32_16x16x32_bf16 v[220:223], v[108:111], v[100:103], v[220:223]
    s_waitcnt lgkmcnt(4)
    ds_read_b64_tr_b16 v[108:109], v4 offset:288
    v_fma_f32 v82, v82, s21, v15
    v_mfma_f32_16x16x32_bf16 v[224:227], v[112:115], v[88:91], v[224:227]
    s_add_u32 m0, s29, s30
    ds_read_b64_tr_b16 v[110:111], v4 offset:800
    v_mfma_f32_16x16x32_bf16 v[228:231], v[112:115], v[92:95], v[228:231]
    s_add_u32 s29, s29, s38
    buffer_load_dwordx4 v5, s[8:11], s24 offen offset:0 nt lds
    v_mfma_f32_16x16x32_bf16 v[232:235], v[112:115], v[96:99], v[232:235]
    s_sub_u32 s31, s29, s39
    v_add_f32 v19, v19, v53
    v_max3_f32 v20, v20, v81, v82
    v_mfma_f32_16x16x32_bf16 v[236:239], v[112:115], v[100:103], v[236:239]
    s_waitcnt lgkmcnt(4)
    ds_read_b64_tr_b16 v[112:113], v4 offset:320
    v_fma_f32 v83, v83, s21, v15
    v_mfma_f32_16x16x32_bf16 v[240:243], v[116:119], v[88:91], v[240:243]
    s_min_u32 s29, s29, s31
    ds_read_b64_tr_b16 v[114:115], v4 offset:832
    v_fma_f32 v60, v60, s21, v12
    v_mfma_f32_16x16x32_bf16 v[244:247], v[116:119], v[92:95], v[244:247]
    buffer_load_dwordx4 v6, s[8:11], s24 offen offset:1040 nt lds
    v_mfma_f32_16x16x32_bf16 v[248:251], v[116:119], v[96:99], v[248:251]
    v_max3_f32 v20, v20, v83, v60
    v_mfma_f32_16x16x32_bf16 v[252:255], v[116:119], v[100:103], v[252:255]
    s_waitcnt lgkmcnt(4)
    ds_read_b64_tr_b16 v[116:117], v4 offset:352
    v_fma_f32 v61, v61, s21, v12
    v_mfma_f32_16x16x32_bf16 a[128:131], v[104:107], v[88:91], a[128:131]
    ds_read_b64_tr_b16 v[118:119], v4 offset:864
    v_fma_f32 v62, v62, s21, v12
    v_mfma_f32_16x16x32_bf16 a[132:135], v[104:107], v[92:95], a[132:135]
    buffer_load_dwordx4 v7, s[8:11], s24 offen offset:2080 nt lds
    v_mfma_f32_16x16x32_bf16 a[136:139], v[104:107], v[96:99], a[136:139]
    v_max3_f32 v20, v20, v61, v62
    v_mfma_f32_16x16x32_bf16 a[140:143], v[104:107], v[100:103], a[140:143]
    s_waitcnt lgkmcnt(4)
    ds_read_b64_tr_b16 v[104:105], v4 offset:384
    v_fma_f32 v63, v63, s21, v12
    v_mfma_f32_16x16x32_bf16 a[144:147], v[108:111], v[88:91], a[144:147]
    ds_read_b64_tr_b16 v[106:107], v4 offset:896
    v_fma_f32 v68, v68, s21, v13
    v_mfma_f32_16x16x32_bf16 a[148:151], v[108:111], v[92:95], a[148:151]
    buffer_load_dwordx4 v8, s[8:11], s24 offen offset:3120 nt lds
    v_mfma_f32_16x16x32_bf16 a[152:155], v[108:111], v[96:99], a[152:155]
    s_add_u32 s24, s24, 0x4000
    v_add_f32 v19, v19, v54
    v_max3_f32 v20, v20, v63, v68
    v_mfma_f32_16x16x32_bf16 a[156:159], v[108:111], v[100:103], a[156:159]
    s_waitcnt lgkmcnt(4)
    ds_read_b64_tr_b16 v[108:109], v4 offset:416
    v_mfma_f32_16x16x32_bf16 a[160:163], v[112:115], v[88:91], a[160:163]
    s_add_u32 m0, s29, s30
    ds_read_b64_tr_b16 v[110:111], v4 offset:928
    v_fma_f32 v69, v69, s21, v13
    v_mfma_f32_16x16x32_bf16 a[164:167], v[112:115], v[92:95], a[164:167]
    s_add_u32 s29, s29, s38
    buffer_load_dwordx4 v5, s[12:15], s25 offen offset:0 nt lds
    v_mfma_f32_16x16x32_bf16 a[168:171], v[112:115], v[96:99], a[168:171]
    s_sub_u32 s31, s29, s39
    v_fma_f32 v70, v70, s21, v13
    v_max3_f32 v20, v20, v69, v70
    v_mfma_f32_16x16x32_bf16 a[172:175], v[112:115], v[100:103], a[172:175]
    s_waitcnt lgkmcnt(4)
    ds_read_b64_tr_b16 v[112:113], v4 offset:448
    v_mfma_f32_16x16x32_bf16 a[176:179], v[116:119], v[88:91], a[176:179]
    s_min_u32 s29, s29, s31
    ds_read_b64_tr_b16 v[114:115], v4 offset:960
    v_fma_f32 v71, v71, s21, v13
    v_mfma_f32_16x16x32_bf16 a[180:183], v[116:119], v[92:95], a[180:183]
    buffer_load_dwordx4 v6, s[12:15], s25 offen offset:1040 nt lds
    v_mfma_f32_16x16x32_bf16 a[184:187], v[116:119], v[96:99], a[184:187]
    v_fma_f32 v76, v76, s21, v14
    v_max3_f32 v20, v20, v71, v76
    v_mfma_f32_16x16x32_bf16 a[188:191], v[116:119], v[100:103], a[188:191]
    s_waitcnt lgkmcnt(4)
    ds_read_b64_tr_b16 v[116:117], v4 offset:480
    v_fma_f32 v77, v77, s21, v14
    v_mfma_f32_16x16x32_bf16 a[192:195], v[104:107], v[88:91], a[192:195]
    ds_read_b64_tr_b16 v[118:119], v4 offset:992
    v_mfma_f32_16x16x32_bf16 a[196:199], v[104:107], v[92:95], a[196:199]
    buffer_load_dwordx4 v7, s[12:15], s25 offen offset:2080 nt lds
    v_mfma_f32_16x16x32_bf16 a[200:203], v[104:107], v[96:99], a[200:203]
    v_fma_f32 v78, v78, s21, v14
    v_max3_f32 v20, v20, v77, v78
    v_mfma_f32_16x16x32_bf16 a[204:207], v[104:107], v[100:103], a[204:207]
    s_waitcnt lgkmcnt(4)
    ds_read_b128 v[104:107], v3 offset:0
    v_add_f32 v19, v19, v55
    v_mfma_f32_16x16x32_bf16 a[208:211], v[108:111], v[88:91], a[208:211]
    buffer_load_dwordx4 v8, s[12:15], s25 offen offset:3120 nt lds
    v_mfma_f32_16x16x32_bf16 a[212:215], v[108:111], v[92:95], a[212:215]
    s_add_u32 s25, s25, 0x4000
    v_fma_f32 v79, v79, s21, v14
    v_mfma_f32_16x16x32_bf16 a[216:219], v[108:111], v[96:99], a[216:219]
    v_fma_f32 v84, v84, s21, v15
    v_max3_f32 v20, v20, v79, v84
    v_mfma_f32_16x16x32_bf16 a[220:223], v[108:111], v[100:103], a[220:223]
    s_waitcnt lgkmcnt(3)
    ds_read_b128 v[108:111], v3 offset:16
    v_fma_f32 v85, v85, s21, v15
    v_mfma_f32_16x16x32_bf16 a[224:227], v[112:115], v[88:91], a[224:227]
    v_fma_f32 v86, v86, s21, v15
    v_mfma_f32_16x16x32_bf16 a[228:231], v[112:115], v[92:95], a[228:231]
    v_max3_f32 v20, v20, v85, v86
    v_fma_f32 v87, v87, s21, v15
    v_mfma_f32_16x16x32_bf16 a[232:235], v[112:115], v[96:99], a[232:235]
    v_max3_f32 v20, v20, v87, v87
    v_mfma_f32_16x16x32_bf16 a[236:239], v[112:115], v[100:103], a[236:239]
    s_waitcnt lgkmcnt(2)
    ds_read_b128 v[112:115], v3 offset:32
    v_mfma_f32_16x16x32_bf16 a[240:243], v[116:119], v[88:91], a[240:243]
    v_mfma_f32_16x16x32_bf16 a[244:247], v[116:119], v[92:95], a[244:247]
    v_cmp_lt_f32 vcc, s35, v20
    v_mfma_f32_16x16x32_bf16 a[248:251], v[116:119], v[96:99], a[248:251]
    v_mfma_f32_16x16x32_bf16 a[252:255], v[116:119], v[100:103], a[252:255]
    s_waitcnt lgkmcnt(1)
    ds_read_b128 v[116:119], v3 offset:48
    s_cbranch_vccnz L_rare_s2c
L_cont_s2c:
    s_mov_b32 s32, 4
L_loop2:
    v_mfma_f32_16x16x32_bf16 v[24:27], v[104:107], a[0:3], 0
    v_exp_f32 v56, v56
    v_mfma_f32_16x16x32_bf16 v[24:27], v[108:111], a[4:7], v[24:27]
    v_add_u32 v4, s28, v2
    v_add_f32 v16, v16, v56
    v_mfma_f32_16x16x32_bf16 v[32:35], v[104:107], a[32:35], 0
    s_add_u32 s28, s28, s38
    v_exp_f32 v57, v57
    v_mfma_f32_16x16x32_bf16 v[32:35], v[108:111], a[36:39], v[32:35]
    s_sub_u32 s48, s28, s39
    v_exp_f32 v58, v58
    v_mfma_f32_16x16x32_bf16 v[40:43], v[104:107], a[64:67], 0
    s_min_u32 s28, s28, s48
    v_exp_f32 v59, v59
    v_mfma_f32_16x16x32_bf16 v[40:43], v[108:111], a[68:71], v[40:43]
    v_exp_f32 v60, v60
    v_mfma_f32_16x16x32_bf16 v[48:51], v[104:107], a[96:99], 0
    ds_read_b128 v[104:107], v3 offset:256
    v_cvt_pk_bf16_f32 v88, v56, v57
    v_mfma_f32_16x16x32_bf16 v[48:51], v[108:111], a[100:103], v[48:51]
    s_waitcnt lgkmcnt(1)
    ds_read_b128 v[108:111], v3 offset:272
    v_cvt_pk_bf16_f32 v89, v58, v59
    v_mfma_f32_16x16x32_bf16 v[24:27], v[112:115], a[8:11], v[24:27]
    v_exp_f32 v61, v61
    v_mfma_f32_16x16x32_bf16 v[24:27], v[116:119], a[12:15], v[24:27]
    v_exp_f32 v62, v62
    v_mfma_f32_16x16x32_bf16 v[32:35], v[112:115], a[40:43], v[32:35]
    v_exp_f32 v63, v63
    v_mfma_f32_16x16x32_bf16 v[32:35], v[116:119], a[44:47], v[32:35]
    v_exp_f32 v64, v64
    v_mfma_f32_16x16x32_bf16 v[40:43], v[112:115], a[72:75], v[40:43]
    v_exp_f32 v65, v65
    v_mfma_f32_16x16x32_bf16 v[40:43], v[116:119], a[76:79], v[40:43]
    v_exp_f32 v66, v66
    v_mfma_f32_16x16x32_bf16 v[48:51], v[112:115], a[104:107], v[48:51]
    ds_read_b128 v[112:115], v3 offset:288
    v_cvt_pk_bf16_f32 v90, v60, v61
    v_mfma_f32_16x16x32_bf16 v[48:51], v[116:119], a[108:111], v[48:51]
    s_waitcnt lgkmcnt(1)
    ds_read_b128 v[116:119], v3 offset:304
    v_cvt_pk_bf16_f32 v91, v62, v63
    v_mfma_f32_16x16x32_bf16 v[24:27], v[104:107], a[16:19], v[24:27]
    v_exp_f32 v67, v67
    v_mfma_f32_16x16x32_bf16 v[24:27], v[108:111], a[20:23], v[24:27]
    v_exp_f32 v68, v68
    v_mfma_f32_16x16x32_bf16 v[32:35], v[104:107], a[48:51], v[32:35]
    v_exp_f32 v69, v69
    v_mfma_f32_16x16x32_bf16 v[32:35], v[108:111], a[52:55], v[32:35]
    v_exp_f32 v70, v70
    v_mfma_f32_16x16x32_bf16 v[40:43], v[104:107], a[80:83], v[40:43]
    v_exp_f32 v71, v71
    v_mfma_f32_16x16x32_bf16 v[40:43], v[108:111], a[84:87], v[40:43]
    v_exp_f32 v72, v72
    v_mfma_f32_16x16x32_bf16 v[48:51], v[104:107], a[112:115], v[48:51]
    ds_read_b128 v[104:107], v3 offset:512
    v_cvt_pk_bf16_f32 v92, v64, v65
    v_mfma_f32_16x16x32_bf16 v[48:51], v[108:111], a[116:119], v[48:51]
    s_waitcnt lgkmcnt(1)
    ds_read_b128 v[108:111], v3 offset:528
    v_cvt_pk_bf16_f32 v93, v66, v67
    v_mfma_f32_16x16x32_bf16 v[24:27], v[112:115], a[24:27], v[24:27]
    v_exp_f32 v73, v73
    v_mfma_f32_16x16x32_bf16 v[24:27], v[116:119], a[28:31], v[24:27]
    v_exp_f32 v74, v74
    v_mfma_f32_16x16x32_bf16 v[32:35], v[112:115], a[56:59], v[32:35]
    v_exp_f32 v75, v75
    v_mfma_f32_16x16x32_bf16 v[32:35], v[116:119], a[60:63], v[32:35]
    v_exp_f32 v76, v76
    v_mfma_f32_16x16x32_bf16 v[40:43], v[112:115], a[88:91], v[40:43]
    v_exp_f32 v77, v77
    v_mfma_f32_16x16x32_bf16 v[40:43], v[116:119], a[92:95], v[40:43]
    v_exp_f32 v78, v78
    v_mfma_f32_16x16x32_bf16 v[48:51], v[112:115], a[120:123], v[48:51]
    ds_read_b128 v[112:115], v3 offset:544
    v_cvt_pk_bf16_f32 v94, v68, v69
    v_mfma_f32_16x16x32_bf16 v[48:51], v[116:119], a[124:127], v[48:51]
    s_waitcnt lgkmcnt(1)
    ds_read_b128 v[116:119], v3 offset:560
    v_cvt_pk_bf16_f32 v95, v70, v71
    v_mfma_f32_16x16x32_bf16 v[28:31], v[104:107], a[0:3], 0
    v_exp_f32 v79, v79
    v_mfma_f32_16x16x32_bf16 v[28:31], v[108:111], a[4:7], v[28:31]
    v_exp_f32 v80, v80
    v_mfma_f32_16x16x32_bf16 v[36:39], v[104:107], a[32:35], 0
    v_exp_f32 v81, v81
    v_mfma_f32_16x16x32_bf16 v[36:39], v[108:111], a[36:39], v[36:39]
    v_exp_f32 v82, v82
    v_mfma_f32_16x16x32_bf16 v[44:47], v[104:107], a[64:67], 0
    v_exp_f32 v83, v83
    v_mfma_f32_16x16x32_bf16 v[44:47], v[108:111], a[68:71], v[44:47]
    v_exp_f32 v84, v84
    v_mfma_f32_16x16x32_bf16 v[52:55], v[104:107], a[96:99], 0
    ds_read_b128 v[104:107], v3 offset:768
    v_cvt_pk_bf16_f32 v96, v72, v73
    v_mfma_f32_16x16x32_bf16 v[52:55], v[108:111], a[100:103], v[52:55]
    s_waitcnt lgkmcnt(1)
    ds_read_b128 v[108:111], v3 offset:784
    v_cvt_pk_bf16_f32 v97, v74, v75
    v_mfma_f32_16x16x32_bf16 v[28:31], v[112:115], a[8:11], v[28:31]
    v_exp_f32 v85, v85
    v_mfma_f32_16x16x32_bf16 v[28:31], v[116:119], a[12:15], v[28:31]
    v_exp_f32 v86, v86
    v_mfma_f32_16x16x32_bf16 v[36:39], v[112:115], a[40:43], v[36:39]
    v_exp_f32 v87, v87
    v_mfma_f32_16x16x32_bf16 v[36:39], v[116:119], a[44:47], v[36:39]
    v_cvt_pk_bf16_f32 v98, v76, v77
    v_cvt_pk_bf16_f32 v99, v78, v79
    v_mfma_f32_16x16x32_bf16 v[44:47], v[112:115], a[72:75], v[44:47]
    v_cvt_pk_bf16_f32 v100, v80, v81
    v_cvt_pk_bf16_f32 v101, v82, v83
    v_mfma_f32_16x16x32_bf16 v[44:47], v[116:119], a[76:79], v[44:47]
    v_cvt_pk_bf16_f32 v102, v84, v85
    v_cvt_pk_bf16_f32 v103, v86, v87
    v_mfma_f32_16x16x32_bf16 v[52:55], v[112:115], a[104:107], v[52:55]
    ds_read_b128 v[112:115], v3 offset:800
    v_add_f32 v16, v16, v57
    v_mfma_f32_16x16x32_bf16 v[52:55], v[116:119], a[108:111], v[52:55]
    s_waitcnt lgkmcnt(1)
    ds_read_b128 v[116:119], v3 offset:816
    v_add_f32 v16, v16, v58
    v_mfma_f32_16x16x32_bf16 v[28:31], v[104:107], a[16:19], v[28:31]
    v_add_f32 v16, v16, v59
    v_add_f32 v16, v16, v60
    v_mfma_f32_16x16x32_bf16 v[28:31], v[108:111], a[20:23], v[28:31]
    v_add_u32 v3, s28, v1
    v_add_f32 v16, v16, v61
    v_mfma_f32_16x16x32_bf16 v[36:39], v[104:107], a[48:51], v[36:39]
    s_add_u32 s28, s28, s38
    v_add_f32 v16, v16, v62
    v_add_f32 v16, v16, v63
    v_mfma_f32_16x16x32_bf16 v[36:39], v[108:111], a[52:55], v[36:39]
    s_sub_u32 s48, s28, s39
    v_add_f32 v17, v17, v64
    v_add_f32 v17, v17, v65
    v_mfma_f32_16x16x32_bf16 v[44:47], v[104:107], a[80:83], v[44:47]
    s_min_u32 s28, s28, s48
    v_add_f32 v17, v17, v66
    v_add_f32 v17, v17, v67
    v_mfma_f32_16x16x32_bf16 v[44:47], v[108:111], a[84:87], v[44:47]
    v_add_f32 v17, v17, v68
    v_add_f32 v17, v17, v69
    v_mfma_f32_16x16x32_bf16 v[52:55], v[104:107], a[112:115], v[52:55]
    ds_read_b64_tr_b16 v[104:105], v4 offset:0
    v_add_f32 v17, v17, v70
    v_mfma_f32_16x16x32_bf16 v[52:55], v[108:111], a[116:119], v[52:55]
    s_waitcnt lgkmcnt(1)
    ds_read_b64_tr_b16 v[106:107], v4 offset:512
    ds_read_b64_tr_b16 v[108:109], v4 offset:32
    v_mfma_f32_16x16x32_bf16 v[28:31], v[112:115], a[24:27], v[28:31]
    ds_read_b64_tr_b16 v[110:111], v4 offset:544
    v_add_f32 v17, v17, v71
    v_mfma_f32_16x16x32_bf16 v[28:31], v[116:119], a[28:31], v[28:31]
    v_add_f32 v18, v18, v72
    v_add_f32 v18, v18, v73
    v_mfma_f32_16x16x32_bf16 v[36:39], v[112:115], a[56:59], v[36:39]
    v_add_f32 v18, v18, v74
    v_add_f32 v18, v18, v75
    v_mfma_f32_16x16x32_bf16 v[36:39], v[116:119], a[60:63], v[36:39]
    v_add_f32 v18, v18, v76
    v_add_f32 v18, v18, v77
    v_mfma_f32_16x16x32_bf16 v[44:47], v[112:115], a[88:91], v[44:47]
    v_add_f32 v18, v18, v78
    v_add_f32 v18, v18, v79
    v_mfma_f32_16x16x32_bf16 v[44:47], v[116:119], a[92:95], v[44:47]
    v_add_f32 v19, v19, v80
    v_add_f32 v19, v19, v81
    v_mfma_f32_16x16x32_bf16 v[52:55], v[112:115], a[120:123], v[52:55]
    ds_read_b64_tr_b16 v[112:113], v4 offset:64
    v_add_f32 v19, v19, v82
    v_mfma_f32_16x16x32_bf16 v[52:55], v[116:119], a[124:127], v[52:55]
    s_waitcnt lgkmcnt(3)
    ds_read_b64_tr_b16 v[114:115], v4 offset:576
    ds_read_b64_tr_b16 v[116:117], v4 offset:96
    v_mfma_f32_16x16x32_bf16 v[128:131], v[104:107], v[88:91], v[128:131]
    ds_read_b64_tr_b16 v[118:119], v4 offset:608
    v_fma_f32 v24, v24, s21, v12
    v_mfma_f32_16x16x32_bf16 v[132:135], v[104:107], v[92:95], v[132:135]
    v_add_f32 v19, v19, v83
    v_fma_f32 v25, v25, s21, v12
    v_mfma_f32_16x16x32_bf16 v[136:139], v[104:107], v[96:99], v[136:139]
    v_fma_f32 v26, v26, s21, v12
    v_mfma_f32_16x16x32_bf16 v[140:143], v[104:107], v[100:103], v[140:143]
    s_waitcnt lgkmcnt(4)
    ds_read_b64_tr_b16 v[104:105], v4 offset:128
    v_max3_f32 v20, v24, v25, v26
    v_mfma_f32_16x16x32_bf16 v[144:147], v[108:111], v[88:91], v[144:147]
    s_waitcnt vmcnt(16)
    ds_read_b64_tr_b16 v[106:107], v4 offset:640
    v_mfma_f32_16x16x32_bf16 v[148:151], v[108:111], v[92:95], v[148:151]
    v_fma_f32 v27, v27, s21, v12
    v_fma_f32 v32, v32, s21, v13
    v_mfma_f32_16x16x32_bf16 v[152:155], v[108:111], v[96:99], v[152:155]
    s_barrier
    v_max3_f32 v20, v20, v27, v32
    v_mfma_f32_16x16x32_bf16 v[156:159], v[108:111], v[100:103], v[156:159]
    s_waitcnt lgkmcnt(4)
    ds_read_b64_tr_b16 v[108:109], v4 offset:160
    v_fma_f32 v33, v33, s21, v13
    v_mfma_f32_16x16x32_bf16 v[160:163], v[112:115], v[88:91], v[160:163]
    s_add_u32 m0, s29, s30
    ds_read_b64_tr_b16 v[110:111], v4 offset:672
    v_fma_f32 v34, v34, s21, v13
    v_mfma_f32_16x16x32_bf16 v[164:167], v[112:115], v[92:95], v[164:167]
    s_add_u32 s29, s29, s38
    buffer_load_dwordx4 v5, s[8:11], s24 offen offset:0 nt lds
    v_mfma_f32_16x16x32_bf16 v[168:171], v[112:115], v[96:99], v[168:171]
    s_sub_u32 s31, s29, s39
    v_max3_f32 v20, v20, v33, v34
    v_mfma_f32_16x16x32_bf16 v[172:175], v[112:115], v[100:103], v[172:175]
    s_waitcnt lgkmcnt(4)
    ds_read_b64_tr_b16 v[112:113], v4 offset:192
    v_fma_f32 v35, v35, s21, v13
    v_mfma_f32_16x16x32_bf16 v[176:179], v[116:119], v[88:91], v[176:179]
    s_min_u32 s29, s29, s31
    ds_read_b64_tr_b16 v[114:115], v4 offset:704
    v_add_f32 v19, v19, v84
    v_mfma_f32_16x16x32_bf16 v[180:183], v[116:119], v[92:95], v[180:183]
    v_fma_f32 v40, v40, s21, v14
    v_mfma_f32_16x16x32_bf16 v[184:187], v[116:119], v[96:99], v[184:187]
    buffer_load_dwordx4 v6, s[8:11], s24 offen offset:1040 nt lds
    v_mfma_f32_16x16x32_bf16 v[188:191], v[116:119], v[100:103], v[188:191]
    s_waitcnt lgkmcnt(4)
    ds_read_b64_tr_b16 v[116:117], v4 offset:224
    v_max3_f32 v20, v20, v35, v40
    v_mfma_f32_16x16x32_bf16 v[192:195], v[104:107], v[88:91], v[192:195]
    ds_read_b64_tr_b16 v[118:119], v4 offset:736
    v_mfma_f32_16x16x32_bf16 v[196:199], v[104:107], v[92:95], v[196:199]
    v_fma_f32 v41, v41, s21, v14
    v_fma_f32 v42, v42, s21, v14
    v_mfma_f32_16x16x32_bf16 v[200:203], v[104:107], v[96:99], v[200:203]
    v_max3_f32 v20, v20, v41, v42
    v_mfma_f32_16x16x32_bf16 v[204:207], v[104:107], v[100:103], v[204:207]
    s_waitcnt lgkmcnt(4)
    ds_read_b64_tr_b16 v[104:105], v4 offset:256
    v_fma_f32 v43, v43, s21, v14
    v_mfma_f32_16x16x32_bf16 v[208:211], v[108:111], v[88:91], v[208:211]
    ds_read_b64_tr_b16 v[106:107], v4 offset:768
    v_fma_f32 v48, v48, s21, v15
    v_mfma_f32_16x16x32_bf16 v[212:215], v[108:111], v[92:95], v[212:215]
    buffer_load_dwordx4 v7, s[8:11], s24 offen offset:2080 nt lds
    v_mfma_f32_16x16x32_bf16 v[216:219], v[108:111], v[96:99], v[216:219]
    v_max3_f32 v20, v20, v43, v48
    v_mfma_f32_16x16x32_bf16 v[220:223], v[108:111], v[100:103], v[220:223]
    s_waitcnt lgkmcnt(4)
    ds_read_b64_tr_b16 v[108:109], v4 offset:288
    v_fma_f32 v49, v49, s21, v15
    v_mfma_f32_16x16x32_bf16 v[224:227], v[112:115], v[88:91], v[224:227]
    ds_read_b64_tr_b16 v[110:111], v4 offset:800
    v_mfma_f32_16x16x32_bf16 v[228:231], v[112:115], v[92:95], v[228:231]
    v_fma_f32 v50, v50, s21, v15
    v_add_f32 v19, v19, v85
    v_mfma_f32_16x16x32_bf16 v[232:235], v[112:115], v[96:99], v[232:235]
    buffer_load_dwordx4 v8, s[8:11], s24 offen offset:3120 nt lds
    v_mfma_f32_16x16x32_bf16 v[236:239], v[112:115], v[100:103], v[236:239]
    s_waitcnt lgkmcnt(4)
    ds_read_b64_tr_b16 v[112:113], v4 offset:320
    v_max3_f32 v20, v20, v49, v50
    v_mfma_f32_16x16x32_bf16 v[240:243], v[116:119], v[88:91], v[240:243]
    s_add_u32 s24, s24, 0x4000
    ds_read_b64_tr_b16 v[114:115], v4 offset:832
    v_mfma_f32_16x16x32_bf16 v[244:247], v[116:119], v[92:95], v[244:247]
    s_add_u32 m0, s29, s30
    v_fma_f32 v51, v51, s21, v15
    v_fma_f32 v28, v28, s21, v12
    v_mfma_f32_16x16x32_bf16 v[248:251], v[116:119], v[96:99], v[248:251]
    s_add_u32 s29, s29, s38
    buffer_load_dwordx4 v5, s[12:15], s25 offen offset:0 nt lds
    v_mfma_f32_16x16x32_bf16 v[252:255], v[116:119], v[100:103], v[252:255]
    s_waitcnt lgkmcnt(4)
    ds_read_b64_tr_b16 v[116:117], v4 offset:352
    v_mfma_f32_16x16x32_bf16 a[128:131], v[104:107], v[88:91], a[128:131]
    s_sub_u32 s31, s29, s39
    ds_read_b64_tr_b16 v[118:119], v4 offset:864
    v_max3_f32 v20, v20, v51, v28
    v_mfma_f32_16x16x32_bf16 a[132:135], v[104:107], v[92:95], a[132:135]
    s_min_u32 s29, s29, s31
    v_fma_f32 v29, v29, s21, v12
    v_mfma_f32_16x16x32_bf16 a[136:139], v[104:107], v[96:99], a[136:139]
    v_fma_f32 v30, v30, s21, v12
    v_max3_f32 v20, v20, v29, v30
    v_mfma_f32_16x16x32_bf16 a[140:143], v[104:107], v[100:103], a[140:143]
    s_waitcnt lgkmcnt(4)
    ds_read_b64_tr_b16 v[104:105], v4 offset:384
    v_fma_f32 v31, v31, s21, v12
    v_mfma_f32_16x16x32_bf16 a[144:147], v[108:111], v[88:91], a[144:147]
    ds_read_b64_tr_b16 v[106:107], v4 offset:896
    v_mfma_f32_16x16x32_bf16 a[148:151], v[108:111], v[92:95], a[148:151]
    buffer_load_dwordx4 v6, s[12:15], s25 offen offset:1040 nt lds
    v_mfma_f32_16x16x32_bf16 a[152:155], v[108:111], v[96:99], a[152:155]
    v_fma_f32 v36, v36, s21, v13
    v_add_f32 v19, v19, v86
    v_mfma_f32_16x16x32_bf16 a[156:159], v[108:111], v[100:103], a[156:159]
    s_waitcnt lgkmcnt(4)
    ds_read_b64_tr_b16 v[108:109], v4 offset:416
    v_mfma_f32_16x16x32_bf16 a[160:163], v[112:115], v[88:91], a[160:163]
    ds_read_b64_tr_b16 v[110:111], v4 offset:928
    v_max3_f32 v20, v20, v31, v36
    v_mfma_f32_16x16x32_bf16 a[164:167], v[112:115], v[92:95], a[164:167]
    v_fma_f32 v37, v37, s21, v13
    v_fma_f32 v38, v38, s21, v13
    v_mfma_f32_16x16x32_bf16 a[168:171], v[112:115], v[96:99], a[168:171]
    buffer_load_dwordx4 v7, s[12:15], s25 offen offset:2080 nt lds
    v_mfma_f32_16x16x32_bf16 a[172:175], v[112:115], v[100:103], a[172:175]
    s_waitcnt lgkmcnt(4)
    ds_read_b64_tr_b16 v[112:113], v4 offset:448
    v_mfma_f32_16x16x32_bf16 a[176:179], v[116:119], v[88:91], a[176:179]
    ds_read_b64_tr_b16 v[114:115], v4 offset:960
    v_max3_f32 v20, v20, v37, v38
    v_mfma_f32_16x16x32_bf16 a[180:183], v[116:119], v[92:95], a[180:183]
    v_fma_f32 v39, v39, s21, v13
    v_mfma_f32_16x16x32_bf16 a[184:187], v[116:119], v[96:99], a[184:187]
    v_fma_f32 v44, v44, s21, v14
    v_max3_f32 v20, v20, v39, v44
    v_mfma_f32_16x16x32_bf16 a[188:191], v[116:119], v[100:103], a[188:191]
    s_waitcnt lgkmcnt(4)
    ds_read_b64_tr_b16 v[116:117], v4 offset:480
    v_mfma_f32_16x16x32_bf16 a[192:195], v[104:107], v[88:91], a[192:195]
    ds_read_b64_tr_b16 v[118:119], v4 offset:992
    v_fma_f32 v45, v45, s21, v14
    v_mfma_f32_16x16x32_bf16 a[196:199], v[104:107], v[92:95], a[196:199]
    buffer_load_dwordx4 v8, s[12:15], s25 offen offset:3120 nt lds
    v_mfma_f32_16x16x32_bf16 a[200:203], v[104:107], v[96:99], a[200:203]
    s_add_u32 s25, s25, 0x4000
    v_fma_f32 v46, v46, s21, v14
    v_max3_f32 v20, v20, v45, v46
    v_mfma_f32_16x16x32_bf16 a[204:207], v[104:107], v[100:103], a[204:207]
    s_waitcnt lgkmcnt(4)
    ds_read_b128 v[104:107], v3 offset:0
    v_mfma_f32_16x16x32_bf16 a[208:211], v[108:111], v[88:91], a[208:211]
    v_add_f32 v19, v19, v87
    v_fma_f32 v47, v47, s21, v14
    v_mfma_f32_16x16x32_bf16 a[212:215], v[108:111], v[92:95], a[212:215]
    v_fma_f32 v52, v52, s21, v15
    v_mfma_f32_16x16x32_bf16 a[216:219], v[108:111], v[96:99], a[216:219]
    v_max3_f32 v20, v20, v47, v52
    v_fma_f32 v53, v53, s21, v15
    v_mfma_f32_16x16x32_bf16 a[220:223], v[108:111], v[100:103], a[220:223]
    s_waitcnt lgkmcnt(3)
    ds_read_b128 v[108:111], v3 offset:16
    v_mfma_f32_16x16x32_bf16 a[224:227], v[112:115], v[88:91], a[224:227]
    v_fma_f32 v54, v54, s21, v15
    v_max3_f32 v20, v20, v53, v54
    v_mfma_f32_16x16x32_bf16 a[228:231], v[112:115], v[92:95], a[228:231]
    v_fma_f32 v55, v55, s21, v15
    v_mfma_f32_16x16x32_bf16 a[232:235], v[112:115], v[96:99], a[232:235]
    v_max3_f32 v20, v20, v55, v55
    v_mfma_f32_16x16x32_bf16 a[236:239], v[112:115], v[100:103], a[236:239]
    s_waitcnt lgkmcnt(2)
    ds_read_b128 v[112:115], v3 offset:32
    v_mfma_f32_16x16x32_bf16 a[240:243], v[116:119], v[88:91], a[240:243]
    v_mfma_f32_16x16x32_bf16 a[244:247], v[116:119], v[92:95], a[244:247]
    v_cmp_lt_f32 vcc, s35, v20
    v_mfma_f32_16x16x32_bf16 a[248:251], v[116:119], v[96:99], a[248:251]
    v_mfma_f32_16x16x32_bf16 a[252:255], v[116:119], v[100:103], a[252:255]
    s_waitcnt lgkmcnt(1)
    ds_read_b128 v[116:119], v3 offset:48
    s_cbranch_vccnz L_rare_s3c
L_cont_s3c:
    v_mfma_f32_16x16x32_bf16 v[56:59], v[104:107], a[0:3], 0
    v_exp_f32 v24, v24
    v_mfma_f32_16x16x32_bf16 v[56:59], v[108:111], a[4:7], v[56:59]
    v_add_u32 v4, s28, v2
    v_add_f32 v16, v16, v24
    v_mfma_f32_16x16x32_bf16 v[64:67], v[104:107], a[32:35], 0
    s_add_u32 s28, s28, s38
    v_exp_f32 v25, v25
    v_mfma_f32_16x16x32_bf16 v[64:67], v[108:111], a[36:39], v[64:67]
    s_sub_u32 s48, s28, s39
    v_exp_f32 v26, v26
    v_mfma_f32_16x16x32_bf16 v[72:75], v[104:107], a[64:67], 0
    s_min_u32 s28, s28, s48
    v_exp_f32 v27, v27
    v_mfma_f32_16x16x32_bf16 v[72:75], v[108:111], a[68:71], v[72:75]
    v_exp_f32 v28, v28
    v_mfma_f32_16x16x32_bf16 v[80:83], v[104:107], a[96:99], 0
    ds_read_b128 v[104:107], v3 offset:256
    v_cvt_pk_bf16_f32 v88, v24, v25
    v_mfma_f32_16x16x32_bf16 v[80:83], v[108:111], a[100:103], v[80:83]
    s_waitcnt lgkmcnt(1)
    ds_read_b128 v[108:111], v3 offset:272
    v_cvt_pk_bf16_f32 v89, v26, v27
    v_mfma_f32_16x16x32_bf16 v[56:59], v[112:115], a[8:11], v[56:59]
    v_exp_f32 v29, v29
    v_mfma_f32_16x16x32_bf16 v[56:59], v[116:119], a[12:15], v[56:59]
    v_exp_f32 v30, v30
    v_mfma_f32_16x16x32_bf16 v[64:67], v[112:115], a[40:43], v[64:67]
    v_exp_f32 v31, v31
    v_mfma_f32_16x16x32_bf16 v[64:67], v[116:119], a[44:47], v[64:67]
    v_exp_f32 v32, v32
    v_mfma_f32_16x16x32_bf16 v[72:75], v[112:115], a[72:75], v[72:75]
    v_exp_f32 v33, v33
    v_mfma_f32_16x16x32_bf16 v[72:75], v[116:119], a[76:79], v[72:75]
    v_exp_f32 v34, v34
    v_mfma_f32_16x16x32_bf16 v[80:83], v[112:115], a[104:107], v[80:83]
    ds_read_b128 v[112:115], v3 offset:288
    v_cvt_pk_bf16_f32 v90, v28, v29
    v_mfma_f32_16x16x32_bf16 v[80:83], v[116:119], a[108:111], v[80:83]
    s_waitcnt lgkmcnt(1)
    ds_read_b128 v[116:119], v3 offset:304
    v_cvt_pk_bf16_f32 v91, v30, v31
    v_mfma_f32_16x16x32_bf16 v[56:59], v[104:107], a[16:19], v[56:59]
    v_exp_f32 v35, v35
    v_mfma_f32_16x16x32_bf16 v[56:59], v[108:111], a[20:23], v[56:59]
    v_exp_f32 v36, v36
    v_mfma_f32_16x16x32_bf16 v[64:67], v[104:107], a[48:51], v[64:67]
    v_exp_f32 v37, v37
    v_mfma_f32_16x16x32_bf16 v[64:67], v[108:111], a[52:55], v[64:67]
    v_exp_f32 v38, v38
    v_mfma_f32_16x16x32_bf16 v[72:75], v[104:107], a[80:83], v[72:75]
    v_exp_f32 v39, v39
    v_mfma_f32_16x16x32_bf16 v[72:75], v[108:111], a[84:87], v[72:75]
    v_exp_f32 v40, v40
    v_mfma_f32_16x16x32_bf16 v[80:83], v[104:107], a[112:115], v[80:83]
    ds_read_b128 v[104:107], v3 offset:512
    v_cvt_pk_bf16_f32 v92, v32, v33
    v_mfma_f32_16x16x32_bf16 v[80:83], v[108:111], a[116:119], v[80:83]
    s_waitcnt lgkmcnt(1)
    ds_read_b128 v[108:111], v3 offset:528
    v_cvt_pk_bf16_f32 v93, v34, v35
    v_mfma_f32_16x16x32_bf16 v[56:59], v[112:115], a[24:27], v[56:59]
    v_exp_f32 v41, v41
    v_mfma_f32_16x16x32_bf16 v[56:59], v[116:119], a[28:31], v[56:59]
    v_exp_f32 v42, v42
    v_mfma_f32_16x16x32_bf16 v[64:67], v[112:115], a[56:59], v[64:67]
    v_exp_f32 v43, v43
    v_mfma_f32_16x16x32_bf16 v[64:67], v[116:119], a[60:63], v[64:67]
    v_exp_f32 v44, v44
    v_mfma_f32_16x16x32_bf16 v[72:75], v[112:115], a[88:91], v[72:75]
    v_exp_f32 v45, v45
    v_mfma_f32_16x16x32_bf16 v[72:75], v[116:119], a[92:95], v[72:75]
    v_exp_f32 v46, v46
    v_mfma_f32_16x16x32_bf16 v[80:83], v[112:115], a[120:123], v[80:83]
    ds_read_b128 v[112:115], v3 offset:544
    v_cvt_pk_bf16_f32 v94, v36, v37
    v_mfma_f32_16x16x32_bf16 v[80:83], v[116:119], a[124:127], v[80:83]
    s_waitcnt lgkmcnt(1)
    ds_read_b128 v[116:119], v3 offset:560
    v_cvt_pk_bf16_f32 v95, v38, v39
    v_mfma_f32_16x16x32_bf16 v[60:63], v[104:107], a[0:3], 0
    v_exp_f32 v47, v47
    v_mfma_f32_16x16x32_bf16 v[60:63], v[108:111], a[4:7], v[60:63]
    v_exp_f32 v48, v48
    v_mfma_f32_16x16x32_bf16 v[68:71], v[104:107], a[32:35], 0
    v_exp_f32 v49, v49
    v_mfma_f32_16x16x32_bf16 v[68:71], v[108:111], a[36:39], v[68:71]
    v_exp_f32 v50, v50
    v_mfma_f32_16x16x32_bf16 v[76:79], v[104:107], a[64:67], 0
    v_exp_f32 v51, v51
    v_mfma_f32_16x16x32_bf16 v[76:79], v[108:111], a[68:71], v[76:79]
    v_exp_f32 v52, v52
    v_mfma_f32_16x16x32_bf16 v[84:87], v[104:107], a[96:99], 0
    ds_read_b128 v[104:107], v3 offset:768
    v_cvt_pk_bf16_f32 v96, v40, v41
    v_mfma_f32_16x16x32_bf16 v[84:87], v[108:111], a[100:103], v[84:87]
    s_waitcnt lgkmcnt(1)
    ds_read_b128 v[108:111], v3 offset:784
    v_cvt_pk_bf16_f32 v97, v42, v43
    v_mfma_f32_16x16x32_bf16 v[60:63], v[112:115], a[8:11], v[60:63]
    v_exp_f32 v53, v53
    v_mfma_f32_16x16x32_bf16 v[60:63], v[116:119], a[12:15], v[60:63]
    v_exp_f32 v54, v54
    v_mfma_f32_16x16x32_bf16 v[68:71], v[112:115], a[40:43], v[68:71]
    v_exp_f32 v55, v55
    v_mfma_f32_16x16x32_bf16 v[68:71], v[116:119], a[44:47], v[68:71]
    v_cvt_pk_bf16_f32 v98, v44, v45
    v_cvt_pk_bf16_f32 v99, v46, v47
    v_mfma_f32_16x16x32_bf16 v[76:79], v[112:115], a[72:75], v[76:79]
    v_cvt_pk_bf16_f32 v100, v48, v49
    v_cvt_pk_bf16_f32 v101, v50, v51
    v_mfma_f32_16x16x32_bf16 v[76:79], v[116:119], a[76:79], v[76:79]
    v_cvt_pk_bf16_f32 v102, v52, v53
    v_cvt_pk_bf16_f32 v103, v54, v55
    v_mfma_f32_16x16x32_bf16 v[84:87], v[112:115], a[104:107], v[84:87]
    ds_read_b128 v[112:115], v3 offset:800
    v_add_f32 v16, v16, v25
    v_mfma_f32_16x16x32_bf16 v[84:87], v[116:119], a[108:111], v[84:87]
    s_waitcnt lgkmcnt(1)
    ds_read_b128 v[116:119], v3 offset:816
    v_add_f32 v16, v16, v26
    v_mfma_f32_16x16x32_bf16 v[60:63], v[104:107], a[16:19], v[60:63]
    v_add_f32 v16, v16, v27
    v_add_f32 v16, v16, v28
    v_mfma_f32_16x16x32_bf16 v[60:63], v[108:111], a[20:23], v[60:63]
    v_add_u32 v3, s28, v1
    v_add_f32 v16, v16, v29
    v_mfma_f32_16x16x32_bf16 v[68:71], v[104:107], a[48:51], v[68:71]
    s_add_u32 s28, s28, s38
    v_add_f32 v16, v16, v30
    v_add_f32 v16, v16, v31
    v_mfma_f32_16x16x32_bf16 v[68:71], v[108:111], a[52:55], v[68:71]
    s_sub_u32 s48, s28, s39
    v_add_f32 v17, v17, v32
    v_add_f32 v17, v17, v33
    v_mfma_f32_16x16x32_bf16 v[76:79], v[104:107], a[80:83], v[76:79]
    s_min_u32 s28, s28, s48
    v_add_f32 v17, v17, v34
    v_add_f32 v17, v17, v35
    v_mfma_f32_16x16x32_bf16 v[76:79], v[108:111], a[84:87], v[76:79]
    v_add_f32 v17, v17, v36
    v_add_f32 v17, v17, v37
    v_mfma_f32_16x16x32_bf16 v[84:87], v[104:107], a[112:115], v[84:87]
    ds_read_b64_tr_b16 v[104:105], v4 offset:0
    v_add_f32 v17, v17, v38
    v_mfma_f32_16x16x32_bf16 v[84:87], v[108:111], a[116:119], v[84:87]
    s_waitcnt lgkmcnt(1)
    ds_read_b64_tr_b16 v[106:107], v4 offset:512
    ds_read_b64_tr_b16 v[108:109], v4 offset:32
    v_mfma_f32_16x16x32_bf16 v[60:63], v[112:115], a[24:27], v[60:63]
    ds_read_b64_tr_b16 v[110:111], v4 offset:544
    v_add_f32 v17, v17, v39
    v_mfma_f32_16x16x32_bf16 v[60:63], v[116:119], a[28:31], v[60:63]
    v_add_f32 v18, v18, v40
    v_add_f32 v18, v18, v41
    v_mfma_f32_16x16x32_bf16 v[68:71], v[112:115], a[56:59], v[68:71]
    v_add_f32 v18, v18, v42
    v_add_f32 v18, v18, v43
    v_mfma_f32_16x16x32_bf16 v[68:71], v[116:119], a[60:63], v[68:71]
    v_add_f32 v18, v18, v44
    v_add_f32 v18, v18, v45
    v_mfma_f32_16x16x32_bf16 v[76:79], v[112:115], a[88:91], v[76:79]
    v_add_f32 v18, v18, v46
    v_add_f32 v18, v18, v47
    v_mfma_f32_16x16x32_bf16 v[76:79], v[116:119], a[92:95], v[76:79]
    v_add_f32 v19, v19, v48
    v_add_f32 v19, v19, v49
    v_mfma_f32_16x16x32_bf16 v[84:87], v[112:115], a[120:123], v[84:87]
    ds_read_b64_tr_b16 v[112:113], v4 offset:64
    v_add_f32 v19, v19, v50
    v_mfma_f32_16x16x32_bf16 v[84:87], v[116:119], a[124:127], v[84:87]
    s_waitcnt lgkmcnt(3)
    ds_read_b64_tr_b16 v[114:115], v4 offset:576
    ds_read_b64_tr_b16 v[116:117], v4 offset:96
    v_mfma_f32_16x16x32_bf16 v[128:131], v[104:107], v[88:91], v[128:131]
    ds_read_b64_tr_b16 v[118:119], v4 offset:608
    v_fma_f32 v56, v56, s21, v12
    v_mfma_f32_16x16x32_bf16 v[132:135], v[104:107], v[92:95], v[132:135]
    v_add_f32 v19, v19, v51
    v_fma_f32 v57, v57, s21, v12
    v_mfma_f32_16x16x32_bf16 v[136:139], v[104:107], v[96:99], v[136:139]
    v_fma_f32 v58, v58, s21, v12
    v_mfma_f32_16x16x32_bf16 v[140:143], v[104:107], v[100:103], v[140:143]
    s_waitcnt lgkmcnt(4)
    ds_read_b64_tr_b16 v[104:105], v4 offset:128
    v_max3_f32 v20, v56, v57, v58
    v_mfma_f32_16x16x32_bf16 v[144:147], v[108:111], v[88:91], v[144:147]
    s_waitcnt vmcnt(16)
    ds_read_b64_tr_b16 v[106:107], v4 offset:640
    v_mfma_f32_16x16x32_bf16 v[148:151], v[108:111], v[92:95], v[148:151]
    v_fma_f32 v59, v59, s21, v12
    v_fma_f32 v64, v64, s21, v13
    v_mfma_f32_16x16x32_bf16 v[152:155], v[108:111], v[96:99], v[152:155]
    s_barrier
    v_max3_f32 v20, v20, v59, v64
    v_mfma_f32_16x16x32_bf16 v[156:159], v[108:111], v[100:103], v[156:159]
    s_waitcnt lgkmcnt(4)
    ds_read_b64_tr_b16 v[108:109], v4 offset:160
    v_fma_f32 v65, v65, s21, v13
    v_mfma_f32_16x16x32_bf16 v[160:163], v[112:115], v[88:91], v[160:163]
    s_add_u32 m0, s29, s30
    ds_read_b64_tr_b16 v[110:111], v4 offset:672
    v_fma_f32 v66, v66, s21, v13
    v_mfma_f32_16x16x32_bf16 v[164:167], v[112:115], v[92:95], v[164:167]
    s_add_u32 s29, s29, s38
    buffer_load_dwordx4 v5, s[8:11], s24 offen offset:0 nt lds
    v_mfma_f32_16x16x32_bf16 v[168:171], v[112:115], v[96:99], v[168:171]
    s_sub_u32 s31, s29, s39
    v_max3_f32 v20, v20, v65, v66
    v_mfma_f32_16x16x32_bf16 v[172:175], v[112:115], v[100:103], v[172:175]
    s_waitcnt lgkmcnt(4)
    ds_read_b64_tr_b16 v[112:113], v4 offset:192
    v_fma_f32 v67, v67, s21, v13
    v_mfma_f32_16x16x32_bf16 v[176:179], v[116:119], v[88:91], v[176:179]
    s_min_u32 s29, s29, s31
    ds_read_b64_tr_b16 v[114:115], v4 offset:704
    v_add_f32 v19, v19, v52
    v_mfma_f32_16x16x32_bf16 v[180:183], v[116:119], v[92:95], v[180:183]
    v_fma_f32 v72, v72, s21, v14
    v_mfma_f32_16x16x32_bf16 v[184:187], v[116:119], v[96:99], v[184:187]
    buffer_load_dwordx4 v6, s[8:11], s24 offen offset:1040 nt lds
    v_mfma_f32_16x16x32_bf16 v[188:191], v[116:119], v[100:103], v[188:191]
    s_waitcnt lgkmcnt(4)
    ds_read_b64_tr_b16 v[116:117], v4 offset:224
    v_max3_f32 v20, v20, v67, v72
    v_mfma_f32_16x16x32_bf16 v[192:195], v[104:107], v[88:91], v[192:195]
    ds_read_b64_tr_b16 v[118:119], v4 offset:736
    v_mfma_f32_16x16x32_bf16 v[196:199], v[104:107], v[92:95], v[196:199]
    v_fma_f32 v73, v73, s21, v14
    v_fma_f32 v74, v74, s21, v14
    v_mfma_f32_16x16x32_bf16 v[200:203], v[104:107], v[96:99], v[200:203]
    v_max3_f32 v20, v20, v73, v74
    v_mfma_f32_16x16x32_bf16 v[204:207], v[104:107], v[100:103], v[204:207]
    s_waitcnt lgkmcnt(4)
    ds_read_b64_tr_b16 v[104:105], v4 offset:256
    v_fma_f32 v75, v75, s21, v14
    v_mfma_f32_16x16x32_bf16 v[208:211], v[108:111], v[88:91], v[208:211]
    ds_read_b64_tr_b16 v[106:107], v4 offset:768
    v_fma_f32 v80, v80, s21, v15
    v_mfma_f32_16x16x32_bf16 v[212:215], v[108:111], v[92:95], v[212:215]
    buffer_load_dwordx4 v7, s[8:11], s24 offen offset:2080 nt lds
    v_mfma_f32_16x16x32_bf16 v[216:219], v[108:111], v[96:99], v[216:219]
    v_max3_f32 v20, v20, v75, v80
    v_mfma_f32_16x16x32_bf16 v[220:223], v[108:111], v[100:103], v[220:223]
    s_waitcnt lgkmcnt(4)
    ds_read_b64_tr_b16 v[108:109], v4 offset:288
    v_fma_f32 v81, v81, s21, v15
    v_mfma_f32_16x16x32_bf16 v[224:227], v[112:115], v[88:91], v[224:227]
    ds_read_b64_tr_b16 v[110:111], v4 offset:800
    v_mfma_f32_16x16x32_bf16 v[228:231], v[112:115], v[92:95], v[228:231]
    v_fma_f32 v82, v82, s21, v15
    v_add_f32 v19, v19, v53
    v_mfma_f32_16x16x32_bf16 v[232:235], v[112:115], v[96:99], v[232:235]
    buffer_load_dwordx4 v8, s[8:11], s24 offen offset:3120 nt lds
    v_mfma_f32_16x16x32_bf16 v[236:239], v[112:115], v[100:103], v[236:239]
    s_waitcnt lgkmcnt(4)
    ds_read_b64_tr_b16 v[112:113], v4 offset:320
    v_max3_f32 v20, v20, v81, v82
    v_mfma_f32_16x16x32_bf16 v[240:243], v[116:119], v[88:91], v[240:243]
    s_add_u32 s24, s24, 0x4000
    ds_read_b64_tr_b16 v[114:115], v4 offset:832
    v_mfma_f32_16x16x32_bf16 v[244:247], v[116:119], v[92:95], v[244:247]
    s_add_u32 m0, s29, s30
    v_fma_f32 v83, v83, s21, v15
    v_fma_f32 v60, v60, s21, v12
    v_mfma_f32_16x16x32_bf16 v[248:251], v[116:119], v[96:99], v[248:251]
    s_add_u32 s29, s29, s38
    buffer_load_dwordx4 v5, s[12:15], s25 offen offset:0 nt lds
    v_mfma_f32_16x16x32_bf16 v[252:255], v[116:119], v[100:103], v[252:255]
    s_waitcnt lgkmcnt(4)
    ds_read_b64_tr_b16 v[116:117], v4 offset:352
    v_mfma_f32_16x16x32_bf16 a[128:131], v[104:107], v[88:91], a[128:131]
    s_sub_u32 s31, s29, s39
    ds_read_b64_tr_b16 v[118:119], v4 offset:864
    v_max3_f32 v20, v20, v83, v60
    v_mfma_f32_16x16x32_bf16 a[132:135], v[104:107], v[92:95], a[132:135]
    s_min_u32 s29, s29, s31
    v_fma_f32 v61, v61, s21, v12
    v_mfma_f32_16x16x32_bf16 a[136:139], v[104:107], v[96:99], a[136:139]
    v_fma_f32 v62, v62, s21, v12
    v_max3_f32 v20, v20, v61, v62
    v_mfma_f32_16x16x32_bf16 a[140:143], v[104:107], v[100:103], a[140:143]
    s_waitcnt lgkmcnt(4)
    ds_read_b64_tr_b16 v[104:105], v4 offset:384
    v_fma_f32 v63, v63, s21, v12
    v_mfma_f32_16x16x32_bf16 a[144:147], v[108:111], v[88:91], a[144:147]
    ds_read_b64_tr_b16 v[106:107], v4 offset:896
    v_mfma_f32_16x16x32_bf16 a[148:151], v[108:111], v[92:95], a[148:151]
    buffer_load_dwordx4 v6, s[12:15], s25 offen offset:1040 nt lds
    v_mfma_f32_16x16x32_bf16 a[152:155], v[108:111], v[96:99], a[152:155]
    v_fma_f32 v68, v68, s21, v13
    v_add_f32 v19, v19, v54
    v_mfma_f32_16x16x32_bf16 a[156:159], v[108:111], v[100:103], a[156:159]
    s_waitcnt lgkmcnt(4)
    ds_read_b64_tr_b16 v[108:109], v4 offset:416
    v_mfma_f32_16x16x32_bf16 a[160:163], v[112:115], v[88:91], a[160:163]
    ds_read_b64_tr_b16 v[110:111], v4 offset:928
    v_max3_f32 v20, v20, v63, v68
    v_mfma_f32_16x16x32_bf16 a[164:167], v[112:115], v[92:95], a[164:167]
    v_fma_f32 v69, v69, s21, v13
    v_fma_f32 v70, v70, s21, v13
    v_mfma_f32_16x16x32_bf16 a[168:171], v[112:115], v[96:99], a[168:171]
    buffer_load_dwordx4 v7, s[12:15], s25 offen offset:2080 nt lds
    v_mfma_f32_16x16x32_bf16 a[172:175], v[112:115], v[100:103], a[172:175]
    s_waitcnt lgkmcnt(4)
    ds_read_b64_tr_b16 v[112:113], v4 offset:448
    v_mfma_f32_16x16x32_bf16 a[176:179], v[116:119], v[88:91], a[176:179]
    ds_read_b64_tr_b16 v[114:115], v4 offset:960
    v_max3_f32 v20, v20, v69, v70
    v_mfma_f32_16x16x32_bf16 a[180:183], v[116:119], v[92:95], a[180:183]
    v_fma_f32 v71, v71, s21, v13
    v_mfma_f32_16x16x32_bf16 a[184:187], v[116:119], v[96:99], a[184:187]
    v_fma_f32 v76, v76, s21, v14
    v_max3_f32 v20, v20, v71, v76
    v_mfma_f32_16x16x32_bf16 a[188:191], v[116:119], v[100:103], a[188:191]
    s_waitcnt lgkmcnt(4)
    ds_read_b64_tr_b16 v[116:117], v4 offset:480
    v_mfma_f32_16x16x32_bf16 a[192:195], v[104:107], v[88:91], a[192:195]
    ds_read_b64_tr_b16 v[118:119], v4 offset:992
    v_fma_f32 v77, v77, s21, v14
    v_mfma_f32_16x16x32_bf16 a[196:199], v[104:107], v[92:95], a[196:199]
    buffer_load_dwordx4 v8, s[12:15], s25 offen offset:3120 nt lds
    v_mfma_f32_16x16x32_bf16 a[200:203], v[104:107], v[96:99], a[200:203]
    s_add_u32 s25, s25, 0x4000
    v_fma_f32 v78, v78, s21, v14
    v_max3_f32 v20, v20, v77, v78
    v_mfma_f32_16x16x32_bf16 a[204:207], v[104:107], v[100:103], a[204:207]
    s_waitcnt lgkmcnt(4)
    ds_read_b128 v[104:107], v3 offset:0
    v_mfma_f32_16x16x32_bf16 a[208:211], v[108:111], v[88:91], a[208:211]
    v_add_f32 v19, v19, v55
    v_fma_f32 v79, v79, s21, v14
    v_mfma_f32_16x16x32_bf16 a[212:215], v[108:111], v[92:95], a[212:215]
    v_fma_f32 v84, v84, s21, v15
    v_mfma_f32_16x16x32_bf16 a[216:219], v[108:111], v[96:99], a[216:219]
    v_max3_f32 v20, v20, v79, v84
    v_fma_f32 v85, v85, s21, v15
    v_mfma_f32_16x16x32_bf16 a[220:223], v[108:111], v[100:103], a[220:223]
    s_waitcnt lgkmcnt(3)
    ds_read_b128 v[108:111], v3 offset:16
    v_mfma_f32_16x16x32_bf16 a[224:227], v[112:115], v[88:91], a[224:227]
    v_fma_f32 v86, v86, s21, v15
    v_max3_f32 v20, v20, v85, v86
    v_mfma_f32_16x16x32_bf16 a[228:231], v[112:115], v[92:95], a[228:231]
    v_fma_f32 v87, v87, s21, v15
    v_mfma_f32_16x16x32_bf16 a[232:235], v[112:115], v[96:99], a[232:235]
    v_max3_f32 v20, v20, v87, v87
    v_mfma_f32_16x16x32_bf16 a[236:239], v[112:115], v[100:103], a[236:239]
    s_waitcnt lgkmcnt(2)
    ds_read_b128 v[112:115], v3 offset:32
    v_mfma_f32_16x16x32_bf16 a[240:243], v[116:119], v[88:91], a[240:243]
    v_mfma_f32_16x16x32_bf16 a[244:247], v[116:119], v[92:95], a[244:247]
    v_cmp_lt_f32 vcc, s35, v20
    v_mfma_f32_16x16x32_bf16 a[248:251], v[116:119], v[96:99], a[248:251]
    v_mfma_f32_16x16x32_bf16 a[252:255], v[116:119], v[100:103], a[252:255]
    s_waitcnt lgkmcnt(1)
    ds_read_b128 v[116:119], v3 offset:48
    s_cbranch_vccnz L_rare_s4c
L_cont_s4c:
    s_sub_u32 s32, s32, 1
    s_cmp_lg_u32 s32, 0
    s_cbranch_scc1 L_loop2
    s_cmp_eq_u32 s22, 0
    s_cbranch_scc1 L_s11
    v_mfma_f32_16x16x32_bf16 v[24:27], v[104:107], a[0:3], 0
    v_exp_f32 v56, v56
    v_mfma_f32_16x16x32_bf16 v[24:27], v[108:111], a[4:7], v[24:27]
    v_add_u32 v4, s28, v2
    v_add_f32 v16, v16, v56
    v_mfma_f32_16x16x32_bf16 v[32:35], v[104:107], a[32:35], 0
    s_add_u32 s28, s28, s38
    v_exp_f32 v57, v57
    v_mfma_f32_16x16x32_bf16 v[32:35], v[108:111], a[36:39], v[32:35]
    s_sub_u32 s48, s28, s39
    v_exp_f32 v58, v58
    v_mfma_f32_16x16x32_bf16 v[40:43], v[104:107], a[64:67], 0
    s_min_u32 s28, s28, s48
    v_exp_f32 v59, v59
    v_mfma_f32_16x16x32_bf16 v[40:43], v[108:111], a[68:71], v[40:43]
    v_exp_f32 v60, v60
    v_mfma_f32_16x16x32_bf16 v[48:51], v[104:107], a[96:99], 0
    ds_read_b128 v[104:107], v3 offset:256
    v_cvt_pk_bf16_f32 v88, v56, v57
    v_mfma_f32_16x16x32_bf16 v[48:51], v[108:111], a[100:103], v[48:51]
    s_waitcnt lgkmcnt(1)
    ds_read_b128 v[108:111], v3 offset:272
    v_cvt_pk_bf16_f32 v89, v58, v59
    v_mfma_f32_16x16x32_bf16 v[24:27], v[112:115], a[8:11], v[24:27]
    v_exp_f32 v61, v61
    v_mfma_f32_16x16x32_bf16 v[24:27], v[116:119], a[12:15], v[24:27]
    v_exp_f32 v62, v62
    v_mfma_f32_16x16x32_bf16 v[32:35], v[112:115], a[40:43], v[32:35]
    v_exp_f32 v63, v63
    v_mfma_f32_16x16x32_bf16 v[32:35], v[116:119], a[44:47], v[32:35]
    v_exp_f32 v64, v64
    v_mfma_f32_16x16x32_bf16 v[40:43], v[112:115], a[72:75], v[40:43]
    v_exp_f32 v65, v65
    v_mfma_f32_16x16x32_bf16 v[40:43], v[116:119], a[76:79], v[40:43]
    v_exp_f32 v66, v66
    v_mfma_f32_16x16x32_bf16 v[48:51], v[112:115], a[104:107], v[48:51]
    ds_read_b128 v[112:115], v3 offset:288
    v_cvt_pk_bf16_f32 v90, v60, v61
    v_mfma_f32_16x16x32_bf16 v[48:51], v[116:119], a[108:111], v[48:51]
    s_waitcnt lgkmcnt(1)
    ds_read_b128 v[116:119], v3 offset:304
    v_cvt_pk_bf16_f32 v91, v62, v63
    v_mfma_f32_16x16x32_bf16 v[24:27], v[104:107], a[16:19], v[24:27]
    v_exp_f32 v67, v67
    v_mfma_f32_16x16x32_bf16 v[24:27], v[108:111], a[20:23], v[24:27]
    v_exp_f32 v68, v68
    v_mfma_f32_16x16x32_bf16 v[32:35], v[104:107], a[48:51], v[32:35]
    v_exp_f32 v69, v69
    v_mfma_f32_16x16x32_bf16 v[32:35], v[108:111], a[52:55], v[32:35]
    v_exp_f32 v70, v70
    v_mfma_f32_16x16x32_bf16 v[40:43], v[104:107], a[80:83], v[40:43]
    v_exp_f32 v71, v71
    v_mfma_f32_16x16x32_bf16 v[40:43], v[108:111], a[84:87], v[40:43]
    v_exp_f32 v72, v72
    v_mfma_f32_16x16x32_bf16 v[48:51], v[104:107], a[112:115], v[48:51]
    ds_read_b128 v[104:107], v3 offset:512
    v_cvt_pk_bf16_f32 v92, v64, v65
    v_mfma_f32_16x16x32_bf16 v[48:51], v[108:111], a[116:119], v[48:51]
    s_waitcnt lgkmcnt(1)
    ds_read_b128 v[108:111], v3 offset:528
    v_cvt_pk_bf16_f32 v93, v66, v67
    v_mfma_f32_16x16x32_bf16 v[24:27], v[112:115], a[24:27], v[24:27]
    v_exp_f32 v73, v73
    v_mfma_f32_16x16x32_bf16 v[24:27], v[116:119], a[28:31], v[24:27]
    v_exp_f32 v74, v74
    v_mfma_f32_16x16x32_bf16 v[32:35], v[112:115], a[56:59], v[32:35]
    v_exp_f32 v75, v75
    v_mfma_f32_16x16x32_bf16 v[32:35], v[116:119], a[60:63], v[32:35]
    v_exp_f32 v76, v76
    v_mfma_f32_16x16x32_bf16 v[40:43], v[112:115], a[88:91], v[40:43]
    v_exp_f32 v77, v77
    v_mfma_f32_16x16x32_bf16 v[40:43], v[116:119], a[92:95], v[40:43]
    v_exp_f32 v78, v78
    v_mfma_f32_16x16x32_bf16 v[48:51], v[112:115], a[120:123], v[48:51]
    ds_read_b128 v[112:115], v3 offset:544
    v_cvt_pk_bf16_f32 v94, v68, v69
    v_mfma_f32_16x16x32_bf16 v[48:51], v[116:119], a[124:127], v[48:51]
    s_waitcnt lgkmcnt(1)
    ds_read_b128 v[116:119], v3 offset:560
    v_cvt_pk_bf16_f32 v95, v70, v71
    v_mfma_f32_16x16x32_bf16 v[28:31], v[104:107], a[0:3], 0
    v_exp_f32 v79, v79
    v_mfma_f32_16x16x32_bf16 v[28:31], v[108:111], a[4:7], v[28:31]
    v_exp_f32 v80, v80
    v_mfma_f32_16x16x32_bf16 v[36:39], v[104:107], a[32:35], 0
    v_exp_f32 v81, v81
    v_mfma_f32_16x16x32_bf16 v[36:39], v[108:111], a[36:39], v[36:39]
    v_exp_f32 v82, v82
    v_mfma_f32_16x16x32_bf16 v[44:47], v[104:107], a[64:67], 0
    v_exp_f32 v83, v83
    v_mfma_f32_16x16x32_bf16 v[44:47], v[108:111], a[68:71], v[44:47]
    v_exp_f32 v84, v84
    v_mfma_f32_16x16x32_bf16 v[52:55], v[104:107], a[96:99], 0
    ds_read_b128 v[104:107], v3 offset:768
    v_cvt_pk_bf16_f32 v96, v72, v73
    v_mfma_f32_16x16x32_bf16 v[52:55], v[108:111], a[100:103], v[52:55]
    s_waitcnt lgkmcnt(1)
    ds_read_b128 v[108:111], v3 offset:784
    v_cvt_pk_bf16_f32 v97, v74, v75
    v_mfma_f32_16x16x32_bf16 v[28:31], v[112:115], a[8:11], v[28:31]
    v_exp_f32 v85, v85
    v_mfma_f32_16x16x32_bf16 v[28:31], v[116:119], a[12:15], v[28:31]
    v_exp_f32 v86, v86
    v_mfma_f32_16x16x32_bf16 v[36:39], v[112:115], a[40:43], v[36:39]
    v_exp_f32 v87, v87
    v_mfma_f32_16x16x32_bf16 v[36:39], v[116:119], a[44:47], v[36:39]
    v_cvt_pk_bf16_f32 v98, v76, v77
    v_cvt_pk_bf16_f32 v99, v78, v79
    v_mfma_f32_16x16x32_bf16 v[44:47], v[112:115], a[72:75], v[44:47]
    v_cvt_pk_bf16_f32 v100, v80, v81
    v_cvt_pk_bf16_f32 v101, v82, v83
    v_mfma_f32_16x16x32_bf16 v[44:47], v[116:119], a[76:79], v[44:47]
    v_cvt_pk_bf16_f32 v102, v84, v85
    v_cvt_pk_bf16_f32 v103, v86, v87
    v_mfma_f32_16x16x32_bf16 v[52:55], v[112:115], a[104:107], v[52:55]
    ds_read_b128 v[112:115], v3 offset:800
    v_add_f32 v16, v16, v57
    v_mfma_f32_16x16x32_bf16 v[52:55], v[116:119], a[108:111], v[52:55]
    s_waitcnt lgkmcnt(1)
    ds_read_b128 v[116:119], v3 offset:816
    v_add_f32 v16, v16, v58
    v_mfma_f32_16x16x32_bf16 v[28:31], v[104:107], a[16:19], v[28:31]
    v_add_f32 v16, v16, v59
    v_add_f32 v16, v16, v60
    v_mfma_f32_16x16x32_bf16 v[28:31], v[108:111], a[20:23], v[28:31]
    v_add_u32 v3, s28, v1
    v_add_f32 v16, v16, v61
    v_mfma_f32_16x16x32_bf16 v[36:39], v[104:107], a[48:51], v[36:39]
    s_add_u32 s28, s28, s38
    v_add_f32 v16, v16, v62
    v_add_f32 v16, v16, v63
    v_mfma_f32_16x16x32_bf16 v[36:39], v[108:111], a[52:55], v[36:39]
    s_sub_u32 s48, s28, s39
    v_add_f32 v17, v17, v64
    v_add_f32 v17, v17, v65
    v_mfma_f32_16x16x32_bf16 v[44:47], v[104:107], a[80:83], v[44:47]
    s_min_u32 s28, s28, s48
    v_add_f32 v17, v17, v66
    v_add_f32 v17, v17, v67
    v_mfma_f32_16x16x32_bf16 v[44:47], v[108:111], a[84:87], v[44:47]
    v_add_f32 v17, v17, v68
    v_add_f32 v17, v17, v69
    v_mfma_f32_16x16x32_bf16 v[52:55], v[104:107], a[112:115], v[52:55]
    ds_read_b64_tr_b16 v[104:105], v4 offset:0
    v_add_f32 v17, v17, v70
    v_mfma_f32_16x16x32_bf16 v[52:55], v[108:111], a[116:119], v[52:55]
    s_waitcnt lgkmcnt(1)
    ds_read_b64_tr_b16 v[106:107], v4 offset:512
    ds_read_b64_tr_b16 v[108:109], v4 offset:32
    v_mfma_f32_16x16x32_bf16 v[28:31], v[112:115], a[24:27], v[28:31]
    ds_read_b64_tr_b16 v[110:111], v4 offset:544
    v_add_f32 v17, v17, v71
    v_mfma_f32_16x16x32_bf16 v[28:31], v[116:119], a[28:31], v[28:31]
    v_add_f32 v18, v18, v72
    v_add_f32 v18, v18, v73
    v_mfma_f32_16x16x32_bf16 v[36:39], v[112:115], a[56:59], v[36:39]
    v_add_f32 v18, v18, v74
    v_add_f32 v18, v18, v75
    v_mfma_f32_16x16x32_bf16 v[36:39], v[116:119], a[60:63], v[36:39]
    v_add_f32 v18, v18, v76
    v_add_f32 v18, v18, v77
    v_mfma_f32_16x16x32_bf16 v[44:47], v[112:115], a[88:91], v[44:47]
    v_add_f32 v18, v18, v78
    v_add_f32 v18, v18, v79
    v_mfma_f32_16x16x32_bf16 v[44:47], v[116:119], a[92:95], v[44:47]
    v_add_f32 v19, v19, v80
    v_add_f32 v19, v19, v81
    v_mfma_f32_16x16x32_bf16 v[52:55], v[112:115], a[120:123], v[52:55]
    ds_read_b64_tr_b16 v[112:113], v4 offset:64
    v_add_f32 v19, v19, v82
    v_mfma_f32_16x16x32_bf16 v[52:55], v[116:119], a[124:127], v[52:55]
    s_waitcnt lgkmcnt(3)
    ds_read_b64_tr_b16 v[114:115], v4 offset:576
    ds_read_b64_tr_b16 v[116:117], v4 offset:96
    v_mfma_f32_16x16x32_bf16 v[128:131], v[104:107], v[88:91], v[128:131]
    ds_read_b64_tr_b16 v[118:119], v4 offset:608
    v_fma_f32 v24, v24, s21, v12
    v_mfma_f32_16x16x32_bf16 v[132:135], v[104:107], v[92:95], v[132:135]
    v_add_f32 v19, v19, v83
    v_mfma_f32_16x16x32_bf16 v[136:139], v[104:107], v[96:99], v[136:139]
    v_fma_f32 v25, v25, s21, v12
    v_fma_f32 v26, v26, s21, v12
    v_mfma_f32_16x16x32_bf16 v[140:143], v[104:107], v[100:103], v[140:143]
    s_waitcnt lgkmcnt(4)
    ds_read_b64_tr_b16 v[104:105], v4 offset:128
    v_mfma_f32_16x16x32_bf16 v[144:147], v[108:111], v[88:91], v[144:147]
    s_waitcnt vmcnt(16)
    ds_read_b64_tr_b16 v[106:107], v4 offset:640
    v_max3_f32 v20, v24, v25, v26
    v_mfma_f32_16x16x32_bf16 v[148:151], v[108:111], v[92:95], v[148:151]
    v_fma_f32 v27, v27, s21, v12
    v_mfma_f32_16x16x32_bf16 v[152:155], v[108:111], v[96:99], v[152:155]
    s_barrier
    v_fma_f32 v32, v32, s21, v13
    v_max3_f32 v20, v20, v27, v32
    v_mfma_f32_16x16x32_bf16 v[156:159], v[108:111], v[100:103], v[156:159]
    s_waitcnt lgkmcnt(4)
    ds_read_b64_tr_b16 v[108:109], v4 offset:160
    v_mfma_f32_16x16x32_bf16 v[160:163], v[112:115], v[88:91], v[160:163]
    s_add_u32 m0, s29, s30
    ds_read_b64_tr_b16 v[110:111], v4 offset:672
    v_fma_f32 v33, v33, s21, v13
    v_mfma_f32_16x16x32_bf16 v[164:167], v[112:115], v[92:95], v[164:167]
    s_add_u32 s29, s29, s38
    buffer_load_dwordx4 v5, s[12:15], s25 offen offset:0 nt lds
    v_mfma_f32_16x16x32_bf16 v[168:171], v[112:115], v[96:99], v[168:171]
    s_sub_u32 s31, s29, s39
    v_fma_f32 v34, v34, s21, v13
    v_mfma_f32_16x16x32_bf16 v[172:175], v[112:115], v[100:103], v[172:175]
    s_waitcnt lgkmcnt(4)
    ds_read_b64_tr_b16 v[112:113], v4 offset:192
    v_max3_f32 v20, v20, v33, v34
    v_mfma_f32_16x16x32_bf16 v[176:179], v[116:119], v[88:91], v[176:179]
    s_min_u32 s29, s29, s31
    ds_read_b64_tr_b16 v[114:115], v4 offset:704
    v_mfma_f32_16x16x32_bf16 v[180:183], v[116:119], v[92:95], v[180:183]
    v_fma_f32 v35, v35, s21, v13
    v_add_f32 v19, v19, v84
    v_mfma_f32_16x16x32_bf16 v[184:187], v[116:119], v[96:99], v[184:187]
    buffer_load_dwordx4 v6, s[12:15], s25 offen offset:1040 nt lds
    v_mfma_f32_16x16x32_bf16 v[188:191], v[116:119], v[100:103], v[188:191]
    s_waitcnt lgkmcnt(4)
    ds_read_b64_tr_b16 v[116:117], v4 offset:224
    v_mfma_f32_16x16x32_bf16 v[192:195], v[104:107], v[88:91], v[192:195]
    ds_read_b64_tr_b16 v[118:119], v4 offset:736
    v_fma_f32 v40, v40, s21, v14
    v_mfma_f32_16x16x32_bf16 v[196:199], v[104:107], v[92:95], v[196:199]
    v_max3_f32 v20, v20, v35, v40
    v_mfma_f32_16x16x32_bf16 v[200:203], v[104:107], v[96:99], v[200:203]
    v_fma_f32 v41, v41, s21, v14
    v_mfma_f32_16x16x32_bf16 v[204:207], v[104:107], v[100:103], v[204:207]
    s_waitcnt lgkmcnt(4)
    ds_read_b64_tr_b16 v[104:105], v4 offset:256
    v_fma_f32 v42, v42, s21, v14
    v_mfma_f32_16x16x32_bf16 v[208:211], v[108:111], v[88:91], v[208:211]
    ds_read_b64_tr_b16 v[106:107], v4 offset:768
    v_max3_f32 v20, v20, v41, v42
    v_mfma_f32_16x16x32_bf16 v[212:215], v[108:111], v[92:95], v[212:215]
    buffer_load_dwordx4 v7, s[12:15], s25 offen offset:2080 nt lds
    v_mfma_f32_16x16x32_bf16 v[216:219], v[108:111], v[96:99], v[216:219]
    v_fma_f32 v43, v43, s21, v14
    v_mfma_f32_16x16x32_bf16 v[220:223], v[108:111], v[100:103], v[220:223]
    s_waitcnt lgkmcnt(4)
    ds_read_b64_tr_b16 v[108:109], v4 offset:288
    v_fma_f32 v48, v48, s21, v15
    v_mfma_f32_16x16x32_bf16 v[224:227], v[112:115], v[88:91], v[224:227]
    ds_read_b64_tr_b16 v[110:111], v4 offset:800
    v_mfma_f32_16x16x32_bf16 v[228:231], v[112:115], v[92:95], v[228:231]
    v_max3_f32 v20, v20, v43, v48
    v_fma_f32 v49, v49, s21, v15
    v_mfma_f32_16x16x32_bf16 v[232:235], v[112:115], v[96:99], v[232:235]
    buffer_load_dwordx4 v8, s[12:15], s25 offen offset:3120 nt lds
    v_mfma_f32_16x16x32_bf16 v[236:239], v[112:115], v[100:103], v[236:239]
    s_waitcnt lgkmcnt(4)
    ds_read_b64_tr_b16 v[112:113], v4 offset:320
    v_mfma_f32_16x16x32_bf16 v[240:243], v[116:119], v[88:91], v[240:243]
    s_add_u32 s25, s25, 0x4000
    ds_read_b64_tr_b16 v[114:115], v4 offset:832
    v_fma_f32 v50, v50, s21, v15
    v_mfma_f32_16x16x32_bf16 v[244:247], v[116:119], v[92:95], v[244:247]
    v_add_f32 v19, v19, v85
    v_mfma_f32_16x16x32_bf16 v[248:251], v[116:119], v[96:99], v[248:251]
    v_max3_f32 v20, v20, v49, v50
    v_mfma_f32_16x16x32_bf16 v[252:255], v[116:119], v[100:103], v[252:255]
    s_waitcnt lgkmcnt(4)
    ds_read_b64_tr_b16 v[116:117], v4 offset:352
    v_fma_f32 v51, v51, s21, v15
    v_mfma_f32_16x16x32_bf16 a[128:131], v[104:107], v[88:91], a[128:131]
    ds_read_b64_tr_b16 v[118:119], v4 offset:864
    v_fma_f32 v28, v28, s21, v12
    v_mfma_f32_16x16x32_bf16 a[132:135], v[104:107], v[92:95], a[132:135]
    v_max3_f32 v20, v20, v51, v28
    v_mfma_f32_16x16x32_bf16 a[136:139], v[104:107], v[96:99], a[136:139]
    v_fma_f32 v29, v29, s21, v12
    v_mfma_f32_16x16x32_bf16 a[140:143], v[104:107], v[100:103], a[140:143]
    s_waitcnt lgkmcnt(4)
    ds_read_b64_tr_b16 v[104:105], v4 offset:384
    v_fma_f32 v30, v30, s21, v12
    v_mfma_f32_16x16x32_bf16 a[144:147], v[108:111], v[88:91], a[144:147]
    ds_read_b64_tr_b16 v[106:107], v4 offset:896
    v_max3_f32 v20, v20, v29, v30
    v_mfma_f32_16x16x32_bf16 a[148:151], v[108:111], v[92:95], a[148:151]
    v_fma_f32 v31, v31, s21, v12
    v_mfma_f32_16x16x32_bf16 a[152:155], v[108:111], v[96:99], a[152:155]
    v_fma_f32 v36, v36, s21, v13
    v_mfma_f32_16x16x32_bf16 a[156:159], v[108:111], v[100:103], a[156:159]
    s_waitcnt lgkmcnt(4)
    ds_read_b64_tr_b16 v[108:109], v4 offset:416
    v_add_f32 v19, v19, v86
    v_mfma_f32_16x16x32_bf16 a[160:163], v[112:115], v[88:91], a[160:163]
    ds_read_b64_tr_b16 v[110:111], v4 offset:928
    v_mfma_f32_16x16x32_bf16 a[164:167], v[112:115], v[92:95], a[164:167]
    v_max3_f32 v20, v20, v31, v36
    v_fma_f32 v37, v37, s21, v13
    v_mfma_f32_16x16x32_bf16 a[168:171], v[112:115], v[96:99], a[168:171]
    v_fma_f32 v38, v38, s21, v13
    v_mfma_f32_16x16x32_bf16 a[172:175], v[112:115], v[100:103], a[172:175]
    s_waitcnt lgkmcnt(4)
    ds_read_b64_tr_b16 v[112:113], v4 offset:448
    v_max3_f32 v20, v20, v37, v38
    v_mfma_f32_16x16x32_bf16 a[176:179], v[116:119], v[88:91], a[176:179]
    ds_read_b64_tr_b16 v[114:115], v4 offset:960
    v_mfma_f32_16x16x32_bf16 a[180:183], v[116:119], v[92:95], a[180:183]
    v_fma_f32 v39, v39, s21, v13
    v_mfma_f32_16x16x32_bf16 a[184:187], v[116:119], v[96:99], a[184:187]
    v_fma_f32 v44, v44, s21, v14
    v_max3_f32 v20, v20, v39, v44
    v_mfma_f32_16x16x32_bf16 a[188:191], v[116:119], v[100:103], a[188:191]
    s_waitcnt lgkmcnt(4)
    ds_read_b64_tr_b16 v[116:117], v4 offset:480
    v_mfma_f32_16x16x32_bf16 a[192:195], v[104:107], v[88:91], a[192:195]
    ds_read_b64_tr_b16 v[118:119], v4 offset:992
    v_fma_f32 v45, v45, s21, v14
    v_mfma_f32_16x16x32_bf16 a[196:199], v[104:107], v[92:95], a[196:199]
    v_fma_f32 v46, v46, s21, v14
    v_mfma_f32_16x16x32_bf16 a[200:203], v[104:107], v[96:99], a[200:203]
    v_max3_f32 v20, v20, v45, v46
    v_add_f32 v19, v19, v87
    v_mfma_f32_16x16x32_bf16 a[204:207], v[104:107], v[100:103], a[204:207]
    s_waitcnt lgkmcnt(4)
    ds_read_b128 v[104:107], v3 offset:0
    v_mfma_f32_16x16x32_bf16 a[208:211], v[108:111], v[88:91], a[208:211]
    v_fma_f32 v47, v47, s21, v14
    v_mfma_f32_16x16x32_bf16 a[212:215], v[108:111], v[92:95], a[212:215]
    v_fma_f32 v52, v52, s21, v15
    v_max3_f32 v20, v20, v47, v52
    v_mfma_f32_16x16x32_bf16 a[216:219], v[108:111], v[96:99], a[216:219]
    v_fma_f32 v53, v53, s21, v15
    v_mfma_f32_16x16x32_bf16 a[220:223], v[108:111], v[100:103], a[220:223]
    s_waitcnt lgkmcnt(3)
    ds_read_b128 v[108:111], v3 offset:16
    v_fma_f32 v54, v54, s21, v15
    v_mfma_f32_16x16x32_bf16 a[224:227], v[112:115], v[88:91], a[224:227]
    v_max3_f32 v20, v20, v53, v54
    v_mfma_f32_16x16x32_bf16 a[228:231], v[112:115], v[92:95], a[228:231]
    v_fma_f32 v55, v55, s21, v15
    v_mfma_f32_16x16x32_bf16 a[232:235], v[112:115], v[96:99], a[232:235]
    v_max3_f32 v20, v20, v55, v55
    v_mfma_f32_16x16x32_bf16 a[236:239], v[112:115], v[100:103], a[236:239]
    s_waitcnt lgkmcnt(2)
    ds_read_b128 v[112:115], v3 offset:32
    v_mfma_f32_16x16x32_bf16 a[240:243], v[116:119], v[88:91], a[240:243]
    v_mfma_f32_16x16x32_bf16 a[244:247], v[116:119], v[92:95], a[244:247]
    v_cmp_lt_f32 vcc, s35, v20
    v_mfma_f32_16x16x32_bf16 a[248:251], v[116:119], v[96:99], a[248:251]
    v_mfma_f32_16x16x32_bf16 a[252:255], v[116:119], v[100:103], a[252:255]
    s_waitcnt lgkmcnt(1)
    ds_read_b128 v[116:119], v3 offset:48
    s_cbranch_vccnz L_rare_s11c
L_cont_s11c:
    v_mfma_f32_16x16x32_bf16 v[56:59], v[104:107], a[0:3], 0
    v_exp_f32 v24, v24
    v_mfma_f32_16x16x32_bf16 v[56:59], v[108:111], a[4:7], v[56:59]
    v_add_u32 v4, s28, v2
    v_add_f32 v16, v16, v24
    v_mfma_f32_16x16x32_bf16 v[64:67], v[104:107], a[32:35], 0
    s_add_u32 s28, s28, s38
    v_exp_f32 v25, v25
    v_mfma_f32_16x16x32_bf16 v[64:67], v[108:111], a[36:39], v[64:67]
    s_sub_u32 s48, s28, s39
    v_exp_f32 v26, v26
    v_mfma_f32_16x16x32_bf16 v[72:75], v[104:107], a[64:67], 0
    s_min_u32 s28, s28, s48
    v_exp_f32 v27, v27
    v_mfma_f32_16x16x32_bf16 v[72:75], v[108:111], a[68:71], v[72:75]
    v_exp_f32 v28, v28
    v_mfma_f32_16x16x32_bf16 v[80:83], v[104:107], a[96:99], 0
    ds_read_b128 v[104:107], v3 offset:256
    v_cvt_pk_bf16_f32 v88, v24, v25
    v_mfma_f32_16x16x32_bf16 v[80:83], v[108:111], a[100:103], v[80:83]
    s_waitcnt lgkmcnt(1)
    ds_read_b128 v[108:111], v3 offset:272
    v_cvt_pk_bf16_f32 v89, v26, v27
    v_mfma_f32_16x16x32_bf16 v[56:59], v[112:115], a[8:11], v[56:59]
    v_exp_f32 v29, v29
    v_mfma_f32_16x16x32_bf16 v[56:59], v[116:119], a[12:15], v[56:59]
    v_exp_f32 v30, v30
    v_mfma_f32_16x16x32_bf16 v[64:67], v[112:115], a[40:43], v[64:67]
    v_exp_f32 v31, v31
    v_mfma_f32_16x16x32_bf16 v[64:67], v[116:119], a[44:47], v[64:67]
    v_exp_f32 v32, v32
    v_mfma_f32_16x16x32_bf16 v[72:75], v[112:115], a[72:75], v[72:75]
    v_exp_f32 v33, v33
    v_mfma_f32_16x16x32_bf16 v[72:75], v[116:119], a[76:79], v[72:75]
    v_exp_f32 v34, v34
    v_mfma_f32_16x16x32_bf16 v[80:83], v[112:115], a[104:107], v[80:83]
    ds_read_b128 v[112:115], v3 offset:288
    v_cvt_pk_bf16_f32 v90, v28, v29
    v_mfma_f32_16x16x32_bf16 v[80:83], v[116:119], a[108:111], v[80:83]
    s_waitcnt lgkmcnt(1)
    ds_read_b128 v[116:119], v3 offset:304
    v_cvt_pk_bf16_f32 v91, v30, v31
    v_mfma_f32_16x16x32_bf16 v[56:59], v[104:107], a[16:19], v[56:59]
    v_exp_f32 v35, v35
    v_mfma_f32_16x16x32_bf16 v[56:59], v[108:111], a[20:23], v[56:59]
    v_exp_f32 v36, v36
    v_mfma_f32_16x16x32_bf16 v[64:67], v[104:107], a[48:51], v[64:67]
    v_exp_f32 v37, v37
    v_mfma_f32_16x16x32_bf16 v[64:67], v[108:111], a[52:55], v[64:67]
    v_exp_f32 v38, v38
    v_mfma_f32_16x16x32_bf16 v[72:75], v[104:107], a[80:83], v[72:75]
    v_exp_f32 v39, v39
    v_mfma_f32_16x16x32_bf16 v[72:75], v[108:111], a[84:87], v[72:75]
    v_exp_f32 v40, v40
    v_mfma_f32_16x16x32_bf16 v[80:83], v[104:107], a[112:115], v[80:83]
    ds_read_b128 v[104:107], v3 offset:512
    v_cvt_pk_bf16_f32 v92, v32, v33
    v_mfma_f32_16x16x32_bf16 v[80:83], v[108:111], a[116:119], v[80:83]
    s_waitcnt lgkmcnt(1)
    ds_read_b128 v[108:111], v3 offset:528
    v_cvt_pk_bf16_f32 v93, v34, v35
    v_mfma_f32_16x16x32_bf16 v[56:59], v[112:115], a[24:27], v[56:59]
    v_exp_f32 v41, v41
    v_mfma_f32_16x16x32_bf16 v[56:59], v[116:119], a[28:31], v[56:59]
    v_exp_f32 v42, v42
    v_mfma_f32_16x16x32_bf16 v[64:67], v[112:115], a[56:59], v[64:67]
    v_exp_f32 v43, v43
    v_mfma_f32_16x16x32_bf16 v[64:67], v[116:119], a[60:63], v[64:67]
    v_exp_f32 v44, v44
    v_mfma_f32_16x16x32_bf16 v[72:75], v[112:115], a[88:91], v[72:75]
    v_exp_f32 v45, v45
    v_mfma_f32_16x16x32_bf16 v[72:75], v[116:119], a[92:95], v[72:75]
    v_exp_f32 v46, v46
    v_mfma_f32_16x16x32_bf16 v[80:83], v[112:115], a[120:123], v[80:83]
    ds_read_b128 v[112:115], v3 offset:544
    v_cvt_pk_bf16_f32 v94, v36, v37
    v_mfma_f32_16x16x32_bf16 v[80:83], v[116:119], a[124:127], v[80:83]
    s_waitcnt lgkmcnt(1)
    ds_read_b128 v[116:119], v3 offset:560
    v_cvt_pk_bf16_f32 v95, v38, v39
    v_mfma_f32_16x16x32_bf16 v[60:63], v[104:107], a[0:3], 0
    v_exp_f32 v47, v47
    v_mfma_f32_16x16x32_bf16 v[60:63], v[108:111], a[4:7], v[60:63]
    v_exp_f32 v48, v48
    v_mfma_f32_16x16x32_bf16 v[68:71], v[104:107], a[32:35], 0
    v_exp_f32 v49, v49
    v_mfma_f32_16x16x32_bf16 v[68:71], v[108:111], a[36:39], v[68:71]
    v_exp_f32 v50, v50
    v_mfma_f32_16x16x32_bf16 v[76:79], v[104:107], a[64:67], 0
    v_exp_f32 v51, v51
    v_mfma_f32_16x16x32_bf16 v[76:79], v[108:111], a[68:71], v[76:79]
    v_exp_f32 v52, v52
    v_mfma_f32_16x16x32_bf16 v[84:87], v[104:107], a[96:99], 0
    ds_read_b128 v[104:107], v3 offset:768
    v_cvt_pk_bf16_f32 v96, v40, v41
    v_mfma_f32_16x16x32_bf16 v[84:87], v[108:111], a[100:103], v[84:87]
    s_waitcnt lgkmcnt(1)
    ds_read_b128 v[108:111], v3 offset:784
    v_cvt_pk_bf16_f32 v97, v42, v43
    v_mfma_f32_16x16x32_bf16 v[60:63], v[112:115], a[8:11], v[60:63]
    v_exp_f32 v53, v53
    v_mfma_f32_16x16x32_bf16 v[60:63], v[116:119], a[12:15], v[60:63]
    v_exp_f32 v54, v54
    v_mfma_f32_16x16x32_bf16 v[68:71], v[112:115], a[40:43], v[68:71]
    v_exp_f32 v55, v55
    v_mfma_f32_16x16x32_bf16 v[68:71], v[116:119], a[44:47], v[68:71]
    v_cvt_pk_bf16_f32 v98, v44, v45
    v_cvt_pk_bf16_f32 v99, v46, v47
    v_mfma_f32_16x16x32_bf16 v[76:79], v[112:115], a[72:75], v[76:79]
    v_cvt_pk_bf16_f32 v100, v48, v49
    v_cvt_pk_bf16_f32 v101, v50, v51
    v_mfma_f32_16x16x32_bf16 v[76:79], v[116:119], a[76:79], v[76:79]
    v_cvt_pk_bf16_f32 v102, v52, v53
    v_cvt_pk_bf16_f32 v103, v54, v55
    v_mfma_f32_16x16x32_bf16 v[84:87], v[112:115], a[104:107], v[84:87]
    ds_read_b128 v[112:115], v3 offset:800
    v_add_f32 v16, v16, v25
    v_mfma_f32_16x16x32_bf16 v[84:87], v[116:119], a[108:111], v[84:87]
    s_waitcnt lgkmcnt(1)
    ds_read_b128 v[116:119], v3 offset:816
    v_add_f32 v16, v16, v26
    v_mfma_f32_16x16x32_bf16 v[60:63], v[104:107], a[16:19], v[60:63]
    v_add_f32 v16, v16, v27
    v_add_f32 v16, v16, v28
    v_mfma_f32_16x16x32_bf16 v[60:63], v[108:111], a[20:23], v[60:63]
    v_add_u32 v3, s28, v1
    v_add_f32 v16, v16, v29
    v_mfma_f32_16x16x32_bf16 v[68:71], v[104:107], a[48:51], v[68:71]
    s_add_u32 s28, s28, s38
    v_add_f32 v16, v16, v30
    v_add_f32 v16, v16, v31
    v_mfma_f32_16x16x32_bf16 v[68:71], v[108:111], a[52:55], v[68:71]
    s_sub_u32 s48, s28, s39
    v_add_f32 v17, v17, v32
    v_add_f32 v17, v17, v33
    v_mfma_f32_16x16x32_bf16 v[76:79], v[104:107], a[80:83], v[76:79]
    s_min_u32 s28, s28, s48
    v_add_f32 v17, v17, v34
    v_add_f32 v17, v17, v35
    v_mfma_f32_16x16x32_bf16 v[76:79], v[108:111], a[84:87], v[76:79]
    v_add_f32 v17, v17, v36
    v_add_f32 v17, v17, v37
    v_mfma_f32_16x16x32_bf16 v[84:87], v[104:107], a[112:115], v[84:87]
    ds_read_b64_tr_b16 v[104:105], v4 offset:0
    v_add_f32 v17, v17, v38
    v_mfma_f32_16x16x32_bf16 v[84:87], v[108:111], a[116:119], v[84:87]
    s_waitcnt lgkmcnt(1)
    ds_read_b64_tr_b16 v[106:107], v4 offset:512
    ds_read_b64_tr_b16 v[108:109], v4 offset:32
    v_mfma_f32_16x16x32_bf16 v[60:63], v[112:115], a[24:27], v[60:63]
    ds_read_b64_tr_b16 v[110:111], v4 offset:544
    v_add_f32 v17, v17, v39
    v_mfma_f32_16x16x32_bf16 v[60:63], v[116:119], a[28:31], v[60:63]
    v_add_f32 v18, v18, v40
    v_add_f32 v18, v18, v41
    v_mfma_f32_16x16x32_bf16 v[68:71], v[112:115], a[56:59], v[68:71]
    v_add_f32 v18, v18, v42
    v_add_f32 v18, v18, v43
    v_mfma_f32_16x16x32_bf16 v[68:71], v[116:119], a[60:63], v[68:71]
    v_add_f32 v18, v18, v44
    v_add_f32 v18, v18, v45
    v_mfma_f32_16x16x32_bf16 v[76:79], v[112:115], a[88:91], v[76:79]
    v_add_f32 v18, v18, v46
    v_add_f32 v18, v18, v47
    v_mfma_f32_16x16x32_bf16 v[76:79], v[116:119], a[92:95], v[76:79]
    v_add_f32 v19, v19, v48
    v_add_f32 v19, v19, v49
    v_mfma_f32_16x16x32_bf16 v[84:87], v[112:115], a[120:123], v[84:87]
    ds_read_b64_tr_b16 v[112:113], v4 offset:64
    v_add_f32 v19, v19, v50
    v_mfma_f32_16x16x32_bf16 v[84:87], v[116:119], a[124:127], v[84:87]
    s_waitcnt lgkmcnt(3)
    ds_read_b64_tr_b16 v[114:115], v4 offset:576
    ds_read_b64_tr_b16 v[116:117], v4 offset:96
    v_mfma_f32_16x16x32_bf16 v[128:131], v[104:107], v[88:91], v[128:131]
    ds_read_b64_tr_b16 v[118:119], v4 offset:608
    v_fma_f32 v56, v56, s21, v12
    v_mfma_f32_16x16x32_bf16 v[132:135], v[104:107], v[92:95], v[132:135]
    v_add_f32 v19, v19, v51
    v_mfma_f32_16x16x32_bf16 v[136:139], v[104:107], v[96:99], v[136:139]
    v_fma_f32 v57, v57, s21, v12
    v_mfma_f32_16x16x32_bf16 v[140:143], v[104:107], v[100:103], v[140:143]
    s_waitcnt lgkmcnt(4)
    ds_read_b64_tr_b16 v[104:105], v4 offset:128
    v_fma_f32 v58, v58, s21, v12
    v_mfma_f32_16x16x32_bf16 v[144:147], v[108:111], v[88:91], v[144:147]
    s_waitcnt vmcnt(12)
    ds_read_b64_tr_b16 v[106:107], v4 offset:640
    v_max3_f32 v20, v56, v57, v58
    v_mfma_f32_16x16x32_bf16 v[148:151], v[108:111], v[92:95], v[148:151]
    v_fma_f32 v59, v59, s21, v12
    v_mfma_f32_16x16x32_bf16 v[152:155], v[108:111], v[96:99], v[152:155]
    s_barrier
    v_fma_f32 v64, v64, s21, v13
    v_mfma_f32_16x16x32_bf16 v[156:159], v[108:111], v[100:103], v[156:159]
    s_waitcnt lgkmcnt(4)
    ds_read_b64_tr_b16 v[108:109], v4 offset:160
    v_mfma_f32_16x16x32_bf16 v[160:163], v[112:115], v[88:91], v[160:163]
    ds_read_b64_tr_b16 v[110:111], v4 offset:672
    v_max3_f32 v20, v20, v59, v64
    v_mfma_f32_16x16x32_bf16 v[164:167], v[112:115], v[92:95], v[164:167]
    v_fma_f32 v65, v65, s21, v13
    v_mfma_f32_16x16x32_bf16 v[168:171], v[112:115], v[96:99], v[168:171]
    v_fma_f32 v66, v66, s21, v13
    v_mfma_f32_16x16x32_bf16 v[172:175], v[112:115], v[100:103], v[172:175]
    s_waitcnt lgkmcnt(4)
    ds_read_b64_tr_b16 v[112:113], v4 offset:192
    v_max3_f32 v20, v20, v65, v66
    v_mfma_f32_16x16x32_bf16 v[176:179], v[116:119], v[88:91], v[176:179]
    ds_read_b64_tr_b16 v[114:115], v4 offset:704
    v_fma_f32 v67, v67, s21, v13
    v_mfma_f32_16x16x32_bf16 v[180:183], v[116:119], v[92:95], v[180:183]
    v_add_f32 v19, v19, v52
    v_mfma_f32_16x16x32_bf16 v[184:187], v[116:119], v[96:99], v[184:187]
    v_fma_f32 v72, v72, s21, v14
    v_mfma_f32_16x16x32_bf16 v[188:191], v[116:119], v[100:103], v[188:191]
    s_waitcnt lgkmcnt(4)
    ds_read_b64_tr_b16 v[116:117], v4 offset:224
    v_mfma_f32_16x16x32_bf16 v[192:195], v[104:107], v[88:91], v[192:195]
    ds_read_b64_tr_b16 v[118:119], v4 offset:736
    v_max3_f32 v20, v20, v67, v72
    v_mfma_f32_16x16x32_bf16 v[196:199], v[104:107], v[92:95], v[196:199]
    v_fma_f32 v73, v73, s21, v14
    v_mfma_f32_16x16x32_bf16 v[200:203], v[104:107], v[96:99], v[200:203]
    v_fma_f32 v74, v74, s21, v14
    v_mfma_f32_16x16x32_bf16 v[204:207], v[104:107], v[100:103], v[204:207]
    s_waitcnt lgkmcnt(4)
    ds_read_b64_tr_b16 v[104:105], v4 offset:256
    v_max3_f32 v20, v20, v73, v74
    v_mfma_f32_16x16x32_bf16 v[208:211], v[108:111], v[88:91], v[208:211]
    ds_read_b64_tr_b16 v[106:107], v4 offset:768
    v_fma_f32 v75, v75, s21, v14
    v_mfma_f32_16x16x32_bf16 v[212:215], v[108:111], v[92:95], v[212:215]
    v_fma_f32 v80, v80, s21, v15
    v_mfma_f32_16x16x32_bf16 v[216:219], v[108:111], v[96:99], v[216:219]
    v_max3_f32 v20, v20, v75, v80
    v_mfma_f32_16x16x32_bf16 v[220:223], v[108:111], v[100:103], v[220:223]
    s_waitcnt lgkmcnt(4)
    ds_read_b64_tr_b16 v[108:109], v4 offset:288
    v_mfma_f32_16x16x32_bf16 v[224:227], v[112:115], v[88:91], v[224:227]
    ds_read_b64_tr_b16 v[110:111], v4 offset:800
    v_fma_f32 v81, v81, s21, v15
    v_mfma_f32_16x16x32_bf16 v[228:231], v[112:115], v[92:95], v[228:231]
    v_fma_f32 v82, v82, s21, v15
    v_mfma_f32_16x16x32_bf16 v[232:235], v[112:115], v[96:99], v[232:235]
    v_add_f32 v19, v19, v53
    v_mfma_f32_16x16x32_bf16 v[236:239], v[112:115], v[100:103], v[236:239]
    s_waitcnt lgkmcnt(4)
    ds_read_b64_tr_b16 v[112:113], v4 offset:320
    v_max3_f32 v20, v20, v81, v82
    v_mfma_f32_16x16x32_bf16 v[240:243], v[116:119], v[88:91], v[240:243]
    ds_read_b64_tr_b16 v[114:115], v4 offset:832
    v_fma_f32 v83, v83, s21, v15
    v_mfma_f32_16x16x32_bf16 v[244:247], v[116:119], v[92:95], v[244:247]
    v_fma_f32 v60, v60, s21, v12
    v_mfma_f32_16x16x32_bf16 v[248:251], v[116:119], v[96:99], v[248:251]
    v_max3_f32 v20, v20, v83, v60
    v_mfma_f32_16x16x32_bf16 v[252:255], v[116:119], v[100:103], v[252:255]
    s_waitcnt lgkmcnt(4)
    ds_read_b64_tr_b16 v[116:117], v4 offset:352
    v_mfma_f32_16x16x32_bf16 a[128:131], v[104:107], v[88:91], a[128:131]
    ds_read_b64_tr_b16 v[118:119], v4 offset:864
    v_fma_f32 v61, v61, s21, v12
    v_mfma_f32_16x16x32_bf16 a[132:135], v[104:107], v[92:95], a[132:135]
    v_fma_f32 v62, v62, s21, v12
    v_mfma_f32_16x16x32_bf16 a[136:139], v[104:107], v[96:99], a[136:139]
    v_max3_f32 v20, v20, v61, v62
    v_mfma_f32_16x16x32_bf16 a[140:143], v[104:107], v[100:103], a[140:143]
    s_waitcnt lgkmcnt(4)
    ds_read_b64_tr_b16 v[104:105], v4 offset:384
    v_fma_f32 v63, v63, s21, v12
    v_mfma_f32_16x16x32_bf16 a[144:147], v[108:111], v[88:91], a[144:147]
    ds_read_b64_tr_b16 v[106:107], v4 offset:896
    v_fma_f32 v68, v68, s21, v13
    v_mfma_f32_16x16x32_bf16 a[148:151], v[108:111], v[92:95], a[148:151]
    v_add_f32 v19, v19, v54
    v_mfma_f32_16x16x32_bf16 a[152:155], v[108:111], v[96:99], a[152:155]
    v_max3_f32 v20, v20, v63, v68
    v_mfma_f32_16x16x32_bf16 a[156:159], v[108:111], v[100:103], a[156:159]
    s_waitcnt lgkmcnt(4)
    ds_read_b64_tr_b16 v[108:109], v4 offset:416
    v_mfma_f32_16x16x32_bf16 a[160:163], v[112:115], v[88:91], a[160:163]
    ds_read_b64_tr_b16 v[110:111], v4 offset:928
    v_fma_f32 v69, v69, s21, v13
    v_mfma_f32_16x16x32_bf16 a[164:167], v[112:115], v[92:95], a[164:167]
    v_fma_f32 v70, v70, s21, v13
    v_mfma_f32_16x16x32_bf16 a[168:171], v[112:115], v[96:99], a[168:171]
    v_max3_f32 v20, v20, v69, v70
    v_mfma_f32_16x16x32_bf16 a[172:175], v[112:115], v[100:103], a[172:175]
    s_waitcnt lgkmcnt(4)
    ds_read_b64_tr_b16 v[112:113], v4 offset:448
    v_fma_f32 v71, v71, s21, v13
    v_mfma_f32_16x16x32_bf16 a[176:179], v[116:119], v[88:91], a[176:179]
    ds_read_b64_tr_b16 v[114:115], v4 offset:960
    v_fma_f32 v76, v76, s21, v14
    v_mfma_f32_16x16x32_bf16 a[180:183], v[116:119], v[92:95], a[180:183]
    v_max3_f32 v20, v20, v71, v76
    v_mfma_f32_16x16x32_bf16 a[184:187], v[116:119], v[96:99], a[184:187]
    v_fma_f32 v77, v77, s21, v14
    v_mfma_f32_16x16x32_bf16 a[188:191], v[116:119], v[100:103], a[188:191]
    s_waitcnt lgkmcnt(4)
    ds_read_b64_tr_b16 v[116:117], v4 offset:480
    v_mfma_f32_16x16x32_bf16 a[192:195], v[104:107], v[88:91], a[192:195]
    ds_read_b64_tr_b16 v[118:119], v4 offset:992
    v_fma_f32 v78, v78, s21, v14
    v_mfma_f32_16x16x32_bf16 a[196:199], v[104:107], v[92:95], a[196:199]
    v_max3_f32 v20, v20, v77, v78
    v_mfma_f32_16x16x32_bf16 a[200:203], v[104:107], v[96:99], a[200:203]
    v_add_f32 v19, v19, v55
    v_mfma_f32_16x16x32_bf16 a[204:207], v[104:107], v[100:103], a[204:207]
    s_waitcnt lgkmcnt(4)
    ds_read_b128 v[104:107], v3 offset:0
    v_fma_f32 v79, v79, s21, v14
    v_mfma_f32_16x16x32_bf16 a[208:211], v[108:111], v[88:91], a[208:211]
    v_fma_f32 v84, v84, s21, v15
    v_mfma_f32_16x16x32_bf16 a[212:215], v[108:111], v[92:95], a[212:215]
    v_max3_f32 v20, v20, v79, v84
    v_mfma_f32_16x16x32_bf16 a[216:219], v[108:111], v[96:99], a[216:219]
    v_fma_f32 v85, v85, s21, v15
    v_mfma_f32_16x16x32_bf16 a[220:223], v[108:111], v[100:103], a[220:223]
    s_waitcnt lgkmcnt(3)
    ds_read_b128 v[108:111], v3 offset:16
    v_fma_f32 v86, v86, s21, v15
    v_mfma_f32_16x16x32_bf16 a[224:227], v[112:115], v[88:91], a[224:227]
    v_max3_f32 v20, v20, v85, v86
    v_mfma_f32_16x16x32_bf16 a[228:231], v[112:115], v[92:95], a[228:231]
    v_fma_f32 v87, v87, s21, v15
    v_mfma_f32_16x16x32_bf16 a[232:235], v[112:115], v[96:99], a[232:235]
    v_max3_f32 v20, v20, v87, v87
    v_mfma_f32_16x16x32_bf16 a[236:239], v[112:115], v[100:103], a[236:239]
    s_waitcnt lgkmcnt(2)
    ds_read_b128 v[112:115], v3 offset:32
    v_mfma_f32_16x16x32_bf16 a[240:243], v[116:119], v[88:91], a[240:243]
    v_mfma_f32_16x16x32_bf16 a[244:247], v[116:119], v[92:95], a[244:247]
    v_cmp_lt_f32 vcc, s35, v20
    v_mfma_f32_16x16x32_bf16 a[248:251], v[116:119], v[96:99], a[248:251]
    v_mfma_f32_16x16x32_bf16 a[252:255], v[116:119], v[100:103], a[252:255]
    s_waitcnt lgkmcnt(1)
    ds_read_b128 v[116:119], v3 offset:48
    s_cbranch_vccnz L_rare_s12c
L_cont_s12c:
    v_mfma_f32_16x16x32_bf16 v[24:27], v[104:107], a[0:3], 0
    v_exp_f32 v56, v56
    v_mfma_f32_16x16x32_bf16 v[24:27], v[108:111], a[4:7], v[24:27]
    v_add_u32 v4, s28, v2
    v_add_f32 v16, v16, v56
    v_mfma_f32_16x16x32_bf16 v[32:35], v[104:107], a[32:35], 0
    s_add_u32 s28, s28, s38
    v_exp_f32 v57, v57
    v_mfma_f32_16x16x32_bf16 v[32:35], v[108:111], a[36:39], v[32:35]
    s_sub_u32 s48, s28, s39
    v_exp_f32 v58, v58
    v_mfma_f32_16x16x32_bf16 v[40:43], v[104:107], a[64:67], 0
    s_min_u32 s28, s28, s48
    v_exp_f32 v59, v59
    v_mfma_f32_16x16x32_bf16 v[40:43], v[108:111], a[68:71], v[40:43]
    v_exp_f32 v60, v60
    v_mfma_f32_16x16x32_bf16 v[48:51], v[104:107], a[96:99], 0
    ds_read_b128 v[104:107], v3 offset:256
    v_cvt_pk_bf16_f32 v88, v56, v57
    v_mfma_f32_16x16x32_bf16 v[48:51], v[108:111], a[100:103], v[48:51]
    s_waitcnt lgkmcnt(1)
    ds_read_b128 v[108:111], v3 offset:272
    v_cvt_pk_bf16_f32 v89, v58, v59
    v_mfma_f32_16x16x32_bf16 v[24:27], v[112:115], a[8:11], v[24:27]
    v_exp_f32 v61, v61
    v_mfma_f32_16x16x32_bf16 v[24:27], v[116:119], a[12:15], v[24:27]
    v_exp_f32 v62, v62
    v_mfma_f32_16x16x32_bf16 v[32:35], v[112:115], a[40:43], v[32:35]
    v_exp_f32 v63, v63
    v_mfma_f32_16x16x32_bf16 v[32:35], v[116:119], a[44:47], v[32:35]
    v_exp_f32 v64, v64
    v_mfma_f32_16x16x32_bf16 v[40:43], v[112:115], a[72:75], v[40:43]
    v_exp_f32 v65, v65
    v_mfma_f32_16x16x32_bf16 v[40:43], v[116:119], a[76:79], v[40:43]
    v_exp_f32 v66, v66
    v_mfma_f32_16x16x32_bf16 v[48:51], v[112:115], a[104:107], v[48:51]
    ds_read_b128 v[112:115], v3 offset:288
    v_cvt_pk_bf16_f32 v90, v60, v61
    v_mfma_f32_16x16x32_bf16 v[48:51], v[116:119], a[108:111], v[48:51]
    s_waitcnt lgkmcnt(1)
    ds_read_b128 v[116:119], v3 offset:304
    v_cvt_pk_bf16_f32 v91, v62, v63
    v_mfma_f32_16x16x32_bf16 v[24:27], v[104:107], a[16:19], v[24:27]
    v_exp_f32 v67, v67
    v_mfma_f32_16x16x32_bf16 v[24:27], v[108:111], a[20:23], v[24:27]
    v_exp_f32 v68, v68
    v_mfma_f32_16x16x32_bf16 v[32:35], v[104:107], a[48:51], v[32:35]
    v_exp_f32 v69, v69
    v_mfma_f32_16x16x32_bf16 v[32:35], v[108:111], a[52:55], v[32:35]
    v_exp_f32 v70, v70
    v_mfma_f32_16x16x32_bf16 v[40:43], v[104:107], a[80:83], v[40:43]
    v_exp_f32 v71, v71
    v_mfma_f32_16x16x32_bf16 v[40:43], v[108:111], a[84:87], v[40:43]
    v_exp_f32 v72, v72
    v_mfma_f32_16x16x32_bf16 v[48:51], v[104:107], a[112:115], v[48:51]
    ds_read_b128 v[104:107], v3 offset:512
    v_cvt_pk_bf16_f32 v92, v64, v65
    v_mfma_f32_16x16x32_bf16 v[48:51], v[108:111], a[116:119], v[48:51]
    s_waitcnt lgkmcnt(1)
    ds_read_b128 v[108:111], v3 offset:528
    v_cvt_pk_bf16_f32 v93, v66, v67
    v_mfma_f32_16x16x32_bf16 v[24:27], v[112:115], a[24:27], v[24:27]
    v_exp_f32 v73, v73
    v_mfma_f32_16x16x32_bf16 v[24:27], v[116:119], a[28:31], v[24:27]
    v_exp_f32 v74, v74
    v_mfma_f32_16x16x32_bf16 v[32:35], v[112:115], a[56:59], v[32:35]
    v_exp_f32 v75, v75
    v_mfma_f32_16x16x32_bf16 v[32:35], v[116:119], a[60:63], v[32:35]
    v_exp_f32 v76, v76
    v_mfma_f32_16x16x32_bf16 v[40:43], v[112:115], a[88:91], v[40:43]
    v_exp_f32 v77, v77
    v_mfma_f32_16x16x32_bf16 v[40:43], v[116:119], a[92:95], v[40:43]
    v_exp_f32 v78, v78
    v_mfma_f32_16x16x32_bf16 v[48:51], v[112:115], a[120:123], v[48:51]
    ds_read_b128 v[112:115], v3 offset:544
    v_cvt_pk_bf16_f32 v94, v68, v69
    v_mfma_f32_16x16x32_bf16 v[48:51], v[116:119], a[124:127], v[48:51]
    s_waitcnt lgkmcnt(1)
    ds_read_b128 v[116:119], v3 offset:560
    v_cvt_pk_bf16_f32 v95, v70, v71
    v_mfma_f32_16x16x32_bf16 v[28:31], v[104:107], a[0:3], 0
    v_exp_f32 v79, v79
    v_mfma_f32_16x16x32_bf16 v[28:31], v[108:111], a[4:7], v[28:31]
    v_exp_f32 v80, v80
    v_mfma_f32_16x16x32_bf16 v[36:39], v[104:107], a[32:35], 0
    v_exp_f32 v81, v81
    v_mfma_f32_16x16x32_bf16 v[36:39], v[108:111], a[36:39], v[36:39]
    v_exp_f32 v82, v82
    v_mfma_f32_16x16x32_bf16 v[44:47], v[104:107], a[64:67], 0
    v_exp_f32 v83, v83
    v_mfma_f32_16x16x32_bf16 v[44:47], v[108:111], a[68:71], v[44:47]
    v_exp_f32 v84, v84
    v_mfma_f32_16x16x32_bf16 v[52:55], v[104:107], a[96:99], 0
    ds_read_b128 v[104:107], v3 offset:768
    v_cvt_pk_bf16_f32 v96, v72, v73
    v_mfma_f32_16x16x32_bf16 v[52:55], v[108:111], a[100:103], v[52:55]
    s_waitcnt lgkmcnt(1)
    ds_read_b128 v[108:111], v3 offset:784
    v_cvt_pk_bf16_f32 v97, v74, v75
    v_mfma_f32_16x16x32_bf16 v[28:31], v[112:115], a[8:11], v[28:31]
    v_exp_f32 v85, v85
    v_mfma_f32_16x16x32_bf16 v[28:31], v[116:119], a[12:15], v[28:31]
    v_exp_f32 v86, v86
    v_mfma_f32_16x16x32_bf16 v[36:39], v[112:115], a[40:43], v[36:39]
    v_exp_f32 v87, v87
    v_mfma_f32_16x16x32_bf16 v[36:39], v[116:119], a[44:47], v[36:39]
    v_cvt_pk_bf16_f32 v98, v76, v77
    v_cvt_pk_bf16_f32 v99, v78, v79
    v_mfma_f32_16x16x32_bf16 v[44:47], v[112:115], a[72:75], v[44:47]
    v_cvt_pk_bf16_f32 v100, v80, v81
    v_cvt_pk_bf16_f32 v101, v82, v83
    v_mfma_f32_16x16x32_bf16 v[44:47], v[116:119], a[76:79], v[44:47]
    v_cvt_pk_bf16_f32 v102, v84, v85
    v_cvt_pk_bf16_f32 v103, v86, v87
    v_mfma_f32_16x16x32_bf16 v[52:55], v[112:115], a[104:107], v[52:55]
    ds_read_b128 v[112:115], v3 offset:800
    v_add_f32 v16, v16, v57
    v_mfma_f32_16x16x32_bf16 v[52:55], v[116:119], a[108:111], v[52:55]
    s_waitcnt lgkmcnt(1)
    ds_read_b128 v[116:119], v3 offset:816
    v_add_f32 v16, v16, v58
    v_mfma_f32_16x16x32_bf16 v[28:31], v[104:107], a[16:19], v[28:31]
    v_add_f32 v16, v16, v59
    v_add_f32 v16, v16, v60
    v_mfma_f32_16x16x32_bf16 v[28:31], v[108:111], a[20:23], v[28:31]
    v_add_u32 v3, s28, v1
    v_add_f32 v16, v16, v61
    v_mfma_f32_16x16x32_bf16 v[36:39], v[104:107], a[48:51], v[36:39]
    s_add_u32 s28, s28, s38
    v_add_f32 v16, v16, v62
    v_add_f32 v16, v16, v63
    v_mfma_f32_16x16x32_bf16 v[36:39], v[108:111], a[52:55], v[36:39]
    s_sub_u32 s48, s28, s39
    v_add_f32 v17, v17, v64
    v_add_f32 v17, v17, v65
    v_mfma_f32_16x16x32_bf16 v[44:47], v[104:107], a[80:83], v[44:47]
    s_min_u32 s28, s28, s48
    v_add_f32 v17, v17, v66
    v_add_f32 v17, v17, v67
    v_mfma_f32_16x16x32_bf16 v[44:47], v[108:111], a[84:87], v[44:47]
    v_add_f32 v17, v17, v68
    v_add_f32 v17, v17, v69
    v_mfma_f32_16x16x32_bf16 v[52:55], v[104:107], a[112:115], v[52:55]
    ds_read_b64_tr_b16 v[104:105], v4 offset:0
    v_add_f32 v17, v17, v70
    v_mfma_f32_16x16x32_bf16 v[52:55], v[108:111], a[116:119], v[52:55]
    s_waitcnt lgkmcnt(1)
    ds_read_b64_tr_b16 v[106:107], v4 offset:512
    ds_read_b64_tr_b16 v[108:109], v4 offset:32
    v_mfma_f32_16x16x32_bf16 v[28:31], v[112:115], a[24:27], v[28:31]
    ds_read_b64_tr_b16 v[110:111], v4 offset:544
    v_add_f32 v17, v17, v71
    v_mfma_f32_16x16x32_bf16 v[28:31], v[116:119], a[28:31], v[28:31]
    v_add_f32 v18, v18, v72
    v_add_f32 v18, v18, v73
    v_mfma_f32_16x16x32_bf16 v[36:39], v[112:115], a[56:59], v[36:39]
    v_add_f32 v18, v18, v74
    v_add_f32 v18, v18, v75
    v_mfma_f32_16x16x32_bf16 v[36:39], v[116:119], a[60:63], v[36:39]
    v_add_f32 v18, v18, v76
    v_add_f32 v18, v18, v77
    v_mfma_f32_16x16x32_bf16 v[44:47], v[112:115], a[88:91], v[44:47]
    v_add_f32 v18, v18, v78
    v_add_f32 v18, v18, v79
    v_mfma_f32_16x16x32_bf16 v[44:47], v[116:119], a[92:95], v[44:47]
    v_add_f32 v19, v19, v80
    v_add_f32 v19, v19, v81
    v_mfma_f32_16x16x32_bf16 v[52:55], v[112:115], a[120:123], v[52:55]
    ds_read_b64_tr_b16 v[112:113], v4 offset:64
    v_add_f32 v19, v19, v82
    v_mfma_f32_16x16x32_bf16 v[52:55], v[116:119], a[124:127], v[52:55]
    s_waitcnt lgkmcnt(3)
    ds_read_b64_tr_b16 v[114:115], v4 offset:576
    ds_read_b64_tr_b16 v[116:117], v4 offset:96
    v_mfma_f32_16x16x32_bf16 v[128:131], v[104:107], v[88:91], v[128:131]
    ds_read_b64_tr_b16 v[118:119], v4 offset:608
    v_fma_f32 v24, v24, s21, v12
    v_mfma_f32_16x16x32_bf16 v[132:135], v[104:107], v[92:95], v[132:135]
    v_add_f32 v19, v19, v83
    v_mfma_f32_16x16x32_bf16 v[136:139], v[104:107], v[96:99], v[136:139]
    v_fma_f32 v25, v25, s21, v12
    v_mfma_f32_16x16x32_bf16 v[140:143], v[104:107], v[100:103], v[140:143]
    s_waitcnt lgkmcnt(4)
    ds_read_b64_tr_b16 v[104:105], v4 offset:128
    v_fma_f32 v26, v26, s21, v12
    v_mfma_f32_16x16x32_bf16 v[144:147], v[108:111], v[88:91], v[144:147]
    s_waitcnt vmcnt(4)
    ds_read_b64_tr_b16 v[106:107], v4 offset:640
    v_max3_f32 v20, v24, v25, v26
    v_mfma_f32_16x16x32_bf16 v[148:151], v[108:111], v[92:95], v[148:151]
    v_fma_f32 v27, v27, s21, v12
    v_mfma_f32_16x16x32_bf16 v[152:155], v[108:111], v[96:99], v[152:155]
    s_barrier
    v_fma_f32 v32, v32, s21, v13
    v_mfma_f32_16x16x32_bf16 v[156:159], v[108:111], v[100:103], v[156:159]
    s_waitcnt lgkmcnt(4)
    ds_read_b64_tr_b16 v[108:109], v4 offset:160
    v_mfma_f32_16x16x32_bf16 v[160:163], v[112:115], v[88:91], v[160:163]
    ds_read_b64_tr_b16 v[110:111], v4 offset:672
    v_max3_f32 v20, v20, v27, v32
    v_mfma_f32_16x16x32_bf16 v[164:167], v[112:115], v[92:95], v[164:167]
    v_fma_f32 v33, v33, s21, v13
    v_mfma_f32_16x16x32_bf16 v[168:171], v[112:115], v[96:99], v[168:171]
    v_fma_f32 v34, v34, s21, v13
    v_mfma_f32_16x16x32_bf16 v[172:175], v[112:115], v[100:103], v[172:175]
    s_waitcnt lgkmcnt(4)
    ds_read_b64_tr_b16 v[112:113], v4 offset:192
    v_max3_f32 v20, v20, v33, v34
    v_mfma_f32_16x16x32_bf16 v[176:179], v[116:119], v[88:91], v[176:179]
    ds_read_b64_tr_b16 v[114:115], v4 offset:704
    v_fma_f32 v35, v35, s21, v13
    v_mfma_f32_16x16x32_bf16 v[180:183], v[116:119], v[92:95], v[180:183]
    v_add_f32 v19, v19, v84
    v_mfma_f32_16x16x32_bf16 v[184:187], v[116:119], v[96:99], v[184:187]
    v_fma_f32 v40, v40, s21, v14
    v_mfma_f32_16x16x32_bf16 v[188:191], v[116:119], v[100:103], v[188:191]
    s_waitcnt lgkmcnt(4)
    ds_read_b64_tr_b16 v[116:117], v4 offset:224
    v_mfma_f32_16x16x32_bf16 v[192:195], v[104:107], v[88:91], v[192:195]
    ds_read_b64_tr_b16 v[118:119], v4 offset:736
    v_max3_f32 v20, v20, v35, v40
    v_mfma_f32_16x16x32_bf16 v[196:199], v[104:107], v[92:95], v[196:199]
    v_fma_f32 v41, v41, s21, v14
    v_mfma_f32_16x16x32_bf16 v[200:203], v[104:107], v[96:99], v[200:203]
    v_fma_f32 v42, v42, s21, v14
    v_mfma_f32_16x16x32_bf16 v[204:207], v[104:107], v[100:103], v[204:207]
    s_waitcnt lgkmcnt(4)
    ds_read_b64_tr_b16 v[104:105], v4 offset:256
    v_max3_f32 v20, v20, v41, v42
    v_mfma_f32_16x16x32_bf16 v[208:211], v[108:111], v[88:91], v[208:211]
    ds_read_b64_tr_b16 v[106:107], v4 offset:768
    v_fma_f32 v43, v43, s21, v14
    v_mfma_f32_16x16x32_bf16 v[212:215], v[108:111], v[92:95], v[212:215]
    v_fma_f32 v48, v48, s21, v15
    v_mfma_f32_16x16x32_bf16 v[216:219], v[108:111], v[96:99], v[216:219]
    v_max3_f32 v20, v20, v43, v48
    v_mfma_f32_16x16x32_bf16 v[220:223], v[108:111], v[100:103], v[220:223]
    s_waitcnt lgkmcnt(4)
    ds_read_b64_tr_b16 v[108:109], v4 offset:288
    v_mfma_f32_16x16x32_bf16 v[224:227], v[112:115], v[88:91], v[224:227]
    ds_read_b64_tr_b16 v[110:111], v4 offset:800
    v_fma_f32 v49, v49, s21, v15
    v_mfma_f32_16x16x32_bf16 v[228:231], v[112:115], v[92:95], v[228:231]
    v_fma_f32 v50, v50, s21, v15
    v_mfma_f32_16x16x32_bf16 v[232:235], v[112:115], v[96:99], v[232:235]
    v_add_f32 v19, v19, v85
    v_mfma_f32_16x16x32_bf16 v[236:239], v[112:115], v[100:103], v[236:239]
    s_waitcnt lgkmcnt(4)
    ds_read_b64_tr_b16 v[112:113], v4 offset:320
    v_max3_f32 v20, v20, v49, v50
    v_mfma_f32_16x16x32_bf16 v[240:243], v[116:119], v[88:91], v[240:243]
    ds_read_b64_tr_b16 v[114:115], v4 offset:832
    v_fma_f32 v51, v51, s21, v15
    v_mfma_f32_16x16x32_bf16 v[244:247], v[116:119], v[92:95], v[244:247]
    v_fma_f32 v28, v28, s21, v12
    v_mfma_f32_16x16x32_bf16 v[248:251], v[116:119], v[96:99], v[248:251]
    v_max3_f32 v20, v20, v51, v28
    v_mfma_f32_16x16x32_bf16 v[252:255], v[116:119], v[100:103], v[252:255]
    s_waitcnt lgkmcnt(4)
    ds_read_b64_tr_b16 v[116:117], v4 offset:352
    v_mfma_f32_16x16x32_bf16 a[128:131], v[104:107], v[88:91], a[128:131]
    ds_read_b64_tr_b16 v[118:119], v4 offset:864
    v_fma_f32 v29, v29, s21, v12
    v_mfma_f32_16x16x32_bf16 a[132:135], v[104:107], v[92:95], a[132:135]
    v_fma_f32 v30, v30, s21, v12
    v_mfma_f32_16x16x32_bf16 a[136:139], v[104:107], v[96:99], a[136:139]
    v_max3_f32 v20, v20, v29, v30
    v_mfma_f32_16x16x32_bf16 a[140:143], v[104:107], v[100:103], a[140:143]
    s_waitcnt lgkmcnt(4)
    ds_read_b64_tr_b16 v[104:105], v4 offset:384
    v_fma_f32 v31, v31, s21, v12
    v_mfma_f32_16x16x32_bf16 a[144:147], v[108:111], v[88:91], a[144:147]
    ds_read_b64_tr_b16 v[106:107], v4 offset:896
    v_fma_f32 v36, v36, s21, v13
    v_mfma_f32_16x16x32_bf16 a[148:151], v[108:111], v[92:95], a[148:151]
    v_add_f32 v19, v19, v86
    v_mfma_f32_16x16x32_bf16 a[152:155], v[108:111], v[96:99], a[152:155]
    v_max3_f32 v20, v20, v31, v36
    v_mfma_f32_16x16x32_bf16 a[156:159], v[108:111], v[100:103], a[156:159]
    s_waitcnt lgkmcnt(4)
    ds_read_b64_tr_b16 v[108:109], v4 offset:416
    v_mfma_f32_16x16x32_bf16 a[160:163], v[112:115], v[88:91], a[160:163]
    ds_read_b64_tr_b16 v[110:111], v4 offset:928
    v_fma_f32 v37, v37, s21, v13
    v_mfma_f32_16x16x32_bf16 a[164:167], v[112:115], v[92:95], a[164:167]
    v_fma_f32 v38, v38, s21, v13
    v_mfma_f32_16x16x32_bf16 a[168:171], v[112:115], v[96:99], a[168:171]
    v_max3_f32 v20, v20, v37, v38
    v_mfma_f32_16x16x32_bf16 a[172:175], v[112:115], v[100:103], a[172:175]
    s_waitcnt lgkmcnt(4)
    ds_read_b64_tr_b16 v[112:113], v4 offset:448
    v_fma_f32 v39, v39, s21, v13
    v_mfma_f32_16x16x32_bf16 a[176:179], v[116:119], v[88:91], a[176:179]
    ds_read_b64_tr_b16 v[114:115], v4 offset:960
    v_fma_f32 v44, v44, s21, v14
    v_mfma_f32_16x16x32_bf16 a[180:183], v[116:119], v[92:95], a[180:183]
    v_max3_f32 v20, v20, v39, v44
    v_mfma_f32_16x16x32_bf16 a[184:187], v[116:119], v[96:99], a[184:187]
    v_fma_f32 v45, v45, s21, v14
    v_mfma_f32_16x16x32_bf16 a[188:191], v[116:119], v[100:103], a[188:191]
    s_waitcnt lgkmcnt(4)
    ds_read_b64_tr_b16 v[116:117], v4 offset:480
    v_mfma_f32_16x16x32_bf16 a[192:195], v[104:107], v[88:91], a[192:195]
    ds_read_b64_tr_b16 v[118:119], v4 offset:992
    v_fma_f32 v46, v46, s21, v14
    v_mfma_f32_16x16x32_bf16 a[196:199], v[104:107], v[92:95], a[196:199]
    v_max3_f32 v20, v20, v45, v46
    v_mfma_f32_16x16x32_bf16 a[200:203], v[104:107], v[96:99], a[200:203]
    v_add_f32 v19, v19, v87
    v_mfma_f32_16x16x32_bf16 a[204:207], v[104:107], v[100:103], a[204:207]
    s_waitcnt lgkmcnt(4)
    ds_read_b128 v[104:107], v3 offset:0
    v_fma_f32 v47, v47, s21, v14
    v_mfma_f32_16x16x32_bf16 a[208:211], v[108:111], v[88:91], a[208:211]
    v_fma_f32 v52, v52, s21, v15
    v_mfma_f32_16x16x32_bf16 a[212:215], v[108:111], v[92:95], a[212:215]
    v_max3_f32 v20, v20, v47, v52
    v_mfma_f32_16x16x32_bf16 a[216:219], v[108:111], v[96:99], a[216:219]
    v_fma_f32 v53, v53, s21, v15
    v_mfma_f32_16x16x32_bf16 a[220:223], v[108:111], v[100:103], a[220:223]
    s_waitcnt lgkmcnt(3)
    ds_read_b128 v[108:111], v3 offset:16
    v_fma_f32 v54, v54, s21, v15
    v_mfma_f32_16x16x32_bf16 a[224:227], v[112:115], v[88:91], a[224:227]
    v_max3_f32 v20, v20, v53, v54
    v_mfma_f32_16x16x32_bf16 a[228:231], v[112:115], v[92:95], a[228:231]
    v_fma_f32 v55, v55, s21, v15
    v_mfma_f32_16x16x32_bf16 a[232:235], v[112:115], v[96:99], a[232:235]
    v_max3_f32 v20, v20, v55, v55
    v_mfma_f32_16x16x32_bf16 a[236:239], v[112:115], v[100:103], a[236:239]
    s_waitcnt lgkmcnt(2)
    ds_read_b128 v[112:115], v3 offset:32
    v_mfma_f32_16x16x32_bf16 a[240:243], v[116:119], v[88:91], a[240:243]
    v_mfma_f32_16x16x32_bf16 a[244:247], v[116:119], v[92:95], a[244:247]
    v_cmp_lt_f32 vcc, s35, v20
    v_mfma_f32_16x16x32_bf16 a[248:251], v[116:119], v[96:99], a[248:251]
    v_mfma_f32_16x16x32_bf16 a[252:255], v[116:119], v[100:103], a[252:255]
    s_waitcnt lgkmcnt(1)
    ds_read_b128 v[116:119], v3 offset:48
    s_cbranch_vccnz L_rare_s13c
L_cont_s13c:
    v_mfma_f32_16x16x32_bf16 v[56:59], v[104:107], a[0:3], 0
    v_exp_f32 v24, v24
    v_mfma_f32_16x16x32_bf16 v[56:59], v[108:111], a[4:7], v[56:59]
    v_add_u32 v4, s28, v2
    v_add_f32 v16, v16, v24
    v_mfma_f32_16x16x32_bf16 v[64:67], v[104:107], a[32:35], 0
    s_add_u32 s28, s28, s38
    v_exp_f32 v25, v25
    v_mfma_f32_16x16x32_bf16 v[64:67], v[108:111], a[36:39], v[64:67]
    s_sub_u32 s48, s28, s39
    v_exp_f32 v26, v26
    v_mfma_f32_16x16x32_bf16 v[72:75], v[104:107], a[64:67], 0
    s_min_u32 s28, s28, s48
    v_exp_f32 v27, v27
    v_mfma_f32_16x16x32_bf16 v[72:75], v[108:111], a[68:71], v[72:75]
    v_exp_f32 v28, v28
    v_mfma_f32_16x16x32_bf16 v[80:83], v[104:107], a[96:99], 0
    ds_read_b128 v[104:107], v3 offset:256
    v_cvt_pk_bf16_f32 v88, v24, v25
    v_mfma_f32_16x16x32_bf16 v[80:83], v[108:111], a[100:103], v[80:83]
    s_waitcnt lgkmcnt(1)
    ds_read_b128 v[108:111], v3 offset:272
    v_cvt_pk_bf16_f32 v89, v26, v27
    v_mfma_f32_16x16x32_bf16 v[56:59], v[112:115], a[8:11], v[56:59]
    v_exp_f32 v29, v29
    v_mfma_f32_16x16x32_bf16 v[56:59], v[116:119], a[12:15], v[56:59]
    v_exp_f32 v30, v30
    v_mfma_f32_16x16x32_bf16 v[64:67], v[112:115], a[40:43], v[64:67]
    v_exp_f32 v31, v31
    v_mfma_f32_16x16x32_bf16 v[64:67], v[116:119], a[44:47], v[64:67]
    v_exp_f32 v32, v32
    v_mfma_f32_16x16x32_bf16 v[72:75], v[112:115], a[72:75], v[72:75]
    v_exp_f32 v33, v33
    v_mfma_f32_16x16x32_bf16 v[72:75], v[116:119], a[76:79], v[72:75]
    v_exp_f32 v34, v34
    v_mfma_f32_16x16x32_bf16 v[80:83], v[112:115], a[104:107], v[80:83]
    ds_read_b128 v[112:115], v3 offset:288
    v_cvt_pk_bf16_f32 v90, v28, v29
    v_mfma_f32_16x16x32_bf16 v[80:83], v[116:119], a[108:111], v[80:83]
    s_waitcnt lgkmcnt(1)
    ds_read_b128 v[116:119], v3 offset:304
    v_cvt_pk_bf16_f32 v91, v30, v31
    v_mfma_f32_16x16x32_bf16 v[56:59], v[104:107], a[16:19], v[56:59]
    v_exp_f32 v35, v35
    v_mfma_f32_16x16x32_bf16 v[56:59], v[108:111], a[20:23], v[56:59]
    v_exp_f32 v36, v36
    v_mfma_f32_16x16x32_bf16 v[64:67], v[104:107], a[48:51], v[64:67]
    v_exp_f32 v37, v37
    v_mfma_f32_16x16x32_bf16 v[64:67], v[108:111], a[52:55], v[64:67]
    v_exp_f32 v38, v38
    v_mfma_f32_16x16x32_bf16 v[72:75], v[104:107], a[80:83], v[72:75]
    v_exp_f32 v39, v39
    v_mfma_f32_16x16x32_bf16 v[72:75], v[108:111], a[84:87], v[72:75]
    v_exp_f32 v40, v40
    v_mfma_f32_16x16x32_bf16 v[80:83], v[104:107], a[112:115], v[80:83]
    ds_read_b128 v[104:107], v3 offset:512
    v_cvt_pk_bf16_f32 v92, v32, v33
    v_mfma_f32_16x16x32_bf16 v[80:83], v[108:111], a[116:119], v[80:83]
    s_waitcnt lgkmcnt(1)
    ds_read_b128 v[108:111], v3 offset:528
    v_cvt_pk_bf16_f32 v93, v34, v35
    v_mfma_f32_16x16x32_bf16 v[56:59], v[112:115], a[24:27], v[56:59]
    v_exp_f32 v41, v41
    v_mfma_f32_16x16x32_bf16 v[56:59], v[116:119], a[28:31], v[56:59]
    v_exp_f32 v42, v42
    v_mfma_f32_16x16x32_bf16 v[64:67], v[112:115], a[56:59], v[64:67]
    v_exp_f32 v43, v43
    v_mfma_f32_16x16x32_bf16 v[64:67], v[116:119], a[60:63], v[64:67]
    v_exp_f32 v44, v44
    v_mfma_f32_16x16x32_bf16 v[72:75], v[112:115], a[88:91], v[72:75]
    v_exp_f32 v45, v45
    v_mfma_f32_16x16x32_bf16 v[72:75], v[116:119], a[92:95], v[72:75]
    v_exp_f32 v46, v46
    v_mfma_f32_16x16x32_bf16 v[80:83], v[112:115], a[120:123], v[80:83]
    ds_read_b128 v[112:115], v3 offset:544
    v_cvt_pk_bf16_f32 v94, v36, v37
    v_mfma_f32_16x16x32_bf16 v[80:83], v[116:119], a[124:127], v[80:83]
    s_waitcnt lgkmcnt(1)
    ds_read_b128 v[116:119], v3 offset:560
    v_cvt_pk_bf16_f32 v95, v38, v39
    v_mfma_f32_16x16x32_bf16 v[60:63], v[104:107], a[0:3], 0
    v_exp_f32 v47, v47
    v_mfma_f32_16x16x32_bf16 v[60:63], v[108:111], a[4:7], v[60:63]
    v_exp_f32 v48, v48
    v_mfma_f32_16x16x32_bf16 v[68:71], v[104:107], a[32:35], 0
    v_exp_f32 v49, v49
    v_mfma_f32_16x16x32_bf16 v[68:71], v[108:111], a[36:39], v[68:71]
    v_exp_f32 v50, v50
    v_mfma_f32_16x16x32_bf16 v[76:79], v[104:107], a[64:67], 0
    v_exp_f32 v51, v51
    v_mfma_f32_16x16x32_bf16 v[76:79], v[108:111], a[68:71], v[76:79]
    v_exp_f32 v52, v52
    v_mfma_f32_16x16x32_bf16 v[84:87], v[104:107], a[96:99], 0
    ds_read_b128 v[104:107], v3 offset:768
    v_cvt_pk_bf16_f32 v96, v40, v41
    v_mfma_f32_16x16x32_bf16 v[84:87], v[108:111], a[100:103], v[84:87]
    s_waitcnt lgkmcnt(1)
    ds_read_b128 v[108:111], v3 offset:784
    v_cvt_pk_bf16_f32 v97, v42, v43
    v_mfma_f32_16x16x32_bf16 v[60:63], v[112:115], a[8:11], v[60:63]
    v_exp_f32 v53, v53
    v_mfma_f32_16x16x32_bf16 v[60:63], v[116:119], a[12:15], v[60:63]
    v_exp_f32 v54, v54
    v_mfma_f32_16x16x32_bf16 v[68:71], v[112:115], a[40:43], v[68:71]
    v_exp_f32 v55, v55
    v_mfma_f32_16x16x32_bf16 v[68:71], v[116:119], a[44:47], v[68:71]
    v_cvt_pk_bf16_f32 v98, v44, v45
    v_cvt_pk_bf16_f32 v99, v46, v47
    v_mfma_f32_16x16x32_bf16 v[76:79], v[112:115], a[72:75], v[76:79]
    v_cvt_pk_bf16_f32 v100, v48, v49
    v_cvt_pk_bf16_f32 v101, v50, v51
    v_mfma_f32_16x16x32_bf16 v[76:79], v[116:119], a[76:79], v[76:79]
    v_cvt_pk_bf16_f32 v102, v52, v53
    v_cvt_pk_bf16_f32 v103, v54, v55
    v_mfma_f32_16x16x32_bf16 v[84:87], v[112:115], a[104:107], v[84:87]
    ds_read_b128 v[112:115], v3 offset:800
    v_add_f32 v16, v16, v25
    v_mfma_f32_16x16x32_bf16 v[84:87], v[116:119], a[108:111], v[84:87]
    s_waitcnt lgkmcnt(1)
    ds_read_b128 v[116:119], v3 offset:816
    v_add_f32 v16, v16, v26
    v_mfma_f32_16x16x32_bf16 v[60:63], v[104:107], a[16:19], v[60:63]
    v_add_f32 v16, v16, v27
    v_add_f32 v16, v16, v28
    v_mfma_f32_16x16x32_bf16 v[60:63], v[108:111], a[20:23], v[60:63]
    v_add_f32 v16, v16, v29
    v_add_f32 v16, v16, v30
    v_mfma_f32_16x16x32_bf16 v[68:71], v[104:107], a[48:51], v[68:71]
    v_add_f32 v16, v16, v31
    v_add_f32 v17, v17, v32
    v_mfma_f32_16x16x32_bf16 v[68:71], v[108:111], a[52:55], v[68:71]
    v_add_f32 v17, v17, v33
    v_add_f32 v17, v17, v34
    v_mfma_f32_16x16x32_bf16 v[76:79], v[104:107], a[80:83], v[76:79]
    v_add_f32 v17, v17, v35
    v_add_f32 v17, v17, v36
    v_mfma_f32_16x16x32_bf16 v[76:79], v[108:111], a[84:87], v[76:79]
    v_add_f32 v17, v17, v37
    v_add_f32 v17, v17, v38
    v_mfma_f32_16x16x32_bf16 v[84:87], v[104:107], a[112:115], v[84:87]
    ds_read_b64_tr_b16 v[104:105], v4 offset:0
    v_add_f32 v17, v17, v39
    v_mfma_f32_16x16x32_bf16 v[84:87], v[108:111], a[116:119], v[84:87]
    s_waitcnt lgkmcnt(1)
    ds_read_b64_tr_b16 v[106:107], v4 offset:512
    ds_read_b64_tr_b16 v[108:109], v4 offset:32
    v_mfma_f32_16x16x32_bf16 v[60:63], v[112:115], a[24:27], v[60:63]
    ds_read_b64_tr_b16 v[110:111], v4 offset:544
    v_add_f32 v18, v18, v40
    v_mfma_f32_16x16x32_bf16 v[60:63], v[116:119], a[28:31], v[60:63]
    v_add_f32 v18, v18, v41
    v_add_f32 v18, v18, v42
    v_mfma_f32_16x16x32_bf16 v[68:71], v[112:115], a[56:59], v[68:71]
    v_add_f32 v18, v18, v43
    v_add_f32 v18, v18, v44
    v_mfma_f32_16x16x32_bf16 v[68:71], v[116:119], a[60:63], v[68:71]
    v_add_f32 v18, v18, v45
    v_add_f32 v18, v18, v46
    v_mfma_f32_16x16x32_bf16 v[76:79], v[112:115], a[88:91], v[76:79]
    v_add_f32 v18, v18, v47
    v_add_f32 v19, v19, v48
    v_mfma_f32_16x16x32_bf16 v[76:79], v[116:119], a[92:95], v[76:79]
    v_add_f32 v19, v19, v49
    v_add_f32 v19, v19, v50
    v_mfma_f32_16x16x32_bf16 v[84:87], v[112:115], a[120:123], v[84:87]
    ds_read_b64_tr_b16 v[112:113], v4 offset:64
    v_add_f32 v19, v19, v51
    v_mfma_f32_16x16x32_bf16 v[84:87], v[116:119], a[124:127], v[84:87]
    s_waitcnt lgkmcnt(3)
    ds_read_b64_tr_b16 v[114:115], v4 offset:576
    ds_read_b64_tr_b16 v[116:117], v4 offset:96
    v_mfma_f32_16x16x32_bf16 v[128:131], v[104:107], v[88:91], v[128:131]
    ds_read_b64_tr_b16 v[118:119], v4 offset:608
    v_fma_f32 v56, v56, s21, v12
    v_mfma_f32_16x16x32_bf16 v[132:135], v[104:107], v[92:95], v[132:135]
    v_add_f32 v19, v19, v52
    v_mfma_f32_16x16x32_bf16 v[136:139], v[104:107], v[96:99], v[136:139]
    v_fma_f32 v57, v57, s21, v12
    v_mfma_f32_16x16x32_bf16 v[140:143], v[104:107], v[100:103], v[140:143]
    s_waitcnt lgkmcnt(4)
    ds_read_b64_tr_b16 v[104:105], v4 offset:128
    v_fma_f32 v58, v58, s21, v12
    v_mfma_f32_16x16x32_bf16 v[144:147], v[108:111], v[88:91], v[144:147]
    s_waitcnt vmcnt(0)
    ds_read_b64_tr_b16 v[106:107], v4 offset:640
    v_mfma_f32_16x16x32_bf16 v[148:151], v[108:111], v[92:95], v[148:151]
    v_max3_f32 v20, v56, v57, v58
    v_fma_f32 v59, v59, s21, v12
    v_mfma_f32_16x16x32_bf16 v[152:155], v[108:111], v[96:99], v[152:155]
    s_barrier
    v_fma_f32 v64, v64, s21, v13
    v_mfma_f32_16x16x32_bf16 v[156:159], v[108:111], v[100:103], v[156:159]
    s_waitcnt lgkmcnt(4)
    ds_read_b64_tr_b16 v[108:109], v4 offset:160
    v_mfma_f32_16x16x32_bf16 v[160:163], v[112:115], v[88:91], v[160:163]
    ds_read_b64_tr_b16 v[110:111], v4 offset:672
    v_max3_f32 v20, v20, v59, v64
    v_mfma_f32_16x16x32_bf16 v[164:167], v[112:115], v[92:95], v[164:167]
    v_fma_f32 v65, v65, s21, v13
    v_mfma_f32_16x16x32_bf16 v[168:171], v[112:115], v[96:99], v[168:171]
    v_fma_f32 v66, v66, s21, v13
    v_mfma_f32_16x16x32_bf16 v[172:175], v[112:115], v[100:103], v[172:175]
    s_waitcnt lgkmcnt(4)
    ds_read_b64_tr_b16 v[112:113], v4 offset:192
    v_max3_f32 v20, v20, v65, v66
    v_mfma_f32_16x16x32_bf16 v[176:179], v[116:119], v[88:91], v[176:179]
    ds_read_b64_tr_b16 v[114:115], v4 offset:704
    v_mfma_f32_16x16x32_bf16 v[180:183], v[116:119], v[92:95], v[180:183]
    v_fma_f32 v67, v67, s21, v13
    v_mfma_f32_16x16x32_bf16 v[184:187], v[116:119], v[96:99], v[184:187]
    v_fma_f32 v72, v72, s21, v14
    v_mfma_f32_16x16x32_bf16 v[188:191], v[116:119], v[100:103], v[188:191]
    s_waitcnt lgkmcnt(4)
    ds_read_b64_tr_b16 v[116:117], v4 offset:224
    v_max3_f32 v20, v20, v67, v72
    v_mfma_f32_16x16x32_bf16 v[192:195], v[104:107], v[88:91], v[192:195]
    ds_read_b64_tr_b16 v[118:119], v4 offset:736
    v_mfma_f32_16x16x32_bf16 v[196:199], v[104:107], v[92:95], v[196:199]
    v_add_f32 v19, v19, v53
    v_fma_f32 v73, v73, s21, v14
    v_mfma_f32_16x16x32_bf16 v[200:203], v[104:107], v[96:99], v[200:203]
    v_fma_f32 v74, v74, s21, v14
    v_mfma_f32_16x16x32_bf16 v[204:207], v[104:107], v[100:103], v[204:207]
    s_waitcnt lgkmcnt(4)
    ds_read_b64_tr_b16 v[104:105], v4 offset:256
    v_mfma_f32_16x16x32_bf16 v[208:211], v[108:111], v[88:91], v[208:211]
    ds_read_b64_tr_b16 v[106:107], v4 offset:768
    v_max3_f32 v20, v20, v73, v74
    v_mfma_f32_16x16x32_bf16 v[212:215], v[108:111], v[92:95], v[212:215]
    v_fma_f32 v75, v75, s21, v14
    v_mfma_f32_16x16x32_bf16 v[216:219], v[108:111], v[96:99], v[216:219]
    v_fma_f32 v80, v80, s21, v15
    v_mfma_f32_16x16x32_bf16 v[220:223], v[108:111], v[100:103], v[220:223]
    s_waitcnt lgkmcnt(4)
    ds_read_b64_tr_b16 v[108:109], v4 offset:288
    v_max3_f32 v20, v20, v75, v80
    v_mfma_f32_16x16x32_bf16 v[224:227], v[112:115], v[88:91], v[224:227]
    ds_read_b64_tr_b16 v[110:111], v4 offset:800
    v_mfma_f32_16x16x32_bf16 v[228:231], v[112:115], v[92:95], v[228:231]
    v_fma_f32 v81, v81, s21, v15
    v_mfma_f32_16x16x32_bf16 v[232:235], v[112:115], v[96:99], v[232:235]
    v_fma_f32 v82, v82, s21, v15
    v_mfma_f32_16x16x32_bf16 v[236:239], v[112:115], v[100:103], v[236:239]
    s_waitcnt lgkmcnt(4)
    ds_read_b64_tr_b16 v[112:113], v4 offset:320
    v_max3_f32 v20, v20, v81, v82
    v_mfma_f32_16x16x32_bf16 v[240:243], v[116:119], v[88:91], v[240:243]
    ds_read_b64_tr_b16 v[114:115], v4 offset:832
    v_fma_f32 v83, v83, s21, v15
    v_mfma_f32_16x16x32_bf16 v[244:247], v[116:119], v[92:95], v[244:247]
    v_fma_f32 v60, v60, s21, v12
    v_mfma_f32_16x16x32_bf16 v[248:251], v[116:119], v[96:99], v[248:251]
    v_max3_f32 v20, v20, v83, v60
    v_mfma_f32_16x16x32_bf16 v[252:255], v[116:119], v[100:103], v[252:255]
    s_waitcnt lgkmcnt(4)
    ds_read_b64_tr_b16 v[116:117], v4 offset:352
    v_mfma_f32_16x16x32_bf16 a[128:131], v[104:107], v[88:91], a[128:131]
    ds_read_b64_tr_b16 v[118:119], v4 offset:864
    v_add_f32 v19, v19, v54
    v_mfma_f32_16x16x32_bf16 a[132:135], v[104:107], v[92:95], a[132:135]
    v_fma_f32 v61, v61, s21, v12
    v_mfma_f32_16x16x32_bf16 a[136:139], v[104:107], v[96:99], a[136:139]
    v_fma_f32 v62, v62, s21, v12
    v_mfma_f32_16x16x32_bf16 a[140:143], v[104:107], v[100:103], a[140:143]
    s_waitcnt lgkmcnt(4)
    ds_read_b64_tr_b16 v[104:105], v4 offset:384
    v_max3_f32 v20, v20, v61, v62
    v_mfma_f32_16x16x32_bf16 a[144:147], v[108:111], v[88:91], a[144:147]
    ds_read_b64_tr_b16 v[106:107], v4 offset:896
    v_mfma_f32_16x16x32_bf16 a[148:151], v[108:111], v[92:95], a[148:151]
    v_fma_f32 v63, v63, s21, v12
    v_mfma_f32_16x16x32_bf16 a[152:155], v[108:111], v[96:99], a[152:155]
    v_fma_f32 v68, v68, s21, v13
    v_mfma_f32_16x16x32_bf16 a[156:159], v[108:111], v[100:103], a[156:159]
    s_waitcnt lgkmcnt(4)
    ds_read_b64_tr_b16 v[108:109], v4 offset:416
    v_max3_f32 v20, v20, v63, v68
    v_mfma_f32_16x16x32_bf16 a[160:163], v[112:115], v[88:91], a[160:163]
    ds_read_b64_tr_b16 v[110:111], v4 offset:928
    v_fma_f32 v69, v69, s21, v13
    v_mfma_f32_16x16x32_bf16 a[164:167], v[112:115], v[92:95], a[164:167]
    v_fma_f32 v70, v70, s21, v13
    v_mfma_f32_16x16x32_bf16 a[168:171], v[112:115], v[96:99], a[168:171]
    v_max3_f32 v20, v20, v69, v70
    v_mfma_f32_16x16x32_bf16 a[172:175], v[112:115], v[100:103], a[172:175]
    s_waitcnt lgkmcnt(4)
    ds_read_b64_tr_b16 v[112:113], v4 offset:448
    v_mfma_f32_16x16x32_bf16 a[176:179], v[116:119], v[88:91], a[176:179]
    ds_read_b64_tr_b16 v[114:115], v4 offset:960
    v_fma_f32 v71, v71, s21, v13
    v_mfma_f32_16x16x32_bf16 a[180:183], v[116:119], v[92:95], a[180:183]
    v_fma_f32 v76, v76, s21, v14
    v_mfma_f32_16x16x32_bf16 a[184:187], v[116:119], v[96:99], a[184:187]
    v_max3_f32 v20, v20, v71, v76
    v_mfma_f32_16x16x32_bf16 a[188:191], v[116:119], v[100:103], a[188:191]
    s_waitcnt lgkmcnt(4)
    ds_read_b64_tr_b16 v[116:117], v4 offset:480
    v_add_f32 v19, v19, v55
    v_mfma_f32_16x16x32_bf16 a[192:195], v[104:107], v[88:91], a[192:195]
    ds_read_b64_tr_b16 v[118:119], v4 offset:992
    v_mfma_f32_16x16x32_bf16 a[196:199], v[104:107], v[92:95], a[196:199]
    v_fma_f32 v77, v77, s21, v14
    v_mfma_f32_16x16x32_bf16 a[200:203], v[104:107], v[96:99], a[200:203]
    v_fma_f32 v78, v78, s21, v14
    v_max3_f32 v20, v20, v77, v78
    v_mfma_f32_16x16x32_bf16 a[204:207], v[104:107], v[100:103], a[204:207]
    s_waitcnt lgkmcnt(4)
    v_fma_f32 v79, v79, s21, v14
    v_mfma_f32_16x16x32_bf16 a[208:211], v[108:111], v[88:91], a[208:211]
    v_fma_f32 v84, v84, s21, v15
    v_mfma_f32_16x16x32_bf16 a[212:215], v[108:111], v[92:95], a[212:215]
    v_max3_f32 v20, v20, v79, v84
    v_mfma_f32_16x16x32_bf16 a[216:219], v[108:111], v[96:99], a[216:219]
    v_fma_f32 v85, v85, s21, v15
    v_mfma_f32_16x16x32_bf16 a[220:223], v[108:111], v[100:103], a[220:223]
    s_waitcnt lgkmcnt(2)
    v_fma_f32 v86, v86, s21, v15
    v_mfma_f32_16x16x32_bf16 a[224:227], v[112:115], v[88:91], a[224:227]
    v_max3_f32 v20, v20, v85, v86
    v_mfma_f32_16x16x32_bf16 a[228:231], v[112:115], v[92:95], a[228:231]
    v_fma_f32 v87, v87, s21, v15
    v_mfma_f32_16x16x32_bf16 a[232:235], v[112:115], v[96:99], a[232:235]
    v_max3_f32 v20, v20, v87, v87
    v_mfma_f32_16x16x32_bf16 a[236:239], v[112:115], v[100:103], a[236:239]
    s_waitcnt lgkmcnt(0)
    v_mfma_f32_16x16x32_bf16 a[240:243], v[116:119], v[88:91], a[240:243]
    v_mfma_f32_16x16x32_bf16 a[244:247], v[116:119], v[92:95], a[244:247]
    v_cmp_lt_f32 vcc, s35, v20
    v_mfma_f32_16x16x32_bf16 a[248:251], v[116:119], v[96:99], a[248:251]
    v_mfma_f32_16x16x32_bf16 a[252:255], v[116:119], v[100:103], a[252:255]
    s_cbranch_vccnz L_rare_s14c
L_cont_s14c:
    v_exp_f32 v56, v56
    v_add_u32 v4, s28, v2
    v_exp_f32 v57, v57
    v_add_f32 v16, v16, v56
    s_barrier
    v_exp_f32 v58, v58
    v_cvt_pk_bf16_f32 v88, v56, v57
    v_add_f32 v16, v16, v57
    s_add_u32 s28, s28, s38
    v_exp_f32 v59, v59
    v_add_f32 v16, v16, v58
    s_sub_u32 s48, s28, s39
    v_exp_f32 v60, v60
    v_cvt_pk_bf16_f32 v89, v58, v59
    v_add_f32 v16, v16, v59
    s_min_u32 s28, s28, s48
    v_exp_f32 v61, v61
    v_add_f32 v16, v16, v60
    v_exp_f32 v62, v62
    v_cvt_pk_bf16_f32 v90, v60, v61
    v_add_f32 v16, v16, v61
    v_exp_f32 v63, v63
    v_add_f32 v16, v16, v62
    v_exp_f32 v64, v64
    v_cvt_pk_bf16_f32 v91, v62, v63
    v_add_f32 v16, v16, v63
    v_exp_f32 v65, v65
    v_add_f32 v17, v17, v64
    v_exp_f32 v66, v66
    v_cvt_pk_bf16_f32 v92, v64, v65
    v_add_f32 v17, v17, v65
    v_exp_f32 v67, v67
    v_add_f32 v17, v17, v66
    v_exp_f32 v68, v68
    v_cvt_pk_bf16_f32 v93, v66, v67
    v_add_f32 v17, v17, v67
    v_exp_f32 v69, v69
    v_add_f32 v17, v17, v68
    v_exp_f32 v70, v70
    v_cvt_pk_bf16_f32 v94, v68, v69
    v_add_f32 v17, v17, v69
    v_exp_f32 v71, v71
    v_add_f32 v17, v17, v70
    v_exp_f32 v72, v72
    v_cvt_pk_bf16_f32 v95, v70, v71
    v_add_f32 v17, v17, v71
    v_exp_f32 v73, v73
    v_add_f32 v18, v18, v72
    v_exp_f32 v74, v74
    v_cvt_pk_bf16_f32 v96, v72, v73
    v_add_f32 v18, v18, v73
    v_exp_f32 v75, v75
    v_add_f32 v18, v18, v74
    v_exp_f32 v76, v76
    v_cvt_pk_bf16_f32 v97, v74, v75
    v_add_f32 v18, v18, v75
    v_exp_f32 v77, v77
    v_add_f32 v18, v18, v76
    v_exp_f32 v78, v78
    v_cvt_pk_bf16_f32 v98, v76, v77
    v_add_f32 v18, v18, v77
    v_exp_f32 v79, v79
    v_add_f32 v18, v18, v78
    v_exp_f32 v80, v80
    v_cvt_pk_bf16_f32 v99, v78, v79
    v_add_f32 v18, v18, v79
    v_exp_f32 v81, v81
    v_add_f32 v19, v19, v80
    v_exp_f32 v82, v82
    v_cvt_pk_bf16_f32 v100, v80, v81
    v_add_f32 v19, v19, v81
    v_exp_f32 v83, v83
    v_add_f32 v19, v19, v82
    v_exp_f32 v84, v84
    v_cvt_pk_bf16_f32 v101, v82, v83
    v_add_f32 v19, v19, v83
    v_exp_f32 v85, v85
    v_add_f32 v19, v19, v84
    v_exp_f32 v86, v86
    v_cvt_pk_bf16_f32 v102, v84, v85
    v_add_f32 v19, v19, v85
    v_exp_f32 v87, v87
    v_add_f32 v19, v19, v86
    v_cvt_pk_bf16_f32 v103, v86, v87
    v_add_f32 v19, v19, v87
    ds_read_b64_tr_b16 v[104:105], v4 offset:0
    ds_read_b64_tr_b16 v[106:107], v4 offset:512
    ds_read_b64_tr_b16 v[108:109], v4 offset:32
    ds_read_b64_tr_b16 v[110:111], v4 offset:544
    ds_read_b64_tr_b16 v[112:113], v4 offset:64
    ds_read_b64_tr_b16 v[114:115], v4 offset:576
    s_waitcnt lgkmcnt(4)
    ds_read_b64_tr_b16 v[116:117], v4 offset:96
    v_mfma_f32_16x16x32_bf16 v[128:131], v[104:107], v[88:91], v[128:131]
    ds_read_b64_tr_b16 v[118:119], v4 offset:608
    v_mfma_f32_16x16x32_bf16 v[132:135], v[104:107], v[92:95], v[132:135]
    v_mfma_f32_16x16x32_bf16 v[136:139], v[104:107], v[96:99], v[136:139]
    v_mfma_f32_16x16x32_bf16 v[140:143], v[104:107], v[100:103], v[140:143]
    s_waitcnt lgkmcnt(4)
    ds_read_b64_tr_b16 v[104:105], v4 offset:128
    v_mfma_f32_16x16x32_bf16 v[144:147], v[108:111], v[88:91], v[144:147]
    ds_read_b64_tr_b16 v[106:107], v4 offset:640
    v_mfma_f32_16x16x32_bf16 v[148:151], v[108:111], v[92:95], v[148:151]
    v_mfma_f32_16x16x32_bf16 v[152:155], v[108:111], v[96:99], v[152:155]
    v_mfma_f32_16x16x32_bf16 v[156:159], v[108:111], v[100:103], v[156:159]
    s_waitcnt lgkmcnt(4)
    ds_read_b64_tr_b16 v[108:109], v4 offset:160
    v_mfma_f32_16x16x32_bf16 v[160:163], v[112:115], v[88:91], v[160:163]
    ds_read_b64_tr_b16 v[110:111], v4 offset:672
    v_mfma_f32_16x16x32_bf16 v[164:167], v[112:115], v[92:95], v[164:167]
    v_mfma_f32_16x16x32_bf16 v[168:171], v[112:115], v[96:99], v[168:171]
    v_mfma_f32_16x16x32_bf16 v[172:175], v[112:115], v[100:103], v[172:175]
    s_waitcnt lgkmcnt(4)
    ds_read_b64_tr_b16 v[112:113], v4 offset:192
    v_mfma_f32_16x16x32_bf16 v[176:179], v[116:119], v[88:91], v[176:179]
    ds_read_b64_tr_b16 v[114:115], v4 offset:704
    v_mfma_f32_16x16x32_bf16 v[180:183], v[116:119], v[92:95], v[180:183]
    v_mfma_f32_16x16x32_bf16 v[184:187], v[116:119], v[96:99], v[184:187]
    v_mfma_f32_16x16x32_bf16 v[188:191], v[116:119], v[100:103], v[188:191]
    s_waitcnt lgkmcnt(4)
    ds_read_b64_tr_b16 v[116:117], v4 offset:224
    v_mfma_f32_16x16x32_bf16 v[192:195], v[104:107], v[88:91], v[192:195]
    ds_read_b64_tr_b16 v[118:119], v4 offset:736
    v_mfma_f32_16x16x32_bf16 v[196:199], v[104:107], v[92:95], v[196:199]
    v_mfma_f32_16x16x32_bf16 v[200:203], v[104:107], v[96:99], v[200:203]
    v_mfma_f32_16x16x32_bf16 v[204:207], v[104:107], v[100:103], v[204:207]
    s_waitcnt lgkmcnt(4)
    ds_read_b64_tr_b16 v[104:105], v4 offset:256
    v_mfma_f32_16x16x32_bf16 v[208:211], v[108:111], v[88:91], v[208:211]
    ds_read_b64_tr_b16 v[106:107], v4 offset:768
    v_mfma_f32_16x16x32_bf16 v[212:215], v[108:111], v[92:95], v[212:215]
    v_mfma_f32_16x16x32_bf16 v[216:219], v[108:111], v[96:99], v[216:219]
    v_mfma_f32_16x16x32_bf16 v[220:223], v[108:111], v[100:103], v[220:223]
    s_waitcnt lgkmcnt(4)
    ds_read_b64_tr_b16 v[108:109], v4 offset:288
    v_mfma_f32_16x16x32_bf16 v[224:227], v[112:115], v[88:91], v[224:227]
    ds_read_b64_tr_b16 v[110:111], v4 offset:800
    v_mfma_f32_16x16x32_bf16 v[228:231], v[112:115], v[92:95], v[228:231]
    v_mfma_f32_16x16x32_bf16 v[232:235], v[112:115], v[96:99], v[232:235]
    v_mfma_f32_16x16x32_bf16 v[236:239], v[112:115], v[100:103], v[236:239]
    s_waitcnt lgkmcnt(4)
    ds_read_b64_tr_b16 v[112:113], v4 offset:320
    v_mfma_f32_16x16x32_bf16 v[240:243], v[116:119], v[88:91], v[240:243]
    ds_read_b64_tr_b16 v[114:115], v4 offset:832
    v_mfma_f32_16x16x32_bf16 v[244:247], v[116:119], v[92:95], v[244:247]
    v_mfma_f32_16x16x32_bf16 v[248:251], v[116:119], v[96:99], v[248:251]
    v_mfma_f32_16x16x32_bf16 v[252:255], v[116:119], v[100:103], v[252:255]
    s_waitcnt lgkmcnt(4)
    ds_read_b64_tr_b16 v[116:117], v4 offset:352
    v_mfma_f32_16x16x32_bf16 a[128:131], v[104:107], v[88:91], a[128:131]
    ds_read_b64_tr_b16 v[118:119], v4 offset:864
    v_mfma_f32_16x16x32_bf16 a[132:135], v[104:107], v[92:95], a[132:135]
    v_mfma_f32_16x16x32_bf16 a[136:139], v[104:107], v[96:99], a[136:139]
    v_mfma_f32_16x16x32_bf16 a[140:143], v[104:107], v[100:103], a[140:143]
    s_waitcnt lgkmcnt(4)
    ds_read_b64_tr_b16 v[104:105], v4 offset:384
    v_mfma_f32_16x16x32_bf16 a[144:147], v[108:111], v[88:91], a[144:147]
    ds_read_b64_tr_b16 v[106:107], v4 offset:896
    v_mfma_f32_16x16x32_bf16 a[148:151], v[108:111], v[92:95], a[148:151]
    v_mfma_f32_16x16x32_bf16 a[152:155], v[108:111], v[96:99], a[152:155]
    v_mfma_f32_16x16x32_bf16 a[156:159], v[108:111], v[100:103], a[156:159]
    s_waitcnt lgkmcnt(4)
    ds_read_b64_tr_b16 v[108:109], v4 offset:416
    v_mfma_f32_16x16x32_bf16 a[160:163], v[112:115], v[88:91], a[160:163]
    ds_read_b64_tr_b16 v[110:111], v4 offset:928
    v_mfma_f32_16x16x32_bf16 a[164:167], v[112:115], v[92:95], a[164:167]
    v_mfma_f32_16x16x32_bf16 a[168:171], v[112:115], v[96:99], a[168:171]
    v_mfma_f32_16x16x32_bf16 a[172:175], v[112:115], v[100:103], a[172:175]
    s_waitcnt lgkmcnt(4)
    ds_read_b64_tr_b16 v[112:113], v4 offset:448
    v_mfma_f32_16x16x32_bf16 a[176:179], v[116:119], v[88:91], a[176:179]
    ds_read_b64_tr_b16 v[114:115], v4 offset:960
    v_mfma_f32_16x16x32_bf16 a[180:183], v[116:119], v[92:95], a[180:183]
    v_mfma_f32_16x16x32_bf16 a[184:187], v[116:119], v[96:99], a[184:187]
    v_mfma_f32_16x16x32_bf16 a[188:191], v[116:119], v[100:103], a[188:191]
    s_waitcnt lgkmcnt(4)
    ds_read_b64_tr_b16 v[116:117], v4 offset:480
    v_mfma_f32_16x16x32_bf16 a[192:195], v[104:107], v[88:91], a[192:195]
    ds_read_b64_tr_b16 v[118:119], v4 offset:992
    v_mfma_f32_16x16x32_bf16 a[196:199], v[104:107], v[92:95], a[196:199]
    v_mfma_f32_16x16x32_bf16 a[200:203], v[104:107], v[96:99], a[200:203]
    v_mfma_f32_16x16x32_bf16 a[204:207], v[104:107], v[100:103], a[204:207]
    s_waitcnt lgkmcnt(4)
    v_mfma_f32_16x16x32_bf16 a[208:211], v[108:111], v[88:91], a[208:211]
    v_mfma_f32_16x16x32_bf16 a[212:215], v[108:111], v[92:95], a[212:215]
    v_mfma_f32_16x16x32_bf16 a[216:219], v[108:111], v[96:99], a[216:219]
    v_mfma_f32_16x16x32_bf16 a[220:223], v[108:111], v[100:103], a[220:223]
    s_waitcnt lgkmcnt(2)
    v_mfma_f32_16x16x32_bf16 a[224:227], v[112:115], v[88:91], a[224:227]
    v_mfma_f32_16x16x32_bf16 a[228:231], v[112:115], v[92:95], a[228:231]
    v_mfma_f32_16x16x32_bf16 a[232:235], v[112:115], v[96:99], a[232:235]
    v_mfma_f32_16x16x32_bf16 a[236:239], v[112:115], v[100:103], a[236:239]
    s_waitcnt lgkmcnt(0)
    v_mfma_f32_16x16x32_bf16 a[240:243], v[116:119], v[88:91], a[240:243]
    v_mfma_f32_16x16x32_bf16 a[244:247], v[116:119], v[92:95], a[244:247]
    v_mfma_f32_16x16x32_bf16 a[248:251], v[116:119], v[96:99], a[248:251]
    v_mfma_f32_16x16x32_bf16 a[252:255], v[116:119], v[100:103], a[252:255]
L_tail:
    s_nop 7
    v_mov_b32 v56, v16
    v_mov_b32 v57, v16
    v_mov_b32 v58, v17
    v_mov_b32 v59, v17
    v_mov_b32 v60, v18
    v_mov_b32 v61, v18
    v_mov_b32 v62, v19
    v_mov_b32 v63, v19
    s_nop 1
    v_permlane16_swap_b32 v56, v57
    v_permlane16_swap_b32 v58, v59
    v_permlane16_swap_b32 v60, v61
    v_permlane16_swap_b32 v62, v63
    v_add_f32 v56, v56, v57
    v_add_f32 v58, v58, v59
    v_add_f32 v60, v60, v61
    v_add_f32 v62, v62, v63
    v_mov_b32 v57, v56
    v_mov_b32 v59, v58
    v_mov_b32 v61, v60
    v_mov_b32 v63, v62
    s_nop 1
    v_permlane32_swap_b32 v56, v57
    v_permlane32_swap_b32 v58, v59
    v_permlane32_swap_b32 v60, v61
    v_permlane32_swap_b32 v62, v63
    v_add_f32 v56, v56, v57
    v_add_f32 v58, v58, v59
    v_add_f32 v60, v60, v61
    v_add_f32 v62, v62, v63
    v_rcp_f32 v56, v56
    v_rcp_f32 v58, v58
    v_rcp_f32 v60, v60
    v_rcp_f32 v62, v62
    s_nop 1
    v_accvgpr_read_b32 v64, a128
    v_accvgpr_read_b32 v65, a129
    v_accvgpr_read_b32 v66, a130
    v_accvgpr_read_b32 v67, a131
    v_accvgpr_read_b32 v68, a144
    v_accvgpr_read_b32 v69, a145
    v_accvgpr_read_b32 v70, a146
    v_accvgpr_read_b32 v71, a147
    v_accvgpr_read_b32 v72, a160
    v_accvgpr_read_b32 v73, a161
    v_accvgpr_read_b32 v74, a162
    v_accvgpr_read_b32 v75, a163
    v_accvgpr_read_b32 v76, a176
    v_accvgpr_read_b32 v77, a177
    v_accvgpr_read_b32 v78, a178
    v_accvgpr_read_b32 v79, a179
    v_pk_mul_f32 v[64:65], v[64:65], v[56:57] op_sel_hi:[1,0]
    v_pk_mul_f32 v[66:67], v[66:67], v[56:57] op_sel_hi:[1,0]
    v_pk_mul_f32 v[68:69], v[68:69], v[56:57] op_sel_hi:[1,0]
    v_pk_mul_f32 v[70:71], v[70:71], v[56:57] op_sel_hi:[1,0]
    v_pk_mul_f32 v[72:73], v[72:73], v[56:57] op_sel_hi:[1,0]
    v_pk_mul_f32 v[74:75], v[74:75], v[56:57] op_sel_hi:[1,0]
    v_pk_mul_f32 v[76:77], v[76:77], v[56:57] op_sel_hi:[1,0]
    v_pk_mul_f32 v[78:79], v[78:79], v[56:57] op_sel_hi:[1,0]
    v_cvt_pk_bf16_f32 v80, v64, v65
    v_cvt_pk_bf16_f32 v81, v66, v67
    v_cvt_pk_bf16_f32 v82, v68, v69
    v_cvt_pk_bf16_f32 v83, v70, v71
    v_cvt_pk_bf16_f32 v84, v72, v73
    v_cvt_pk_bf16_f32 v85, v74, v75
    v_cvt_pk_bf16_f32 v86, v76, v77
    v_cvt_pk_bf16_f32 v87, v78, v79
    v_permlane16_swap_b32 v80, v82
    v_permlane16_swap_b32 v81, v83
    v_permlane16_swap_b32 v84, v86
    v_permlane16_swap_b32 v85, v87
    v_accvgpr_read_b32 v64, a132
    v_accvgpr_read_b32 v65, a133
    v_accvgpr_read_b32 v66, a134
    v_accvgpr_read_b32 v67, a135
    v_accvgpr_read_b32 v68, a148
    v_accvgpr_read_b32 v69, a149
    ds_write_b128 v120, v[80:83]
    v_accvgpr_read_b32 v70, a150
    v_accvgpr_read_b32 v71, a151
    v_accvgpr_read_b32 v72, a164
    v_accvgpr_read_b32 v73, a165
    v_accvgpr_read_b32 v74, a166
    v_accvgpr_read_b32 v75, a167
    ds_write_b128 v121, v[84:87]
    v_accvgpr_read_b32 v76, a180
    v_accvgpr_read_b32 v77, a181
    v_accvgpr_read_b32 v78, a182
    v_accvgpr_read_b32 v79, a183
    v_pk_mul_f32 v[64:65], v[64:65], v[58:59] op_sel_hi:[1,0]
    v_pk_mul_f32 v[66:67], v[66:67], v[58:59] op_sel_hi:[1,0]
    v_pk_mul_f32 v[68:69], v[68:69], v[58:59] op_sel_hi:[1,0]
    ds_read_b128 a[128:131], v11
    v_pk_mul_f32 v[70:71], v[70:71], v[58:59] op_sel_hi:[1,0]
    v_pk_mul_f32 v[72:73], v[72:73], v[58:59] op_sel_hi:[1,0]
    v_pk_mul_f32 v[74:75], v[74:75], v[58:59] op_sel_hi:[1,0]
    v_pk_mul_f32 v[76:77], v[76:77], v[58:59] op_sel_hi:[1,0]
    v_pk_mul_f32 v[78:79], v[78:79], v[58:59] op_sel_hi:[1,0]
    v_cvt_pk_bf16_f32 v104, v64, v65
    ds_read_b128 a[144:147], v122
    v_cvt_pk_bf16_f32 v105, v66, v67
    v_cvt_pk_bf16_f32 v106, v68, v69
    v_cvt_pk_bf16_f32 v107, v70, v71
    v_cvt_pk_bf16_f32 v108, v72, v73
    v_cvt_pk_bf16_f32 v109, v74, v75
    v_cvt_pk_bf16_f32 v110, v76, v77
    v_cvt_pk_bf16_f32 v111, v78, v79
    v_permlane16_swap_b32 v104, v106
    v_permlane16_swap_b32 v105, v107
    v_permlane16_swap_b32 v108, v110
    v_permlane16_swap_b32 v109, v111
    v_accvgpr_read_b32 v64, a136
    v_accvgpr_read_b32 v65, a137
    v_accvgpr_read_b32 v66, a138
    v_accvgpr_read_b32 v67, a139
    v_accvgpr_read_b32 v68, a152
    v_accvgpr_read_b32 v69, a153
    ds_write_b128 v120, v[104:107]
    v_accvgpr_read_b32 v70, a154
    v_accvgpr_read_b32 v71, a155
    v_accvgpr_read_b32 v72, a168
    v_accvgpr_read_b32 v73, a169
    v_accvgpr_read_b32 v74, a170
    v_accvgpr_read_b32 v75, a171
    ds_write_b128 v121, v[108:111]
    v_accvgpr_read_b32 v76, a184
    v_accvgpr_read_b32 v77, a185
    v_accvgpr_read_b32 v78, a186
    v_accvgpr_read_b32 v79, a187
    v_pk_mul_f32 v[64:65], v[64:65], v[60:61] op_sel_hi:[1,0]
    v_pk_mul_f32 v[66:67], v[66:67], v[60:61] op_sel_hi:[1,0]
    v_pk_mul_f32 v[68:69], v[68:69], v[60:61] op_sel_hi:[1,0]
    ds_read_b128 a[132:135], v11
    v_pk_mul_f32 v[70:71], v[70:71], v[60:61] op_sel_hi:[1,0]
    v_pk_mul_f32 v[72:73], v[72:73], v[60:61] op_sel_hi:[1,0]
    v_pk_mul_f32 v[74:75], v[74:75], v[60:61] op_sel_hi:[1,0]
    v_pk_mul_f32 v[76:77], v[76:77], v[60:61] op_sel_hi:[1,0]
    v_pk_mul_f32 v[78:79], v[78:79], v[60:61] op_sel_hi:[1,0]
    v_cvt_pk_bf16_f32 v112, v64, v65
    ds_read_b128 a[148:151], v122
    v_cvt_pk_bf16_f32 v113, v66, v67
    v_cvt_pk_bf16_f32 v114, v68, v69
    v_cvt_pk_bf16_f32 v115, v70, v71
    v_cvt_pk_bf16_f32 v116, v72, v73
    v_cvt_pk_bf16_f32 v117, v74, v75
    v_cvt_pk_bf16_f32 v118, v76, v77
    v_cvt_pk_bf16_f32 v119, v78, v79
    s_waitcnt lgkmcnt(5)
    buffer_store_dwordx4 a[128:131], v9, s[16:19], s76 offen offset:256 sc0 sc1
    s_waitcnt lgkmcnt(4)
    buffer_store_dwordx4 a[144:147], v10, s[16:19], s76 offen offset:256 sc0 sc1
    v_permlane16_swap_b32 v112, v114
    v_permlane16_swap_b32 v113, v115
    v_permlane16_swap_b32 v116, v118
    v_permlane16_swap_b32 v117, v119
    v_accvgpr_read_b32 v64, a140
    v_accvgpr_read_b32 v65, a141
    v_accvgpr_read_b32 v66, a142
    v_accvgpr_read_b32 v67, a143
    v_accvgpr_read_b32 v68, a156
    v_accvgpr_read_b32 v69, a157
    ds_write_b128 v120, v[112:115]
    v_accvgpr_read_b32 v70, a158
    v_accvgpr_read_b32 v71, a159
    v_accvgpr_read_b32 v72, a172
    v_accvgpr_read_b32 v73, a173
    v_accvgpr_read_b32 v74, a174
    v_accvgpr_read_b32 v75, a175
    ds_write_b128 v121, v[116:119]
    v_accvgpr_read_b32 v76, a188
    v_accvgpr_read_b32 v77, a189
    v_accvgpr_read_b32 v78, a190
    v_accvgpr_read_b32 v79, a191
    v_pk_mul_f32 v[64:65], v[64:65], v[62:63] op_sel_hi:[1,0]
    v_pk_mul_f32 v[66:67], v[66:67], v[62:63] op_sel_hi:[1,0]
    v_pk_mul_f32 v[68:69], v[68:69], v[62:63] op_sel_hi:[1,0]
    ds_read_b128 a[136:139], v11
    v_pk_mul_f32 v[70:71], v[70:71], v[62:63] op_sel_hi:[1,0]
    v_pk_mul_f32 v[72:73], v[72:73], v[62:63] op_sel_hi:[1,0]
    v_pk_mul_f32 v[74:75], v[74:75], v[62:63] op_sel_hi:[1,0]
    v_pk_mul_f32 v[76:77], v[76:77], v[62:63] op_sel_hi:[1,0]
    v_pk_mul_f32 v[78:79], v[78:79], v[62:63] op_sel_hi:[1,0]
    v_cvt_pk_bf16_f32 v80, v64, v65
    ds_read_b128 a[152:155], v122
    v_cvt_pk_bf16_f32 v81, v66, v67
    v_cvt_pk_bf16_f32 v82, v68, v69
    v_cvt_pk_bf16_f32 v83, v70, v71
    v_cvt_pk_bf16_f32 v84, v72, v73
    v_cvt_pk_bf16_f32 v85, v74, v75
    v_cvt_pk_bf16_f32 v86, v76, v77
    v_cvt_pk_bf16_f32 v87, v78, v79
    s_waitcnt lgkmcnt(5)
    buffer_store_dwordx4 a[132:135], v9, s[16:19], s77 offen offset:256 sc0 sc1
    s_waitcnt lgkmcnt(4)
    buffer_store_dwordx4 a[148:151], v10, s[16:19], s77 offen offset:256 sc0 sc1
    v_permlane16_swap_b32 v80, v82
    v_permlane16_swap_b32 v81, v83
    v_permlane16_swap_b32 v84, v86
    v_permlane16_swap_b32 v85, v87
    v_accvgpr_read_b32 v64, a192
    v_accvgpr_read_b32 v65, a193
    v_accvgpr_read_b32 v66, a194
    v_accvgpr_read_b32 v67, a195
    v_accvgpr_read_b32 v68, a208
    v_accvgpr_read_b32 v69, a209
    ds_write_b128 v120, v[80:83]
    v_accvgpr_read_b32 v70, a210
    v_accvgpr_read_b32 v71, a211
    v_accvgpr_read_b32 v72, a224
    v_accvgpr_read_b32 v73, a225
    v_accvgpr_read_b32 v74, a226
    v_accvgpr_read_b32 v75, a227
    ds_write_b128 v121, v[84:87]
    v_accvgpr_read_b32 v76, a240
    v_accvgpr_read_b32 v77, a241
    v_accvgpr_read_b32 v78, a242
    v_accvgpr_read_b32 v79, a243
    v_pk_mul_f32 v[64:65], v[64:65], v[56:57] op_sel_hi:[1,0]
    v_pk_mul_f32 v[66:67], v[66:67], v[56:57] op_sel_hi:[1,0]
    v_pk_mul_f32 v[68:69], v[68:69], v[56:57] op_sel_hi:[1,0]
    ds_read_b128 a[140:143], v11
    v_pk_mul_f32 v[70:71], v[70:71], v[56:57] op_sel_hi:[1,0]
    v_pk_mul_f32 v[72:73], v[72:73], v[56:57] op_sel_hi:[1,0]
    v_pk_mul_f32 v[74:75], v[74:75], v[56:57] op_sel_hi:[1,0]
    v_pk_mul_f32 v[76:77], v[76:77], v[56:57] op_sel_hi:[1,0]
    v_pk_mul_f32 v[78:79], v[78:79], v[56:57] op_sel_hi:[1,0]
    v_cvt_pk_bf16_f32 v104, v64, v65
    ds_read_b128 a[156:159], v122
    v_cvt_pk_bf16_f32 v105, v66, v67
    v_cvt_pk_bf16_f32 v106, v68, v69
    v_cvt_pk_bf16_f32 v107, v70, v71
    v_cvt_pk_bf16_f32 v108, v72, v73
    v_cvt_pk_bf16_f32 v109, v74, v75
    v_cvt_pk_bf16_f32 v110, v76, v77
    v_cvt_pk_bf16_f32 v111, v78, v79
    s_waitcnt lgkmcnt(5)
    buffer_store_dwordx4 a[136:139], v9, s[16:19], s78 offen offset:256 sc0 sc1
    s_waitcnt lgkmcnt(4)
    buffer_store_dwordx4 a[152:155], v10, s[16:19], s78 offen offset:256 sc0 sc1
    v_permlane16_swap_b32 v104, v106
    v_permlane16_swap_b32 v105, v107
    v_permlane16_swap_b32 v108, v110
    v_permlane16_swap_b32 v109, v111
    v_accvgpr_read_b32 v64, a196
    v_accvgpr_read_b32 v65, a197
    v_accvgpr_read_b32 v66, a198
    v_accvgpr_read_b32 v67, a199
    v_accvgpr_read_b32 v68, a212
    v_accvgpr_read_b32 v69, a213
    ds_write_b128 v120, v[104:107]
    v_accvgpr_read_b32 v70, a214
    v_accvgpr_read_b32 v71, a215
    v_accvgpr_read_b32 v72, a228
    v_accvgpr_read_b32 v73, a229
    v_accvgpr_read_b32 v74, a230
    v_accvgpr_read_b32 v75, a231
    ds_write_b128 v121, v[108:111]
    v_accvgpr_read_b32 v76, a244
    v_accvgpr_read_b32 v77, a245
    v_accvgpr_read_b32 v78, a246
    v_accvgpr_read_b32 v79, a247
    v_pk_mul_f32 v[64:65], v[64:65], v[58:59] op_sel_hi:[1,0]
    v_pk_mul_f32 v[66:67], v[66:67], v[58:59] op_sel_hi:[1,0]
    v_pk_mul_f32 v[68:69], v[68:69], v[58:59] op_sel_hi:[1,0]
    ds_read_b128 a[160:163], v11
    v_pk_mul_f32 v[70:71], v[70:71], v[58:59] op_sel_hi:[1,0]
    v_pk_mul_f32 v[72:73], v[72:73], v[58:59] op_sel_hi:[1,0]
    v_pk_mul_f32 v[74:75], v[74:75], v[58:59] op_sel_hi:[1,0]
    v_pk_mul_f32 v[76:77], v[76:77], v[58:59] op_sel_hi:[1,0]
    v_pk_mul_f32 v[78:79], v[78:79], v[58:59] op_sel_hi:[1,0]
    v_cvt_pk_bf16_f32 v112, v64, v65
    ds_read_b128 a[176:179], v122
    v_cvt_pk_bf16_f32 v113, v66, v67
    v_cvt_pk_bf16_f32 v114, v68, v69
    v_cvt_pk_bf16_f32 v115, v70, v71
    v_cvt_pk_bf16_f32 v116, v72, v73
    v_cvt_pk_bf16_f32 v117, v74, v75
    v_cvt_pk_bf16_f32 v118, v76, v77
    v_cvt_pk_bf16_f32 v119, v78, v79
    s_waitcnt lgkmcnt(5)
    buffer_store_dwordx4 a[140:143], v9, s[16:19], s79 offen offset:256 sc0 sc1
    s_waitcnt lgkmcnt(4)
    buffer_store_dwordx4 a[156:159], v10, s[16:19], s79 offen offset:256 sc0 sc1
    v_permlane16_swap_b32 v112, v114
    v_permlane16_swap_b32 v113, v115
    v_permlane16_swap_b32 v116, v118
    v_permlane16_swap_b32 v117, v119
    v_accvgpr_read_b32 v64, a200
    v_accvgpr_read_b32 v65, a201
    v_accvgpr_read_b32 v66, a202
    v_accvgpr_read_b32 v67, a203
    v_accvgpr_read_b32 v68, a216
    v_accvgpr_read_b32 v69, a217
    ds_write_b128 v120, v[112:115]
    v_accvgpr_read_b32 v70, a218
    v_accvgpr_read_b32 v71, a219
    v_accvgpr_read_b32 v72, a232
    v_accvgpr_read_b32 v73, a233
    v_accvgpr_read_b32 v74, a234
    v_accvgpr_read_b32 v75, a235
    ds_write_b128 v121, v[116:119]
    v_accvgpr_read_b32 v76, a248
    v_accvgpr_read_b32 v77, a249
    v_accvgpr_read_b32 v78, a250
    v_accvgpr_read_b32 v79, a251
    v_pk_mul_f32 v[64:65], v[64:65], v[60:61] op_sel_hi:[1,0]
    v_pk_mul_f32 v[66:67], v[66:67], v[60:61] op_sel_hi:[1,0]
    v_pk_mul_f32 v[68:69], v[68:69], v[60:61] op_sel_hi:[1,0]
    ds_read_b128 a[164:167], v11
    v_pk_mul_f32 v[70:71], v[70:71], v[60:61] op_sel_hi:[1,0]
    v_pk_mul_f32 v[72:73], v[72:73], v[60:61] op_sel_hi:[1,0]
    v_pk_mul_f32 v[74:75], v[74:75], v[60:61] op_sel_hi:[1,0]
    v_pk_mul_f32 v[76:77], v[76:77], v[60:61] op_sel_hi:[1,0]
    v_pk_mul_f32 v[78:79], v[78:79], v[60:61] op_sel_hi:[1,0]
    v_cvt_pk_bf16_f32 v80, v64, v65
    ds_read_b128 a[180:183], v122
    v_cvt_pk_bf16_f32 v81, v66, v67
    v_cvt_pk_bf16_f32 v82, v68, v69
    v_cvt_pk_bf16_f32 v83, v70, v71
    v_cvt_pk_bf16_f32 v84, v72, v73
    v_cvt_pk_bf16_f32 v85, v74, v75
    v_cvt_pk_bf16_f32 v86, v76, v77
    v_cvt_pk_bf16_f32 v87, v78, v79
    s_waitcnt lgkmcnt(5)
    buffer_store_dwordx4 a[160:163], v9, s[16:19], s76 offen offset:384 sc0 sc1
    s_waitcnt lgkmcnt(4)
    buffer_store_dwordx4 a[176:179], v10, s[16:19], s76 offen offset:384 sc0 sc1
    v_permlane16_swap_b32 v80, v82
    v_permlane16_swap_b32 v81, v83
    v_permlane16_swap_b32 v84, v86
    v_permlane16_swap_b32 v85, v87
    v_accvgpr_read_b32 v64, a204
    v_accvgpr_read_b32 v65, a205
    v_accvgpr_read_b32 v66, a206
    v_accvgpr_read_b32 v67, a207
    v_accvgpr_read_b32 v68, a220
    v_accvgpr_read_b32 v69, a221
    ds_write_b128 v120, v[80:83]
    v_accvgpr_read_b32 v70, a222
    v_accvgpr_read_b32 v71, a223
    v_accvgpr_read_b32 v72, a236
    v_accvgpr_read_b32 v73, a237
    v_accvgpr_read_b32 v74, a238
    v_accvgpr_read_b32 v75, a239
    ds_write_b128 v121, v[84:87]
    v_accvgpr_read_b32 v76, a252
    v_accvgpr_read_b32 v77, a253
    v_accvgpr_read_b32 v78, a254
    v_accvgpr_read_b32 v79, a255
    v_pk_mul_f32 v[64:65], v[64:65], v[62:63] op_sel_hi:[1,0]
    v_pk_mul_f32 v[66:67], v[66:67], v[62:63] op_sel_hi:[1,0]
    v_pk_mul_f32 v[68:69], v[68:69], v[62:63] op_sel_hi:[1,0]
    ds_read_b128 a[168:171], v11
    v_pk_mul_f32 v[70:71], v[70:71], v[62:63] op_sel_hi:[1,0]
    v_pk_mul_f32 v[72:73], v[72:73], v[62:63] op_sel_hi:[1,0]
    v_pk_mul_f32 v[74:75], v[74:75], v[62:63] op_sel_hi:[1,0]
    v_pk_mul_f32 v[76:77], v[76:77], v[62:63] op_sel_hi:[1,0]
    v_pk_mul_f32 v[78:79], v[78:79], v[62:63] op_sel_hi:[1,0]
    v_cvt_pk_bf16_f32 v104, v64, v65
    ds_read_b128 a[184:187], v122
    v_cvt_pk_bf16_f32 v105, v66, v67
    v_cvt_pk_bf16_f32 v106, v68, v69
    v_cvt_pk_bf16_f32 v107, v70, v71
    v_cvt_pk_bf16_f32 v108, v72, v73
    v_cvt_pk_bf16_f32 v109, v74, v75
    v_cvt_pk_bf16_f32 v110, v76, v77
    v_cvt_pk_bf16_f32 v111, v78, v79
    s_waitcnt lgkmcnt(5)
    buffer_store_dwordx4 a[164:167], v9, s[16:19], s77 offen offset:384 sc0 sc1
    s_waitcnt lgkmcnt(4)
    buffer_store_dwordx4 a[180:183], v10, s[16:19], s77 offen offset:384 sc0 sc1
    v_permlane16_swap_b32 v104, v106
    v_permlane16_swap_b32 v105, v107
    v_permlane16_swap_b32 v108, v110
    v_permlane16_swap_b32 v109, v111
    v_pk_mul_f32 v[128:129], v[128:129], v[56:57] op_sel_hi:[1,0]
    v_pk_mul_f32 v[130:131], v[130:131], v[56:57] op_sel_hi:[1,0]
    v_pk_mul_f32 v[144:145], v[144:145], v[56:57] op_sel_hi:[1,0]
    ds_write_b128 v120, v[104:107]
    v_pk_mul_f32 v[146:147], v[146:147], v[56:57] op_sel_hi:[1,0]
    v_pk_mul_f32 v[160:161], v[160:161], v[56:57] op_sel_hi:[1,0]
    v_pk_mul_f32 v[162:163], v[162:163], v[56:57] op_sel_hi:[1,0]
    ds_write_b128 v121, v[108:111]
    v_pk_mul_f32 v[176:177], v[176:177], v[56:57] op_sel_hi:[1,0]
    v_pk_mul_f32 v[178:179], v[178:179], v[56:57] op_sel_hi:[1,0]
    v_cvt_pk_bf16_f32 v112, v128, v129
    ds_read_b128 a[172:175], v11
    v_cvt_pk_bf16_f32 v113, v130, v131
    v_cvt_pk_bf16_f32 v114, v144, v145
    v_cvt_pk_bf16_f32 v115, v146, v147
    ds_read_b128 a[188:191], v122
    v_cvt_pk_bf16_f32 v116, v160, v161
    v_cvt_pk_bf16_f32 v117, v162, v163
    v_cvt_pk_bf16_f32 v118, v176, v177
    v_cvt_pk_bf16_f32 v119, v178, v179
    s_waitcnt lgkmcnt(5)
    buffer_store_dwordx4 a[168:171], v9, s[16:19], s78 offen offset:384 sc0 sc1
    s_waitcnt lgkmcnt(4)
    buffer_store_dwordx4 a[184:187], v10, s[16:19], s78 offen offset:384 sc0 sc1
    v_permlane16_swap_b32 v112, v114
    v_permlane16_swap_b32 v113, v115
    v_permlane16_swap_b32 v116, v118
    v_permlane16_swap_b32 v117, v119
    v_pk_mul_f32 v[132:133], v[132:133], v[58:59] op_sel_hi:[1,0]
    v_pk_mul_f32 v[134:135], v[134:135], v[58:59] op_sel_hi:[1,0]
    v_pk_mul_f32 v[148:149], v[148:149], v[58:59] op_sel_hi:[1,0]
    ds_write_b128 v120, v[112:115]
    v_pk_mul_f32 v[150:151], v[150:151], v[58:59] op_sel_hi:[1,0]
    v_pk_mul_f32 v[164:165], v[164:165], v[58:59] op_sel_hi:[1,0]
    v_pk_mul_f32 v[166:167], v[166:167], v[58:59] op_sel_hi:[1,0]
    ds_write_b128 v121, v[116:119]
    v_pk_mul_f32 v[180:181], v[180:181], v[58:59] op_sel_hi:[1,0]
    v_pk_mul_f32 v[182:183], v[182:183], v[58:59] op_sel_hi:[1,0]
    v_cvt_pk_bf16_f32 v80, v132, v133
    ds_read_b128 a[192:195], v11
    v_cvt_pk_bf16_f32 v81, v134, v135
    v_cvt_pk_bf16_f32 v82, v148, v149
    v_cvt_pk_bf16_f32 v83, v150, v151
    ds_read_b128 a[208:211], v122
    v_cvt_pk_bf16_f32 v84, v164, v165
    v_cvt_pk_bf16_f32 v85, v166, v167
    v_cvt_pk_bf16_f32 v86, v180, v181
    v_cvt_pk_bf16_f32 v87, v182, v183
    s_waitcnt lgkmcnt(5)
    buffer_store_dwordx4 a[172:175], v9, s[16:19], s79 offen offset:384 sc0 sc1
    s_waitcnt lgkmcnt(4)
    buffer_store_dwordx4 a[188:191], v10, s[16:19], s79 offen offset:384 sc0 sc1
    v_permlane16_swap_b32 v80, v82
    v_permlane16_swap_b32 v81, v83
    v_permlane16_swap_b32 v84, v86
    v_permlane16_swap_b32 v85, v87
    v_pk_mul_f32 v[136:137], v[136:137], v[60:61] op_sel_hi:[1,0]
    v_pk_mul_f32 v[138:139], v[138:139], v[60:61] op_sel_hi:[1,0]
    v_pk_mul_f32 v[152:153], v[152:153], v[60:61] op_sel_hi:[1,0]
    ds_write_b128 v120, v[80:83]
    v_pk_mul_f32 v[154:155], v[154:155], v[60:61] op_sel_hi:[1,0]
    v_pk_mul_f32 v[168:169], v[168:169], v[60:61] op_sel_hi:[1,0]
    v_pk_mul_f32 v[170:171], v[170:171], v[60:61] op_sel_hi:[1,0]
    ds_write_b128 v121, v[84:87]
    v_pk_mul_f32 v[184:185], v[184:185], v[60:61] op_sel_hi:[1,0]
    v_pk_mul_f32 v[186:187], v[186:187], v[60:61] op_sel_hi:[1,0]
    v_cvt_pk_bf16_f32 v104, v136, v137
    ds_read_b128 a[196:199], v11
    v_cvt_pk_bf16_f32 v105, v138, v139
    v_cvt_pk_bf16_f32 v106, v152, v153
    v_cvt_pk_bf16_f32 v107, v154, v155
    ds_read_b128 a[212:215], v122
    v_cvt_pk_bf16_f32 v108, v168, v169
    v_cvt_pk_bf16_f32 v109, v170, v171
    v_cvt_pk_bf16_f32 v110, v184, v185
    v_cvt_pk_bf16_f32 v111, v186, v187
    s_waitcnt lgkmcnt(5)
    buffer_store_dwordx4 a[192:195], v9, s[16:19], s76 offen offset:0 sc0 sc1
    s_waitcnt lgkmcnt(4)
    buffer_store_dwordx4 a[208:211], v10, s[16:19], s76 offen offset:0 sc0 sc1
    v_permlane16_swap_b32 v104, v106
    v_permlane16_swap_b32 v105, v107
    v_permlane16_swap_b32 v108, v110
    v_permlane16_swap_b32 v109, v111
    v_pk_mul_f32 v[140:141], v[140:141], v[62:63] op_sel_hi:[1,0]
    v_pk_mul_f32 v[142:143], v[142:143], v[62:63] op_sel_hi:[1,0]
    v_pk_mul_f32 v[156:157], v[156:157], v[62:63] op_sel_hi:[1,0]
    ds_write_b128 v120, v[104:107]
    v_pk_mul_f32 v[158:159], v[158:159], v[62:63] op_sel_hi:[1,0]
    v_pk_mul_f32 v[172:173], v[172:173], v[62:63] op_sel_hi:[1,0]
    v_pk_mul_f32 v[174:175], v[174:175], v[62:63] op_sel_hi:[1,0]
    ds_write_b128 v121, v[108:111]
    v_pk_mul_f32 v[188:189], v[188:189], v[62:63] op_sel_hi:[1,0]
    v_pk_mul_f32 v[190:191], v[190:191], v[62:63] op_sel_hi:[1,0]
    v_cvt_pk_bf16_f32 v112, v140, v141
    ds_read_b128 a[200:203], v11
    v_cvt_pk_bf16_f32 v113, v142, v143
    v_cvt_pk_bf16_f32 v114, v156, v157
    v_cvt_pk_bf16_f32 v115, v158, v159
    ds_read_b128 a[216:219], v122
    v_cvt_pk_bf16_f32 v116, v172, v173
    v_cvt_pk_bf16_f32 v117, v174, v175
    v_cvt_pk_bf16_f32 v118, v188, v189
    v_cvt_pk_bf16_f32 v119, v190, v191
    s_waitcnt lgkmcnt(5)
    buffer_store_dwordx4 a[196:199], v9, s[16:19], s77 offen offset:0 sc0 sc1
    s_waitcnt lgkmcnt(4)
    buffer_store_dwordx4 a[212:215], v10, s[16:19], s77 offen offset:0 sc0 sc1
    v_permlane16_swap_b32 v112, v114
    v_permlane16_swap_b32 v113, v115
    v_permlane16_swap_b32 v116, v118
    v_permlane16_swap_b32 v117, v119
    v_pk_mul_f32 v[192:193], v[192:193], v[56:57] op_sel_hi:[1,0]
    v_pk_mul_f32 v[194:195], v[194:195], v[56:57] op_sel_hi:[1,0]
    v_pk_mul_f32 v[208:209], v[208:209], v[56:57] op_sel_hi:[1,0]
    ds_write_b128 v120, v[112:115]
    v_pk_mul_f32 v[210:211], v[210:211], v[56:57] op_sel_hi:[1,0]
    v_pk_mul_f32 v[224:225], v[224:225], v[56:57] op_sel_hi:[1,0]
    v_pk_mul_f32 v[226:227], v[226:227], v[56:57] op_sel_hi:[1,0]
    ds_write_b128 v121, v[116:119]
    v_pk_mul_f32 v[240:241], v[240:241], v[56:57] op_sel_hi:[1,0]
    v_pk_mul_f32 v[242:243], v[242:243], v[56:57] op_sel_hi:[1,0]
    v_cvt_pk_bf16_f32 v80, v192, v193
    ds_read_b128 a[204:207], v11
    v_cvt_pk_bf16_f32 v81, v194, v195
    v_cvt_pk_bf16_f32 v82, v208, v209
    v_cvt_pk_bf16_f32 v83, v210, v211
    ds_read_b128 a[220:223], v122
    v_cvt_pk_bf16_f32 v84, v224, v225
    v_cvt_pk_bf16_f32 v85, v226, v227
    v_cvt_pk_bf16_f32 v86, v240, v241
    v_cvt_pk_bf16_f32 v87, v242, v243
    s_waitcnt lgkmcnt(5)
    buffer_store_dwordx4 a[200:203], v9, s[16:19], s78 offen offset:0 sc0 sc1
    s_waitcnt lgkmcnt(4)
    buffer_store_dwordx4 a[216:219], v10, s[16:19], s78 offen offset:0 sc0 sc1
    v_permlane16_swap_b32 v80, v82
    v_permlane16_swap_b32 v81, v83
    v_permlane16_swap_b32 v84, v86
    v_permlane16_swap_b32 v85, v87
    v_pk_mul_f32 v[196:197], v[196:197], v[58:59] op_sel_hi:[1,0]
    v_pk_mul_f32 v[198:199], v[198:199], v[58:59] op_sel_hi:[1,0]
    v_pk_mul_f32 v[212:213], v[212:213], v[58:59] op_sel_hi:[1,0]
    ds_write_b128 v120, v[80:83]
    v_pk_mul_f32 v[214:215], v[214:215], v[58:59] op_sel_hi:[1,0]
    v_pk_mul_f32 v[228:229], v[228:229], v[58:59] op_sel_hi:[1,0]
    v_pk_mul_f32 v[230:231], v[230:231], v[58:59] op_sel_hi:[1,0]
    ds_write_b128 v121, v[84:87]
    v_pk_mul_f32 v[244:245], v[244:245], v[58:59] op_sel_hi:[1,0]
    v_pk_mul_f32 v[246:247], v[246:247], v[58:59] op_sel_hi:[1,0]
    v_cvt_pk_bf16_f32 v104, v196, v197
    ds_read_b128 a[224:227], v11
    v_cvt_pk_bf16_f32 v105, v198, v199
    v_cvt_pk_bf16_f32 v106, v212, v213
    v_cvt_pk_bf16_f32 v107, v214, v215
    ds_read_b128 a[240:243], v122
    v_cvt_pk_bf16_f32 v108, v228, v229
    v_cvt_pk_bf16_f32 v109, v230, v231
    v_cvt_pk_bf16_f32 v110, v244, v245
    v_cvt_pk_bf16_f32 v111, v246, v247
    s_waitcnt lgkmcnt(5)
    buffer_store_dwordx4 a[204:207], v9, s[16:19], s79 offen offset:0 sc0 sc1
    s_waitcnt lgkmcnt(4)
    buffer_store_dwordx4 a[220:223], v10, s[16:19], s79 offen offset:0 sc0 sc1
    v_permlane16_swap_b32 v104, v106
    v_permlane16_swap_b32 v105, v107
    v_permlane16_swap_b32 v108, v110
    v_permlane16_swap_b32 v109, v111
    v_pk_mul_f32 v[200:201], v[200:201], v[60:61] op_sel_hi:[1,0]
    v_pk_mul_f32 v[202:203], v[202:203], v[60:61] op_sel_hi:[1,0]
    v_pk_mul_f32 v[216:217], v[216:217], v[60:61] op_sel_hi:[1,0]
    ds_write_b128 v120, v[104:107]
    v_pk_mul_f32 v[218:219], v[218:219], v[60:61] op_sel_hi:[1,0]
    v_pk_mul_f32 v[232:233], v[232:233], v[60:61] op_sel_hi:[1,0]
    v_pk_mul_f32 v[234:235], v[234:235], v[60:61] op_sel_hi:[1,0]
    ds_write_b128 v121, v[108:111]
    v_pk_mul_f32 v[248:249], v[248:249], v[60:61] op_sel_hi:[1,0]
    v_pk_mul_f32 v[250:251], v[250:251], v[60:61] op_sel_hi:[1,0]
    v_cvt_pk_bf16_f32 v112, v200, v201
    ds_read_b128 a[228:231], v11
    v_cvt_pk_bf16_f32 v113, v202, v203
    v_cvt_pk_bf16_f32 v114, v216, v217
    v_cvt_pk_bf16_f32 v115, v218, v219
    ds_read_b128 a[244:247], v122
    v_cvt_pk_bf16_f32 v116, v232, v233
    v_cvt_pk_bf16_f32 v117, v234, v235
    v_cvt_pk_bf16_f32 v118, v248, v249
    v_cvt_pk_bf16_f32 v119, v250, v251
    s_waitcnt lgkmcnt(5)
    buffer_store_dwordx4 a[224:227], v9, s[16:19], s76 offen offset:128 sc0 sc1
    s_waitcnt lgkmcnt(4)
    buffer_store_dwordx4 a[240:243], v10, s[16:19], s76 offen offset:128 sc0 sc1
    v_permlane16_swap_b32 v112, v114
    v_permlane16_swap_b32 v113, v115
    v_permlane16_swap_b32 v116, v118
    v_permlane16_swap_b32 v117, v119
    v_pk_mul_f32 v[204:205], v[204:205], v[62:63] op_sel_hi:[1,0]
    v_pk_mul_f32 v[206:207], v[206:207], v[62:63] op_sel_hi:[1,0]
    v_pk_mul_f32 v[220:221], v[220:221], v[62:63] op_sel_hi:[1,0]
    ds_write_b128 v120, v[112:115]
    v_pk_mul_f32 v[222:223], v[222:223], v[62:63] op_sel_hi:[1,0]
    v_pk_mul_f32 v[236:237], v[236:237], v[62:63] op_sel_hi:[1,0]
    v_pk_mul_f32 v[238:239], v[238:239], v[62:63] op_sel_hi:[1,0]
    ds_write_b128 v121, v[116:119]
    v_pk_mul_f32 v[252:253], v[252:253], v[62:63] op_sel_hi:[1,0]
    v_pk_mul_f32 v[254:255], v[254:255], v[62:63] op_sel_hi:[1,0]
    v_cvt_pk_bf16_f32 v80, v204, v205
    ds_read_b128 a[232:235], v11
    v_cvt_pk_bf16_f32 v81, v206, v207
    v_cvt_pk_bf16_f32 v82, v220, v221
    v_cvt_pk_bf16_f32 v83, v222, v223
    ds_read_b128 a[248:251], v122
    v_cvt_pk_bf16_f32 v84, v236, v237
    v_cvt_pk_bf16_f32 v85, v238, v239
    v_cvt_pk_bf16_f32 v86, v252, v253
    v_cvt_pk_bf16_f32 v87, v254, v255
    s_waitcnt lgkmcnt(5)
    buffer_store_dwordx4 a[228:231], v9, s[16:19], s77 offen offset:128 sc0 sc1
    s_waitcnt lgkmcnt(4)
    buffer_store_dwordx4 a[244:247], v10, s[16:19], s77 offen offset:128 sc0 sc1
    v_permlane16_swap_b32 v80, v82
    v_permlane16_swap_b32 v81, v83
    v_permlane16_swap_b32 v84, v86
    v_permlane16_swap_b32 v85, v87
    ds_write_b128 v120, v[80:83]
    ds_write_b128 v121, v[84:87]
    ds_read_b128 a[236:239], v11
    ds_read_b128 a[252:255], v122
    s_waitcnt lgkmcnt(5)
    buffer_store_dwordx4 a[232:235], v9, s[16:19], s78 offen offset:128 sc0 sc1
    s_waitcnt lgkmcnt(4)
    buffer_store_dwordx4 a[248:251], v10, s[16:19], s78 offen offset:128 sc0 sc1
    s_waitcnt lgkmcnt(1)
    buffer_store_dwordx4 a[236:239], v9, s[16:19], s79 offen offset:128 sc0 sc1
    s_waitcnt lgkmcnt(0)
    buffer_store_dwordx4 a[252:255], v10, s[16:19], s79 offen offset:128 sc0 sc1
    s_waitcnt vmcnt(0)
L_exit:
    s_endpgm
L_rare_s0a:
    s_call_b64 s[36:37], L_rarefn_1
    s_branch L_cont_s0a
L_rare_s11:
    s_call_b64 s[36:37], L_rarefn_0
    s_branch L_cont_s11
L_rare_s12:
    s_call_b64 s[36:37], L_rarefn_1
    s_branch L_cont_s12
L_rare_s13:
    s_call_b64 s[36:37], L_rarefn_0
    s_branch L_cont_s13
L_rare_s14:
    s_call_b64 s[36:37], L_rarefn_1
    s_branch L_cont_s14
L_rare_s0b:
    s_call_b64 s[36:37], L_rarefn_1
    s_branch L_cont_s0b
L_rare_s1c:
    s_call_b64 s[36:37], L_rarefn_0
    s_branch L_cont_s1c
L_rare_s2c:
    s_call_b64 s[36:37], L_rarefn_1
    s_branch L_cont_s2c
L_rare_s3c:
    s_call_b64 s[36:37], L_rarefn_0
    s_branch L_cont_s3c
L_rare_s4c:
    s_call_b64 s[36:37], L_rarefn_1
    s_branch L_cont_s4c
L_rare_s11c:
    s_call_b64 s[36:37], L_rarefn_0
    s_branch L_cont_s11c
L_rare_s12c:
    s_call_b64 s[36:37], L_rarefn_1
    s_branch L_cont_s12c
L_rare_s13c:
    s_call_b64 s[36:37], L_rarefn_0
    s_branch L_cont_s13c
L_rare_s14c:
    s_call_b64 s[36:37], L_rarefn_1
    s_branch L_cont_s14c
L_rarefn_0:
    s_nop 15
    v_max3_f32 v88, v24, v25, v26
    v_max3_f32 v88, v88, v27, v28
    v_max3_f32 v88, v88, v29, v30
    v_max_f32 v88, v88, v31
    v_mov_b32 v89, v88
    v_max3_f32 v90, v32, v33, v34
    v_max3_f32 v90, v90, v35, v36
    v_max3_f32 v90, v90, v37, v38
    v_max_f32 v90, v90, v39
    v_mov_b32 v91, v90
    v_max3_f32 v92, v40, v41, v42
    v_max3_f32 v92, v92, v43, v44
    v_max3_f32 v92, v92, v45, v46
    v_max_f32 v92, v92, v47
    v_mov_b32 v93, v92
    v_max3_f32 v94, v48, v49, v50
    v_max3_f32 v94, v94, v51, v52
    v_max3_f32 v94, v94, v53, v54
    v_max_f32 v94, v94, v55
    v_mov_b32 v95, v94
    s_nop 1
    v_permlane16_swap_b32 v88, v89
    v_permlane16_swap_b32 v90, v91
    v_permlane16_swap_b32 v92, v93
    v_permlane16_swap_b32 v94, v95
    v_max_f32 v88, v88, v89
    v_max_f32 v90, v90, v91
    v_max_f32 v92, v92, v93
    v_max_f32 v94, v94, v95
    v_mov_b32 v89, v88
    v_mov_b32 v91, v90
    v_mov_b32 v93, v92
    v_mov_b32 v95, v94
    s_nop 1
    v_permlane32_swap_b32 v88, v89
    v_permlane32_swap_b32 v90, v91
    v_permlane32_swap_b32 v92, v93
    v_permlane32_swap_b32 v94, v95
    v_max_f32 v88, v88, v89
    v_max_f32 v90, v90, v91
    v_max_f32 v92, v92, v93
    v_max_f32 v94, v94, v95
    v_max_f32 v88, 0, v88
    v_sub_f32 v12, v12, v88
    v_sub_f32 v89, 0, v88
    v_exp_f32 v89, v89
    v_sub_f32 v24, v24, v88
    v_sub_f32 v25, v25, v88
    v_sub_f32 v26, v26, v88
    v_sub_f32 v27, v27, v88
    v_sub_f32 v28, v28, v88
    v_sub_f32 v29, v29, v88
    v_sub_f32 v30, v30, v88
    v_sub_f32 v31, v31, v88
    v_mul_f32 v16, v16, v89
    v_max_f32 v90, 0, v90
    v_sub_f32 v13, v13, v90
    v_sub_f32 v91, 0, v90
    v_exp_f32 v91, v91
    v_sub_f32 v32, v32, v90
    v_sub_f32 v33, v33, v90
    v_sub_f32 v34, v34, v90
    v_sub_f32 v35, v35, v90
    v_sub_f32 v36, v36, v90
    v_sub_f32 v37, v37, v90
    v_sub_f32 v38, v38, v90
    v_sub_f32 v39, v39, v90
    v_mul_f32 v17, v17, v91
    v_max_f32 v92, 0, v92
    v_sub_f32 v14, v14, v92
    v_sub_f32 v93, 0, v92
    v_exp_f32 v93, v93
    v_sub_f32 v40, v40, v92
    v_sub_f32 v41, v41, v92
    v_sub_f32 v42, v42, v92
    v_sub_f32 v43, v43, v92
    v_sub_f32 v44, v44, v92
    v_sub_f32 v45, v45, v92
    v_sub_f32 v46, v46, v92
    v_sub_f32 v47, v47, v92
    v_mul_f32 v18, v18, v93
    v_max_f32 v94, 0, v94
    v_sub_f32 v15, v15, v94
    v_sub_f32 v95, 0, v94
    v_exp_f32 v95, v95
    v_sub_f32 v48, v48, v94
    v_sub_f32 v49, v49, v94
    v_sub_f32 v50, v50, v94
    v_sub_f32 v51, v51, v94
    v_sub_f32 v52, v52, v94
    v_sub_f32 v53, v53, v94
    v_sub_f32 v54, v54, v94
    v_sub_f32 v55, v55, v94
    v_mul_f32 v19, v19, v95
    s_branch L_rescale
L_rarefn_1:
    s_nop 15
    v_max3_f32 v88, v56, v57, v58
    v_max3_f32 v88, v88, v59, v60
    v_max3_f32 v88, v88, v61, v62
    v_max_f32 v88, v88, v63
    v_mov_b32 v89, v88
    v_max3_f32 v90, v64, v65, v66
    v_max3_f32 v90, v90, v67, v68
    v_max3_f32 v90, v90, v69, v70
    v_max_f32 v90, v90, v71
    v_mov_b32 v91, v90
    v_max3_f32 v92, v72, v73, v74
    v_max3_f32 v92, v92, v75, v76
    v_max3_f32 v92, v92, v77, v78
    v_max_f32 v92, v92, v79
    v_mov_b32 v93, v92
    v_max3_f32 v94, v80, v81, v82
    v_max3_f32 v94, v94, v83, v84
    v_max3_f32 v94, v94, v85, v86
    v_max_f32 v94, v94, v87
    v_mov_b32 v95, v94
    s_nop 1
    v_permlane16_swap_b32 v88, v89
    v_permlane16_swap_b32 v90, v91
    v_permlane16_swap_b32 v92, v93
    v_permlane16_swap_b32 v94, v95
    v_max_f32 v88, v88, v89
    v_max_f32 v90, v90, v91
    v_max_f32 v92, v92, v93
    v_max_f32 v94, v94, v95
    v_mov_b32 v89, v88
    v_mov_b32 v91, v90
    v_mov_b32 v93, v92
    v_mov_b32 v95, v94
    s_nop 1
    v_permlane32_swap_b32 v88, v89
    v_permlane32_swap_b32 v90, v91
    v_permlane32_swap_b32 v92, v93
    v_permlane32_swap_b32 v94, v95
    v_max_f32 v88, v88, v89
    v_max_f32 v90, v90, v91
    v_max_f32 v92, v92, v93
    v_max_f32 v94, v94, v95
    v_max_f32 v88, 0, v88
    v_sub_f32 v12, v12, v88
    v_sub_f32 v89, 0, v88
    v_exp_f32 v89, v89
    v_sub_f32 v56, v56, v88
    v_sub_f32 v57, v57, v88
    v_sub_f32 v58, v58, v88
    v_sub_f32 v59, v59, v88
    v_sub_f32 v60, v60, v88
    v_sub_f32 v61, v61, v88
    v_sub_f32 v62, v62, v88
    v_sub_f32 v63, v63, v88
    v_mul_f32 v16, v16, v89
    v_max_f32 v90, 0, v90
    v_sub_f32 v13, v13, v90
    v_sub_f32 v91, 0, v90
    v_exp_f32 v91, v91
    v_sub_f32 v64, v64, v90
    v_sub_f32 v65, v65, v90
    v_sub_f32 v66, v66, v90
    v_sub_f32 v67, v67, v90
    v_sub_f32 v68, v68, v90
    v_sub_f32 v69, v69, v90
    v_sub_f32 v70, v70, v90
    v_sub_f32 v71, v71, v90
    v_mul_f32 v17, v17, v91
    v_max_f32 v92, 0, v92
    v_sub_f32 v14, v14, v92
    v_sub_f32 v93, 0, v92
    v_exp_f32 v93, v93
    v_sub_f32 v72, v72, v92
    v_sub_f32 v73, v73, v92
    v_sub_f32 v74, v74, v92
    v_sub_f32 v75, v75, v92
    v_sub_f32 v76, v76, v92
    v_sub_f32 v77, v77, v92
    v_sub_f32 v78, v78, v92
    v_sub_f32 v79, v79, v92
    v_mul_f32 v18, v18, v93
    v_max_f32 v94, 0, v94
    v_sub_f32 v15, v15, v94
    v_sub_f32 v95, 0, v94
    v_exp_f32 v95, v95
    v_sub_f32 v80, v80, v94
    v_sub_f32 v81, v81, v94
    v_sub_f32 v82, v82, v94
    v_sub_f32 v83, v83, v94
    v_sub_f32 v84, v84, v94
    v_sub_f32 v85, v85, v94
    v_sub_f32 v86, v86, v94
    v_sub_f32 v87, v87, v94
    v_mul_f32 v19, v19, v95
    s_branch L_rescale
L_rescale:
    v_mul_f32 v128, v128, v89
    v_mul_f32 v129, v129, v89
    v_mul_f32 v130, v130, v89
    v_mul_f32 v131, v131, v89
    v_mul_f32 v132, v132, v91
    v_mul_f32 v133, v133, v91
    v_mul_f32 v134, v134, v91
    v_mul_f32 v135, v135, v91
    v_mul_f32 v136, v136, v93
    v_mul_f32 v137, v137, v93
    v_mul_f32 v138, v138, v93
    v_mul_f32 v139, v139, v93
    v_mul_f32 v140, v140, v95
    v_mul_f32 v141, v141, v95
    v_mul_f32 v142, v142, v95
    v_mul_f32 v143, v143, v95
    v_mul_f32 v144, v144, v89
    v_mul_f32 v145, v145, v89
    v_mul_f32 v146, v146, v89
    v_mul_f32 v147, v147, v89
    v_mul_f32 v148, v148, v91
    v_mul_f32 v149, v149, v91
    v_mul_f32 v150, v150, v91
    v_mul_f32 v151, v151, v91
    v_mul_f32 v152, v152, v93
    v_mul_f32 v153, v153, v93
    v_mul_f32 v154, v154, v93
    v_mul_f32 v155, v155, v93
    v_mul_f32 v156, v156, v95
    v_mul_f32 v157, v157, v95
    v_mul_f32 v158, v158, v95
    v_mul_f32 v159, v159, v95
    v_mul_f32 v160, v160, v89
    v_mul_f32 v161, v161, v89
    v_mul_f32 v162, v162, v89
    v_mul_f32 v163, v163, v89
    v_mul_f32 v164, v164, v91
    v_mul_f32 v165, v165, v91
    v_mul_f32 v166, v166, v91
    v_mul_f32 v167, v167, v91
    v_mul_f32 v168, v168, v93
    v_mul_f32 v169, v169, v93
    v_mul_f32 v170, v170, v93
    v_mul_f32 v171, v171, v93
    v_mul_f32 v172, v172, v95
    v_mul_f32 v173, v173, v95
    v_mul_f32 v174, v174, v95
    v_mul_f32 v175, v175, v95
    v_mul_f32 v176, v176, v89
    v_mul_f32 v177, v177, v89
    v_mul_f32 v178, v178, v89
    v_mul_f32 v179, v179, v89
    v_mul_f32 v180, v180, v91
    v_mul_f32 v181, v181, v91
    v_mul_f32 v182, v182, v91
    v_mul_f32 v183, v183, v91
    v_mul_f32 v184, v184, v93
    v_mul_f32 v185, v185, v93
    v_mul_f32 v186, v186, v93
    v_mul_f32 v187, v187, v93
    v_mul_f32 v188, v188, v95
    v_mul_f32 v189, v189, v95
    v_mul_f32 v190, v190, v95
    v_mul_f32 v191, v191, v95
    v_mul_f32 v192, v192, v89
    v_mul_f32 v193, v193, v89
    v_mul_f32 v194, v194, v89
    v_mul_f32 v195, v195, v89
    v_mul_f32 v196, v196, v91
    v_mul_f32 v197, v197, v91
    v_mul_f32 v198, v198, v91
    v_mul_f32 v199, v199, v91
    v_mul_f32 v200, v200, v93
    v_mul_f32 v201, v201, v93
    v_mul_f32 v202, v202, v93
    v_mul_f32 v203, v203, v93
    v_mul_f32 v204, v204, v95
    v_mul_f32 v205, v205, v95
    v_mul_f32 v206, v206, v95
    v_mul_f32 v207, v207, v95
    v_mul_f32 v208, v208, v89
    v_mul_f32 v209, v209, v89
    v_mul_f32 v210, v210, v89
    v_mul_f32 v211, v211, v89
    v_mul_f32 v212, v212, v91
    v_mul_f32 v213, v213, v91
    v_mul_f32 v214, v214, v91
    v_mul_f32 v215, v215, v91
    v_mul_f32 v216, v216, v93
    v_mul_f32 v217, v217, v93
    v_mul_f32 v218, v218, v93
    v_mul_f32 v219, v219, v93
    v_mul_f32 v220, v220, v95
    v_mul_f32 v221, v221, v95
    v_mul_f32 v222, v222, v95
    v_mul_f32 v223, v223, v95
    v_mul_f32 v224, v224, v89
    v_mul_f32 v225, v225, v89
    v_mul_f32 v226, v226, v89
    v_mul_f32 v227, v227, v89
    v_mul_f32 v228, v228, v91
    v_mul_f32 v229, v229, v91
    v_mul_f32 v230, v230, v91
    v_mul_f32 v231, v231, v91
    v_mul_f32 v232, v232, v93
    v_mul_f32 v233, v233, v93
    v_mul_f32 v234, v234, v93
    v_mul_f32 v235, v235, v93
    v_mul_f32 v236, v236, v95
    v_mul_f32 v237, v237, v95
    v_mul_f32 v238, v238, v95
    v_mul_f32 v239, v239, v95
    v_mul_f32 v240, v240, v89
    v_mul_f32 v241, v241, v89
    v_mul_f32 v242, v242, v89
    v_mul_f32 v243, v243, v89
    v_mul_f32 v244, v244, v91
    v_mul_f32 v245, v245, v91
    v_mul_f32 v246, v246, v91
    v_mul_f32 v247, v247, v91
    v_mul_f32 v248, v248, v93
    v_mul_f32 v249, v249, v93
    v_mul_f32 v250, v250, v93
    v_mul_f32 v251, v251, v93
    v_mul_f32 v252, v252, v95
    v_mul_f32 v253, v253, v95
    v_mul_f32 v254, v254, v95
    v_mul_f32 v255, v255, v95
    v_accvgpr_read_b32 v96, a128
    v_accvgpr_read_b32 v97, a129
    v_accvgpr_read_b32 v98, a130
    v_accvgpr_read_b32 v99, a131
    v_mul_f32 v96, v96, v89
    v_mul_f32 v97, v97, v89
    v_mul_f32 v98, v98, v89
    v_mul_f32 v99, v99, v89
    v_accvgpr_write_b32 a128, v96
    v_accvgpr_write_b32 a129, v97
    v_accvgpr_write_b32 a130, v98
    v_accvgpr_write_b32 a131, v99
    v_accvgpr_read_b32 v96, a132
    v_accvgpr_read_b32 v97, a133
    v_accvgpr_read_b32 v98, a134
    v_accvgpr_read_b32 v99, a135
    v_mul_f32 v96, v96, v91
    v_mul_f32 v97, v97, v91
    v_mul_f32 v98, v98, v91
    v_mul_f32 v99, v99, v91
    v_accvgpr_write_b32 a132, v96
    v_accvgpr_write_b32 a133, v97
    v_accvgpr_write_b32 a134, v98
    v_accvgpr_write_b32 a135, v99
    v_accvgpr_read_b32 v96, a136
    v_accvgpr_read_b32 v97, a137
    v_accvgpr_read_b32 v98, a138
    v_accvgpr_read_b32 v99, a139
    v_mul_f32 v96, v96, v93
    v_mul_f32 v97, v97, v93
    v_mul_f32 v98, v98, v93
    v_mul_f32 v99, v99, v93
    v_accvgpr_write_b32 a136, v96
    v_accvgpr_write_b32 a137, v97
    v_accvgpr_write_b32 a138, v98
    v_accvgpr_write_b32 a139, v99
    v_accvgpr_read_b32 v96, a140
    v_accvgpr_read_b32 v97, a141
    v_accvgpr_read_b32 v98, a142
    v_accvgpr_read_b32 v99, a143
    v_mul_f32 v96, v96, v95
    v_mul_f32 v97, v97, v95
    v_mul_f32 v98, v98, v95
    v_mul_f32 v99, v99, v95
    v_accvgpr_write_b32 a140, v96
    v_accvgpr_write_b32 a141, v97
    v_accvgpr_write_b32 a142, v98
    v_accvgpr_write_b32 a143, v99
    v_accvgpr_read_b32 v96, a144
    v_accvgpr_read_b32 v97, a145
    v_accvgpr_read_b32 v98, a146
    v_accvgpr_read_b32 v99, a147
    v_mul_f32 v96, v96, v89
    v_mul_f32 v97, v97, v89
    v_mul_f32 v98, v98, v89
    v_mul_f32 v99, v99, v89
    v_accvgpr_write_b32 a144, v96
    v_accvgpr_write_b32 a145, v97
    v_accvgpr_write_b32 a146, v98
    v_accvgpr_write_b32 a147, v99
    v_accvgpr_read_b32 v96, a148
    v_accvgpr_read_b32 v97, a149
    v_accvgpr_read_b32 v98, a150
    v_accvgpr_read_b32 v99, a151
    v_mul_f32 v96, v96, v91
    v_mul_f32 v97, v97, v91
    v_mul_f32 v98, v98, v91
    v_mul_f32 v99, v99, v91
    v_accvgpr_write_b32 a148, v96
    v_accvgpr_write_b32 a149, v97
    v_accvgpr_write_b32 a150, v98
    v_accvgpr_write_b32 a151, v99
    v_accvgpr_read_b32 v96, a152
    v_accvgpr_read_b32 v97, a153
    v_accvgpr_read_b32 v98, a154
    v_accvgpr_read_b32 v99, a155
    v_mul_f32 v96, v96, v93
    v_mul_f32 v97, v97, v93
    v_mul_f32 v98, v98, v93
    v_mul_f32 v99, v99, v93
    v_accvgpr_write_b32 a152, v96
    v_accvgpr_write_b32 a153, v97
    v_accvgpr_write_b32 a154, v98
    v_accvgpr_write_b32 a155, v99
    v_accvgpr_read_b32 v96, a156
    v_accvgpr_read_b32 v97, a157
    v_accvgpr_read_b32 v98, a158
    v_accvgpr_read_b32 v99, a159
    v_mul_f32 v96, v96, v95
    v_mul_f32 v97, v97, v95
    v_mul_f32 v98, v98, v95
    v_mul_f32 v99, v99, v95
    v_accvgpr_write_b32 a156, v96
    v_accvgpr_write_b32 a157, v97
    v_accvgpr_write_b32 a158, v98
    v_accvgpr_write_b32 a159, v99
    v_accvgpr_read_b32 v96, a160
    v_accvgpr_read_b32 v97, a161
    v_accvgpr_read_b32 v98, a162
    v_accvgpr_read_b32 v99, a163
    v_mul_f32 v96, v96, v89
    v_mul_f32 v97, v97, v89
    v_mul_f32 v98, v98, v89
    v_mul_f32 v99, v99, v89
    v_accvgpr_write_b32 a160, v96
    v_accvgpr_write_b32 a161, v97
    v_accvgpr_write_b32 a162, v98
    v_accvgpr_write_b32 a163, v99
    v_accvgpr_read_b32 v96, a164
    v_accvgpr_read_b32 v97, a165
    v_accvgpr_read_b32 v98, a166
    v_accvgpr_read_b32 v99, a167
    v_mul_f32 v96, v96, v91
    v_mul_f32 v97, v97, v91
    v_mul_f32 v98, v98, v91
    v_mul_f32 v99, v99, v91
    v_accvgpr_write_b32 a164, v96
    v_accvgpr_write_b32 a165, v97
    v_accvgpr_write_b32 a166, v98
    v_accvgpr_write_b32 a167, v99
    v_accvgpr_read_b32 v96, a168
    v_accvgpr_read_b32 v97, a169
    v_accvgpr_read_b32 v98, a170
    v_accvgpr_read_b32 v99, a171
    v_mul_f32 v96, v96, v93
    v_mul_f32 v97, v97, v93
    v_mul_f32 v98, v98, v93
    v_mul_f32 v99, v99, v93
    v_accvgpr_write_b32 a168, v96
    v_accvgpr_write_b32 a169, v97
    v_accvgpr_write_b32 a170, v98
    v_accvgpr_write_b32 a171, v99
    v_accvgpr_read_b32 v96, a172
    v_accvgpr_read_b32 v97, a173
    v_accvgpr_read_b32 v98, a174
    v_accvgpr_read_b32 v99, a175
    v_mul_f32 v96, v96, v95
    v_mul_f32 v97, v97, v95
    v_mul_f32 v98, v98, v95
    v_mul_f32 v99, v99, v95
    v_accvgpr_write_b32 a172, v96
    v_accvgpr_write_b32 a173, v97
    v_accvgpr_write_b32 a174, v98
    v_accvgpr_write_b32 a175, v99
    v_accvgpr_read_b32 v96, a176
    v_accvgpr_read_b32 v97, a177
    v_accvgpr_read_b32 v98, a178
    v_accvgpr_read_b32 v99, a179
    v_mul_f32 v96, v96, v89
    v_mul_f32 v97, v97, v89
    v_mul_f32 v98, v98, v89
    v_mul_f32 v99, v99, v89
    v_accvgpr_write_b32 a176, v96
    v_accvgpr_write_b32 a177, v97
    v_accvgpr_write_b32 a178, v98
    v_accvgpr_write_b32 a179, v99
    v_accvgpr_read_b32 v96, a180
    v_accvgpr_read_b32 v97, a181
    v_accvgpr_read_b32 v98, a182
    v_accvgpr_read_b32 v99, a183
    v_mul_f32 v96, v96, v91
    v_mul_f32 v97, v97, v91
    v_mul_f32 v98, v98, v91
    v_mul_f32 v99, v99, v91
    v_accvgpr_write_b32 a180, v96
    v_accvgpr_write_b32 a181, v97
    v_accvgpr_write_b32 a182, v98
    v_accvgpr_write_b32 a183, v99
    v_accvgpr_read_b32 v96, a184
    v_accvgpr_read_b32 v97, a185
    v_accvgpr_read_b32 v98, a186
    v_accvgpr_read_b32 v99, a187
    v_mul_f32 v96, v96, v93
    v_mul_f32 v97, v97, v93
    v_mul_f32 v98, v98, v93
    v_mul_f32 v99, v99, v93
    v_accvgpr_write_b32 a184, v96
    v_accvgpr_write_b32 a185, v97
    v_accvgpr_write_b32 a186, v98
    v_accvgpr_write_b32 a187, v99
    v_accvgpr_read_b32 v96, a188
    v_accvgpr_read_b32 v97, a189
    v_accvgpr_read_b32 v98, a190
    v_accvgpr_read_b32 v99, a191
    v_mul_f32 v96, v96, v95
    v_mul_f32 v97, v97, v95
    v_mul_f32 v98, v98, v95
    v_mul_f32 v99, v99, v95
    v_accvgpr_write_b32 a188, v96
    v_accvgpr_write_b32 a189, v97
    v_accvgpr_write_b32 a190, v98
    v_accvgpr_write_b32 a191, v99
    v_accvgpr_read_b32 v96, a192
    v_accvgpr_read_b32 v97, a193
    v_accvgpr_read_b32 v98, a194
    v_accvgpr_read_b32 v99, a195
    v_mul_f32 v96, v96, v89
    v_mul_f32 v97, v97, v89
    v_mul_f32 v98, v98, v89
    v_mul_f32 v99, v99, v89
    v_accvgpr_write_b32 a192, v96
    v_accvgpr_write_b32 a193, v97
    v_accvgpr_write_b32 a194, v98
    v_accvgpr_write_b32 a195, v99
    v_accvgpr_read_b32 v96, a196
    v_accvgpr_read_b32 v97, a197
    v_accvgpr_read_b32 v98, a198
    v_accvgpr_read_b32 v99, a199
    v_mul_f32 v96, v96, v91
    v_mul_f32 v97, v97, v91
    v_mul_f32 v98, v98, v91
    v_mul_f32 v99, v99, v91
    v_accvgpr_write_b32 a196, v96
    v_accvgpr_write_b32 a197, v97
    v_accvgpr_write_b32 a198, v98
    v_accvgpr_write_b32 a199, v99
    v_accvgpr_read_b32 v96, a200
    v_accvgpr_read_b32 v97, a201
    v_accvgpr_read_b32 v98, a202
    v_accvgpr_read_b32 v99, a203
    v_mul_f32 v96, v96, v93
    v_mul_f32 v97, v97, v93
    v_mul_f32 v98, v98, v93
    v_mul_f32 v99, v99, v93
    v_accvgpr_write_b32 a200, v96
    v_accvgpr_write_b32 a201, v97
    v_accvgpr_write_b32 a202, v98
    v_accvgpr_write_b32 a203, v99
    v_accvgpr_read_b32 v96, a204
    v_accvgpr_read_b32 v97, a205
    v_accvgpr_read_b32 v98, a206
    v_accvgpr_read_b32 v99, a207
    v_mul_f32 v96, v96, v95
    v_mul_f32 v97, v97, v95
    v_mul_f32 v98, v98, v95
    v_mul_f32 v99, v99, v95
    v_accvgpr_write_b32 a204, v96
    v_accvgpr_write_b32 a205, v97
    v_accvgpr_write_b32 a206, v98
    v_accvgpr_write_b32 a207, v99
    v_accvgpr_read_b32 v96, a208
    v_accvgpr_read_b32 v97, a209
    v_accvgpr_read_b32 v98, a210
    v_accvgpr_read_b32 v99, a211
    v_mul_f32 v96, v96, v89
    v_mul_f32 v97, v97, v89
    v_mul_f32 v98, v98, v89
    v_mul_f32 v99, v99, v89
    v_accvgpr_write_b32 a208, v96
    v_accvgpr_write_b32 a209, v97
    v_accvgpr_write_b32 a210, v98
    v_accvgpr_write_b32 a211, v99
    v_accvgpr_read_b32 v96, a212
    v_accvgpr_read_b32 v97, a213
    v_accvgpr_read_b32 v98, a214
    v_accvgpr_read_b32 v99, a215
    v_mul_f32 v96, v96, v91
    v_mul_f32 v97, v97, v91
    v_mul_f32 v98, v98, v91
    v_mul_f32 v99, v99, v91
    v_accvgpr_write_b32 a212, v96
    v_accvgpr_write_b32 a213, v97
    v_accvgpr_write_b32 a214, v98
    v_accvgpr_write_b32 a215, v99
    v_accvgpr_read_b32 v96, a216
    v_accvgpr_read_b32 v97, a217
    v_accvgpr_read_b32 v98, a218
    v_accvgpr_read_b32 v99, a219
    v_mul_f32 v96, v96, v93
    v_mul_f32 v97, v97, v93
    v_mul_f32 v98, v98, v93
    v_mul_f32 v99, v99, v93
    v_accvgpr_write_b32 a216, v96
    v_accvgpr_write_b32 a217, v97
    v_accvgpr_write_b32 a218, v98
    v_accvgpr_write_b32 a219, v99
    v_accvgpr_read_b32 v96, a220
    v_accvgpr_read_b32 v97, a221
    v_accvgpr_read_b32 v98, a222
    v_accvgpr_read_b32 v99, a223
    v_mul_f32 v96, v96, v95
    v_mul_f32 v97, v97, v95
    v_mul_f32 v98, v98, v95
    v_mul_f32 v99, v99, v95
    v_accvgpr_write_b32 a220, v96
    v_accvgpr_write_b32 a221, v97
    v_accvgpr_write_b32 a222, v98
    v_accvgpr_write_b32 a223, v99
    v_accvgpr_read_b32 v96, a224
    v_accvgpr_read_b32 v97, a225
    v_accvgpr_read_b32 v98, a226
    v_accvgpr_read_b32 v99, a227
    v_mul_f32 v96, v96, v89
    v_mul_f32 v97, v97, v89
    v_mul_f32 v98, v98, v89
    v_mul_f32 v99, v99, v89
    v_accvgpr_write_b32 a224, v96
    v_accvgpr_write_b32 a225, v97
    v_accvgpr_write_b32 a226, v98
    v_accvgpr_write_b32 a227, v99
    v_accvgpr_read_b32 v96, a228
    v_accvgpr_read_b32 v97, a229
    v_accvgpr_read_b32 v98, a230
    v_accvgpr_read_b32 v99, a231
    v_mul_f32 v96, v96, v91
    v_mul_f32 v97, v97, v91
    v_mul_f32 v98, v98, v91
    v_mul_f32 v99, v99, v91
    v_accvgpr_write_b32 a228, v96
    v_accvgpr_write_b32 a229, v97
    v_accvgpr_write_b32 a230, v98
    v_accvgpr_write_b32 a231, v99
    v_accvgpr_read_b32 v96, a232
    v_accvgpr_read_b32 v97, a233
    v_accvgpr_read_b32 v98, a234
    v_accvgpr_read_b32 v99, a235
    v_mul_f32 v96, v96, v93
    v_mul_f32 v97, v97, v93
    v_mul_f32 v98, v98, v93
    v_mul_f32 v99, v99, v93
    v_accvgpr_write_b32 a232, v96
    v_accvgpr_write_b32 a233, v97
    v_accvgpr_write_b32 a234, v98
    v_accvgpr_write_b32 a235, v99
    v_accvgpr_read_b32 v96, a236
    v_accvgpr_read_b32 v97, a237
    v_accvgpr_read_b32 v98, a238
    v_accvgpr_read_b32 v99, a239
    v_mul_f32 v96, v96, v95
    v_mul_f32 v97, v97, v95
    v_mul_f32 v98, v98, v95
    v_mul_f32 v99, v99, v95
    v_accvgpr_write_b32 a236, v96
    v_accvgpr_write_b32 a237, v97
    v_accvgpr_write_b32 a238, v98
    v_accvgpr_write_b32 a239, v99
    v_accvgpr_read_b32 v96, a240
    v_accvgpr_read_b32 v97, a241
    v_accvgpr_read_b32 v98, a242
    v_accvgpr_read_b32 v99, a243
    v_mul_f32 v96, v96, v89
    v_mul_f32 v97, v97, v89
    v_mul_f32 v98, v98, v89
    v_mul_f32 v99, v99, v89
    v_accvgpr_write_b32 a240, v96
    v_accvgpr_write_b32 a241, v97
    v_accvgpr_write_b32 a242, v98
    v_accvgpr_write_b32 a243, v99
    v_accvgpr_read_b32 v96, a244
    v_accvgpr_read_b32 v97, a245
    v_accvgpr_read_b32 v98, a246
    v_accvgpr_read_b32 v99, a247
    v_mul_f32 v96, v96, v91
    v_mul_f32 v97, v97, v91
    v_mul_f32 v98, v98, v91
    v_mul_f32 v99, v99, v91
    v_accvgpr_write_b32 a244, v96
    v_accvgpr_write_b32 a245, v97
    v_accvgpr_write_b32 a246, v98
    v_accvgpr_write_b32 a247, v99
    v_accvgpr_read_b32 v96, a248
    v_accvgpr_read_b32 v97, a249
    v_accvgpr_read_b32 v98, a250
    v_accvgpr_read_b32 v99, a251
    v_mul_f32 v96, v96, v93
    v_mul_f32 v97, v97, v93
    v_mul_f32 v98, v98, v93
    v_mul_f32 v99, v99, v93
    v_accvgpr_write_b32 a248, v96
    v_accvgpr_write_b32 a249, v97
    v_accvgpr_write_b32 a250, v98
    v_accvgpr_write_b32 a251, v99
    v_accvgpr_read_b32 v96, a252
    v_accvgpr_read_b32 v97, a253
    v_accvgpr_read_b32 v98, a254
    v_accvgpr_read_b32 v99, a255
    v_mul_f32 v96, v96, v95
    v_mul_f32 v97, v97, v95
    v_mul_f32 v98, v98, v95
    v_mul_f32 v99, v99, v95
    v_accvgpr_write_b32 a252, v96
    v_accvgpr_write_b32 a253, v97
    v_accvgpr_write_b32 a254, v98
    v_accvgpr_write_b32 a255, v99
    s_nop 1
    s_setpc_b64 s[36:37]
L_code_end:
.section .rodata,"a"
.p2align 6
.amdhsa_kernel standalone__mha_softmax__near_ridge_kernel
  .amdhsa_next_free_vgpr 512
  .amdhsa_next_free_sgpr 96
  .amdhsa_accum_offset 256
  .amdhsa_group_segment_fixed_size 0
  .amdhsa_kernarg_size 48
  .amdhsa_user_sgpr_count 2
  .amdhsa_user_sgpr_kernarg_segment_ptr 1
  .amdhsa_system_sgpr_workgroup_id_x 1
.end_amdhsa_kernel
```
